```python
import torch

def _softmax(x, axis=-1):
    return torch.softmax(x, dim=axis)
def _gelu(x):
    return torch.nn.functional.gelu(x, approximate="tanh")
def _silu(x):
    return torch.nn.functional.silu(x)
def _sigmoid(x):
    return torch.sigmoid(x)
def _layernorm(x, axis=-1, eps=1e-5):
    m = x.mean(dim=axis, keepdim=True)
    v = x.var(dim=axis, keepdim=True, unbiased=False)
    return (x - m) / torch.sqrt(v + eps)
def _scatter_add(tgt, idx, src, axis=0):
    return tgt.clone().index_add_(axis, idx, src)
def _segment_sum(src, seg, n):
    out = torch.zeros((n,) + src.shape[1:], dtype=src.dtype)
    return out.index_add_(0, seg, src)
def _pad(x, pw):
    flat = tuple(v for pair in reversed(pw) for v in pair)
    return torch.nn.functional.pad(x, flat)

kernel_name = 'standalone__gqa_softmax__near_ridge'

def setup_inputs():

    _w = (lambda a: (lambda t: t.to(torch.bfloat16) if t.is_floating_point() else t)(torch.as_tensor(a)))
    B, Hq, Hkv, Sq, Sk, D = 64, 32, 16, 256, 256, 128
    return {
        "q": _w((lambda *s: torch.randn(*s, dtype=torch.bfloat16) * 0.8)(B, Hq, Sq, D)),
        "k": _w((lambda *s: torch.randn(*s, dtype=torch.bfloat16) * 0.8)(B, Hkv, Sk, D)),
        "v": _w((lambda *s: torch.randn(*s, dtype=torch.bfloat16) * 0.05)(B, Hkv, Sk, D)),
    }

def reference(q, k, v):
    B, Hq, Sq, D = q.shape
    Hkv = k.shape[1]
    rep = Hq // Hkv
    k = (lambda x, n, axis: torch.repeat_interleave(x, n, dim=axis))(k, rep, axis=1)
    v = (lambda x, n, axis: torch.repeat_interleave(x, n, dim=axis))(v, rep, axis=1)
    scale = D ** -0.5
    scores = torch.einsum("bhqd,bhkd->bhqk", q, k) * scale
    p = _softmax(scores, axis=-1)
    return torch.einsum("bhqk,bhkd->bhqd", p, v)
```

```asm
; @launch grid=(256,1,1) block=(512,1,1) lds=163840
.amdgcn_target "amdgcn-amd-amdhsa--gfx950"
.text
.globl standalone__gqa_softmax__near_ridge_kernel
.p2align 8
.type standalone__gqa_softmax__near_ridge_kernel,@function
standalone__gqa_softmax__near_ridge_kernel:
    s_cmp_ge_u32 s2, 0x100
    s_cbranch_scc0 L_go
    s_endpgm
L_go:
    s_load_dwordx2 s[16:17], s[0:1], 8
    s_load_dwordx2 s[12:13], s[0:1], 0
    s_load_dwordx2 s[20:21], s[0:1], 16
    s_load_dwordx2 s[24:25], s[0:1], 24
    s_load_dwordx2 s[52:53], s[0:1], 24
    v_lshrrev_b32 v10, 6, v0
    v_and_b32 v1, 63, v0
    v_readfirstlane_b32 s28, v10
    v_lshrrev_b32 v2, 4, v1
    v_and_b32 v3, 15, v1
    v_xor_b32 v4, v3, v2
    v_lshlrev_b32 v4, 4, v4
    v_lshl_add_u32 v5, v2, 8, v4
    v_and_b32 v9, 3, v10
    v_lshlrev_b32 v9, 6, v9
    v_xor_b32 v245, v5, v9
    v_and_b32 v9, 1, v10
    v_lshlrev_b32 v9, 7, v9
    v_xor_b32 v246, v5, v9
    v_mov_b32 v240, v5
    v_xor_b32 v241, 0x440, v240
    v_xor_b32 v242, 0x880, v240
    v_xor_b32 v243, 0xcc0, v240
    s_lshl_b32 s37, s28, 10
    s_lshl_b32 s58, s28, 12
    s_add_u32 s58, s58, 0x20000
    s_mov_b32 s3, s2
    s_lshl_b32 s30, s3, 17
    s_lshr_b32 s41, s28, 0
    s_and_b32 s41, s41, 1
    s_lshl_b32 s41, s41, 15
    s_add_u32 s30, s30, s41
    s_lshr_b32 s41, s28, 1
    s_and_b32 s41, s41, 1
    s_lshl_b32 s41, s41, 16
    s_add_u32 s30, s30, s41
    s_lshr_b32 s41, s28, 2
    s_and_b32 s41, s41, 1
    s_lshl_b32 s41, s41, 13
    s_add_u32 s30, s30, s41
    s_xor_b32 s31, s30, 0x1000
    s_mov_b32 s32, 0
    s_mov_b32 s33, 0
    s_mov_b32 s35, 0
    s_lshl_b32 s36, s3, 16
    s_lshr_b32 s3, s28, 0
    s_and_b32 s3, s3, 1
    s_lshl_b32 s3, s3, 15
    s_add_u32 s36, s36, s3
    s_lshr_b32 s3, s28, 1
    s_and_b32 s3, s3, 1
    s_lshl_b32 s3, s3, 11
    s_add_u32 s36, s36, s3
    s_lshr_b32 s3, s28, 2
    s_and_b32 s3, s3, 1
    s_lshl_b32 s3, s3, 10
    s_add_u32 s36, s36, s3
    s_mov_b32 s29, 0
    s_mov_b32 s40, 0x49800000
    s_mov_b32 s14, 0x8000000
    s_mov_b32 s15, 0x20000
    s_mov_b32 s18, 0x4000000
    s_mov_b32 s19, 0x20000
    s_mov_b32 s22, 0x4000000
    s_mov_b32 s23, 0x20000
    s_mov_b32 s26, 0x8000000
    s_mov_b32 s27, 0x20000
    s_mov_b32 s54, 0x0
    s_mov_b32 s55, 0x20000
    s_setprio 3
    s_waitcnt lgkmcnt(0)
    s_add_u32 m0, s37, 0x0
    s_xor_b32 s38, s36, 0x0
    buffer_load_dwordx4 v245, s[16:19], s38 offen offset:0 nt lds
    s_setprio 0
    s_add_u32 m0, s58, 0x0
    s_nop 0
    buffer_load_dwordx4 v240, s[12:15], s30 offen offset:0 nt lds
    s_add_u32 m0, s58, 0x400
    s_nop 0
    buffer_load_dwordx4 v241, s[12:15], s30 offen offset:0 nt lds
    s_add_u32 m0, s58, 0x800
    s_nop 0
    buffer_load_dwordx4 v242, s[12:15], s30 offen offset:0 nt lds
    s_add_u32 m0, s58, 0xc00
    s_nop 0
    buffer_load_dwordx4 v243, s[12:15], s30 offen offset:0 nt lds
    s_add_u32 m0, s58, 0xffff8000
    s_nop 0
    buffer_load_dwordx4 v240, s[12:15], s31 offen offset:0 nt lds
    s_add_u32 m0, s58, 0xffff8400
    s_nop 0
    buffer_load_dwordx4 v241, s[12:15], s31 offen offset:0 nt lds
    s_add_u32 m0, s58, 0xffff8800
    s_nop 0
    buffer_load_dwordx4 v242, s[12:15], s31 offen offset:0 nt lds
    s_add_u32 m0, s58, 0xffff8c00
    s_nop 0
    buffer_load_dwordx4 v243, s[12:15], s31 offen offset:0 nt lds
    s_getpc_b64 s[4:5]
L_pc:
    s_lshr_b32 s41, s2, 3
    s_lshl_b32 s41, s41, 11
    v_lshrrev_b32 v11, 5, v0
    v_lshl_add_u32 v11, v11, 7, s41
    v_min_u32 v11, L_codeend-L_pc-16, v11
    v_mov_b32 v13, s5
    v_add_co_u32 v12, vcc, s4, v11
    s_nop 1
    v_addc_co_u32 v13, vcc, 0, v13, vcc
    global_load_dword v16, v[12:13], off
    v_and_b32 v9, 1, v1
    v_lshl_add_u32 v9, v2, 1, v9
    v_lshlrev_b32 v9, 4, v9
    v_bfe_u32 v8, v1, 1, 1
    v_lshl_add_u32 v9, v8, 9, v9
    v_bfe_u32 v8, v1, 2, 1
    v_lshl_add_u32 v9, v8, 10, v9
    v_bfe_u32 v8, v1, 3, 1
    v_lshl_add_u32 v244, v8, 11, v9
    v_lshl_add_u32 v224, v3, 8, v4
    v_xor_b32 v225, 64, v224
    v_xor_b32 v226, 0x80, v224
    v_xor_b32 v227, 0xc0, v224
    v_add_u32 v236, s58, v224
    v_add_u32 v237, s58, v225
    v_add_u32 v238, s58, v226
    v_add_u32 v239, s58, v227
    v_add_u32 v168, 0xffff8000, v236
    v_add_u32 v169, 0xffff8000, v237
    v_add_u32 v170, 0xffff8000, v238
    v_add_u32 v171, 0xffff8000, v239
    v_lshrrev_b32 v8, 2, v1
    v_lshlrev_b32 v9, 8, v8
    v_and_b32 v8, 3, v8
    v_lshl_add_u32 v9, v8, 4, v9
    v_and_b32 v8, 1, v2
    v_lshl_add_u32 v9, v8, 7, v9
    v_bfe_u32 v8, v1, 1, 1
    v_lshl_add_u32 v9, v8, 6, v9
    v_and_b32 v8, 1, v1
    v_lshl_add_u32 v9, v8, 3, v9
    v_add_u32 v228, 0x10000, v9
    v_xor_b32 v229, 32, v228
    v_xor_b32 v230, 16, v228
    v_xor_b32 v231, 48, v228
    v_xor_b32 v232, 0x80, v228
    v_xor_b32 v233, 0xa0, v228
    v_xor_b32 v234, 0x90, v228
    v_xor_b32 v235, 0xb0, v228
    v_and_b32 v8, 3, v1
    v_min_u32 v8, 1, v8
    v_add_u32 v8, -1, v8
    v_and_b32 v216, 0x3f803f80, v8
    v_and_b32 v217, 0x3f803f80, v8
    v_and_b32 v218, 0x3f803f80, v8
    v_and_b32 v219, 0x3f803f80, v8
    s_mov_b32 vcc_lo, 0x55555555
    s_mov_b32 vcc_hi, 0x55555555
    s_cmp_ge_u32 s28, 4
    s_cbranch_scc1 L_lag
L_lead:
    s_waitcnt vmcnt(1)
    ds_read_b128 v[64:67], v236 offset:0
    ds_read_b128 v[68:71], v237 offset:0
    ds_read_b128 v[72:75], v238 offset:0
    ds_read_b128 v[76:79], v239 offset:0
    ds_read_b128 v[80:83], v168 offset:0
    ds_read_b128 v[84:87], v169 offset:0
    ds_read_b128 v[88:91], v170 offset:0
    ds_read_b128 v[92:95], v171 offset:0
    s_setprio 0
.p2align 3
    s_waitcnt vmcnt(9)
    s_barrier
    ds_read_b128 v[176:179], v224 offset:0
    ds_read_b128 v[180:183], v225 offset:0
    ds_read_b128 v[184:187], v226 offset:0
    ds_read_b128 v[188:191], v227 offset:0
    s_waitcnt lgkmcnt(3)
    v_mfma_f32_16x16x32_bf16 v[128:131], v[176:179], v[64:67], 0
    s_setprio 3
    ds_read_b128 v[192:195], v224 offset:4096
    v_mfma_f32_16x16x32_bf16 v[136:139], v[176:179], v[80:83], 0
    s_add_u32 m0, s37, 0x2000
    s_xor_b32 s38, s36, 0x1000
    buffer_load_dwordx4 v245, s[16:19], s38 offen offset:0 nt lds
    s_waitcnt lgkmcnt(3)
    v_mfma_f32_16x16x32_bf16 v[136:139], v[180:183], v[84:87], v[136:139]
    ds_read_b128 v[196:199], v225 offset:4096
    v_mfma_f32_16x16x32_bf16 v[128:131], v[180:183], v[68:71], v[128:131]
    s_add_u32 m0, s37, 0x10000
    s_xor_b32 s38, s36, 0x0
    buffer_load_dwordx4 v246, s[20:23], s38 offen offset:0 nt lds
    s_waitcnt lgkmcnt(3)
    v_mfma_f32_16x16x32_bf16 v[128:131], v[184:187], v[72:75], v[128:131]
    ds_read_b128 v[176:179], v226 offset:4096
    v_mfma_f32_16x16x32_bf16 v[136:139], v[184:187], v[88:91], v[136:139]
    s_waitcnt lgkmcnt(3)
    v_mfma_f32_16x16x32_bf16 v[136:139], v[188:191], v[92:95], v[136:139]
    ds_read_b128 v[180:183], v227 offset:4096
    v_mfma_f32_16x16x32_bf16 v[128:131], v[188:191], v[76:79], v[128:131]
    s_add_u32 m0, s37, 0x4000
    s_xor_b32 s38, s36, 0x2000
    buffer_load_dwordx4 v245, s[16:19], s38 offen offset:0 nt lds
    s_waitcnt lgkmcnt(3)
    v_mfma_f32_16x16x32_bf16 v[132:135], v[192:195], v[64:67], 0
    v_mfma_f32_16x16x32_bf16 v[140:143], v[192:195], v[80:83], 0
    s_waitcnt lgkmcnt(2)
    v_mfma_f32_16x16x32_bf16 v[140:143], v[196:199], v[84:87], v[140:143]
    v_mfma_f32_16x16x32_bf16 v[132:135], v[196:199], v[68:71], v[132:135]
    s_waitcnt lgkmcnt(1)
    v_mfma_f32_16x16x32_bf16 v[132:135], v[176:179], v[72:75], v[132:135]
    v_mfma_f32_16x16x32_bf16 v[140:143], v[176:179], v[88:91], v[140:143]
    s_waitcnt lgkmcnt(0)
    v_mfma_f32_16x16x32_bf16 v[140:143], v[180:183], v[92:95], v[140:143]
    v_mfma_f32_16x16x32_bf16 v[132:135], v[180:183], v[76:79], v[132:135]
    s_mov_b32 s50, s35
    s_mov_b32 s34, s32
    s_mov_b32 s32, s30
    s_xor_b32 s30, s30, 0x4000
    s_mov_b32 s35, s33
    s_mov_b32 s33, s31
    s_xor_b32 s31, s31, 0x4000
    s_setprio 0
.p2align 3
    v_max_f32_e64 v248, v128, v129
    v_max_f32_e64 v249, v136, v137
    v_max3_f32 v248, v248, v130, v131
    v_max3_f32 v249, v249, v138, v139
    v_max3_f32 v248, v248, v132, v133
    v_max3_f32 v249, v249, v140, v141
    v_max3_f32 v248, v248, v134, v135
    v_max3_f32 v249, v249, v142, v143
    s_nop 1
    v_permlane32_swap_b32 v248, v249
    v_max_f32 v248, v248, v249
    v_mov_b32 v249, v248
    s_nop 1
    v_permlane16_swap_b32 v248, v249
    v_max_f32 v248, v248, v249
    v_mul_f32 v248, 0xbe0293ee, v248
    v_mov_b32 v249, v248
    s_nop 1
    v_permlane32_swap_b32 v248, v249
.p2align 3
    v_fmamk_f32 v168, v128, 0x3e0293ee, v248
    v_fmamk_f32 v169, v129, 0x3e0293ee, v248
    v_fmamk_f32 v170, v130, 0x3e0293ee, v248
    v_fmamk_f32 v171, v131, 0x3e0293ee, v248
    v_exp_f32 v168, v168
    v_exp_f32 v169, v169
    v_exp_f32 v170, v170
    v_exp_f32 v171, v171
    v_fmamk_f32 v172, v136, 0x3e0293ee, v249
    v_fmamk_f32 v173, v137, 0x3e0293ee, v249
    v_fmamk_f32 v174, v138, 0x3e0293ee, v249
    v_fmamk_f32 v175, v139, 0x3e0293ee, v249
    s_setprio 1
    s_nop 0
    v_cvt_pk_bf16_f32 v160, v168, v169
    v_cvt_pk_bf16_f32 v161, v170, v171
    v_exp_f32 v172, v172
    v_exp_f32 v173, v173
    v_exp_f32 v174, v174
    v_exp_f32 v175, v175
    v_fmamk_f32 v168, v132, 0x3e0293ee, v248
    v_fmamk_f32 v169, v133, 0x3e0293ee, v248
    v_fmamk_f32 v170, v134, 0x3e0293ee, v248
    v_fmamk_f32 v171, v135, 0x3e0293ee, v248
    v_cvt_pk_bf16_f32 v164, v172, v173
    v_cvt_pk_bf16_f32 v165, v174, v175
    v_exp_f32 v168, v168
    v_exp_f32 v169, v169
    v_exp_f32 v170, v170
    v_exp_f32 v171, v171
    v_fmamk_f32 v172, v140, 0x3e0293ee, v249
    v_fmamk_f32 v173, v141, 0x3e0293ee, v249
    v_fmamk_f32 v174, v142, 0x3e0293ee, v249
    v_fmamk_f32 v175, v143, 0x3e0293ee, v249
    v_cvt_pk_bf16_f32 v162, v168, v169
    v_cvt_pk_bf16_f32 v163, v170, v171
    v_exp_f32 v172, v172
    v_exp_f32 v173, v173
    v_exp_f32 v174, v174
    v_exp_f32 v175, v175
    v_cvt_pk_bf16_f32 v166, v172, v173
    v_cvt_pk_bf16_f32 v167, v174, v175
    s_waitcnt vmcnt(1)
    s_barrier
    ds_read_b128 v[176:179], v224 offset:8192
    ds_read_b128 v[180:183], v225 offset:8192
    ds_read_b128 v[184:187], v226 offset:8192
    ds_read_b128 v[188:191], v227 offset:8192
    s_waitcnt vmcnt(0)
    v_mfma_f32_16x16x32_bf16 v[200:203], v[216:219], v[160:163], 0
    v_mfma_f32_16x16x32_bf16 v[204:207], v[216:219], v[164:167], 0
    s_waitcnt lgkmcnt(3)
    v_mfma_f32_16x16x32_bf16 v[144:147], v[176:179], v[64:67], 0
    s_setprio 3
    ds_read_b128 v[192:195], v224 offset:12288
    v_mfma_f32_16x16x32_bf16 v[152:155], v[176:179], v[80:83], 0
    s_add_u32 m0, s37, 0x6000
    s_xor_b32 s38, s36, 0x3000
    buffer_load_dwordx4 v245, s[16:19], s38 offen offset:0 nt lds
    s_waitcnt lgkmcnt(3)
    v_mfma_f32_16x16x32_bf16 v[152:155], v[180:183], v[84:87], v[152:155]
    ds_read_b128 v[196:199], v225 offset:12288
    v_mfma_f32_16x16x32_bf16 v[144:147], v[180:183], v[68:71], v[144:147]
    s_waitcnt lgkmcnt(3)
    v_mfma_f32_16x16x32_bf16 v[144:147], v[184:187], v[72:75], v[144:147]
    ds_read_b128 v[176:179], v226 offset:12288
    v_mfma_f32_16x16x32_bf16 v[152:155], v[184:187], v[88:91], v[152:155]
    s_add_u32 m0, s37, 0x12000
    s_xor_b32 s38, s36, 0x1000
    buffer_load_dwordx4 v246, s[20:23], s38 offen offset:0 nt lds
    s_waitcnt lgkmcnt(3)
    v_mfma_f32_16x16x32_bf16 v[152:155], v[188:191], v[92:95], v[152:155]
    ds_read_b128 v[180:183], v227 offset:12288
    v_mfma_f32_16x16x32_bf16 v[144:147], v[188:191], v[76:79], v[144:147]
    s_waitcnt lgkmcnt(3)
    v_mfma_f32_16x16x32_bf16 v[148:151], v[192:195], v[64:67], 0
    ds_read_b64_tr_b16 v[184:185], v228 offset:0
    v_mfma_f32_16x16x32_bf16 v[156:159], v[192:195], v[80:83], 0
    ds_read_b64_tr_b16 v[186:187], v228 offset:4096
    s_add_u32 m0, s58, 0x0
    s_nop 0
    buffer_load_dwordx4 v240, s[12:15], s30 offen offset:0 nt lds
    s_waitcnt lgkmcnt(4)
    v_mfma_f32_16x16x32_bf16 v[156:159], v[196:199], v[84:87], v[156:159]
    ds_read_b64_tr_b16 v[188:189], v229 offset:0
    v_mfma_f32_16x16x32_bf16 v[148:151], v[196:199], v[68:71], v[148:151]
    ds_read_b64_tr_b16 v[190:191], v229 offset:4096
    s_waitcnt lgkmcnt(5)
    v_mfma_f32_16x16x32_bf16 v[148:151], v[176:179], v[72:75], v[148:151]
    ds_read_b64_tr_b16 v[192:193], v230 offset:0
    v_mfma_f32_16x16x32_bf16 v[156:159], v[176:179], v[88:91], v[156:159]
    ds_read_b64_tr_b16 v[194:195], v230 offset:4096
    s_waitcnt lgkmcnt(6)
    v_mfma_f32_16x16x32_bf16 v[156:159], v[180:183], v[92:95], v[156:159]
    ds_read_b64_tr_b16 v[176:177], v231 offset:0
    v_mfma_f32_16x16x32_bf16 v[148:151], v[180:183], v[76:79], v[148:151]
    ds_read_b64_tr_b16 v[178:179], v231 offset:4096
    s_waitcnt lgkmcnt(6)
    v_mfma_f32_16x16x32_bf16 v[0:3], v[184:187], v[160:163], 0
    ds_read_b64_tr_b16 v[180:181], v232 offset:0
    v_mfma_f32_16x16x32_bf16 v[32:35], v[184:187], v[164:167], 0
    ds_read_b64_tr_b16 v[182:183], v232 offset:4096
    s_waitcnt lgkmcnt(6)
    v_mfma_f32_16x16x32_bf16 v[36:39], v[188:191], v[164:167], 0
    ds_read_b64_tr_b16 v[184:185], v233 offset:0
    v_mfma_f32_16x16x32_bf16 v[4:7], v[188:191], v[160:163], 0
    ds_read_b64_tr_b16 v[186:187], v233 offset:4096
    s_waitcnt lgkmcnt(6)
    v_mfma_f32_16x16x32_bf16 v[8:11], v[192:195], v[160:163], 0
    ds_read_b64_tr_b16 v[196:197], v234 offset:0
    v_mfma_f32_16x16x32_bf16 v[40:43], v[192:195], v[164:167], 0
    ds_read_b64_tr_b16 v[198:199], v234 offset:4096
    s_waitcnt lgkmcnt(6)
    v_mfma_f32_16x16x32_bf16 v[44:47], v[176:179], v[164:167], 0
    ds_read_b64_tr_b16 v[192:193], v235 offset:0
    v_mfma_f32_16x16x32_bf16 v[12:15], v[176:179], v[160:163], 0
    ds_read_b64_tr_b16 v[194:195], v235 offset:4096
    s_waitcnt lgkmcnt(6)
    v_mfma_f32_16x16x32_bf16 v[16:19], v[180:183], v[160:163], 0
    v_mfma_f32_16x16x32_bf16 v[48:51], v[180:183], v[164:167], 0
    s_waitcnt lgkmcnt(4)
    v_mfma_f32_16x16x32_bf16 v[52:55], v[184:187], v[164:167], 0
    v_mfma_f32_16x16x32_bf16 v[20:23], v[184:187], v[160:163], 0
    s_waitcnt lgkmcnt(2)
    v_mfma_f32_16x16x32_bf16 v[24:27], v[196:199], v[160:163], 0
    v_mfma_f32_16x16x32_bf16 v[56:59], v[196:199], v[164:167], 0
    s_waitcnt lgkmcnt(0)
    v_mfma_f32_16x16x32_bf16 v[60:63], v[192:195], v[164:167], 0
    v_mfma_f32_16x16x32_bf16 v[28:31], v[192:195], v[160:163], 0
    s_setprio 0
.p2align 3
    v_fmamk_f32 v168, v144, 0x3e0293ee, v248
    v_fmamk_f32 v169, v145, 0x3e0293ee, v248
    v_fmamk_f32 v170, v146, 0x3e0293ee, v248
    v_fmamk_f32 v171, v147, 0x3e0293ee, v248
    v_exp_f32 v168, v168
    v_exp_f32 v169, v169
    v_exp_f32 v170, v170
    v_exp_f32 v171, v171
    v_fmamk_f32 v172, v152, 0x3e0293ee, v249
    v_fmamk_f32 v173, v153, 0x3e0293ee, v249
    v_fmamk_f32 v174, v154, 0x3e0293ee, v249
    v_fmamk_f32 v175, v155, 0x3e0293ee, v249
    v_cvt_pk_bf16_f32 v160, v168, v169
    v_cvt_pk_bf16_f32 v161, v170, v171
    v_exp_f32 v172, v172
    v_exp_f32 v173, v173
    v_exp_f32 v174, v174
    v_exp_f32 v175, v175
    v_fmamk_f32 v168, v148, 0x3e0293ee, v248
    v_fmamk_f32 v169, v149, 0x3e0293ee, v248
    v_fmamk_f32 v170, v150, 0x3e0293ee, v248
    v_fmamk_f32 v171, v151, 0x3e0293ee, v248
    s_setprio 1
    s_nop 0
    v_cvt_pk_bf16_f32 v164, v172, v173
    v_cvt_pk_bf16_f32 v165, v174, v175
    v_exp_f32 v168, v168
    v_exp_f32 v169, v169
    v_exp_f32 v170, v170
    v_exp_f32 v171, v171
    v_fmamk_f32 v172, v156, 0x3e0293ee, v249
    v_fmamk_f32 v173, v157, 0x3e0293ee, v249
    v_fmamk_f32 v174, v158, 0x3e0293ee, v249
    v_fmamk_f32 v175, v159, 0x3e0293ee, v249
    v_cvt_pk_bf16_f32 v162, v168, v169
    v_cvt_pk_bf16_f32 v163, v170, v171
    v_exp_f32 v172, v172
    v_exp_f32 v173, v173
    v_exp_f32 v174, v174
    v_exp_f32 v175, v175
    v_cvt_pk_bf16_f32 v166, v172, v173
    v_cvt_pk_bf16_f32 v167, v174, v175
    s_waitcnt vmcnt(1)
    s_barrier
    ds_read_b128 v[176:179], v224 offset:16384
    ds_read_b128 v[180:183], v225 offset:16384
    ds_read_b128 v[184:187], v226 offset:16384
    ds_read_b128 v[188:191], v227 offset:16384
    s_waitcnt vmcnt(0)
    v_mfma_f32_16x16x32_bf16 v[208:211], v[216:219], v[160:163], v[200:203]
    v_mfma_f32_16x16x32_bf16 v[212:215], v[216:219], v[164:167], v[204:207]
    s_waitcnt lgkmcnt(3)
    v_mfma_f32_16x16x32_bf16 v[128:131], v[176:179], v[64:67], 0
    s_setprio 3
    ds_read_b128 v[192:195], v224 offset:20480
    v_mfma_f32_16x16x32_bf16 v[136:139], v[176:179], v[80:83], 0
    s_add_u32 m0, s37, 0x8000
    s_xor_b32 s38, s36, 0x4000
    buffer_load_dwordx4 v245, s[16:19], s38 offen offset:0 nt lds
    s_waitcnt lgkmcnt(3)
    v_mfma_f32_16x16x32_bf16 v[136:139], v[180:183], v[84:87], v[136:139]
    ds_read_b128 v[196:199], v225 offset:20480
    v_mfma_f32_16x16x32_bf16 v[128:131], v[180:183], v[68:71], v[128:131]
    s_waitcnt lgkmcnt(3)
    v_mfma_f32_16x16x32_bf16 v[128:131], v[184:187], v[72:75], v[128:131]
    ds_read_b128 v[176:179], v226 offset:20480
    v_mfma_f32_16x16x32_bf16 v[136:139], v[184:187], v[88:91], v[136:139]
    v_max_f32_e64 v250, v208, v212
    v_cmp_nle_f32_e64 s[42:43], v250, s40
    s_add_u32 m0, s37, 0x14000
    s_xor_b32 s38, s36, 0x2000
    buffer_load_dwordx4 v246, s[20:23], s38 offen offset:0 nt lds
    s_waitcnt lgkmcnt(3)
    v_mfma_f32_16x16x32_bf16 v[136:139], v[188:191], v[92:95], v[136:139]
    ds_read_b128 v[180:183], v227 offset:20480
    v_mfma_f32_16x16x32_bf16 v[128:131], v[188:191], v[76:79], v[128:131]
    s_cmp_lg_u64 s[42:43], 0
    s_cbranch_scc1 L_stublead0
L_retlead0:
    s_waitcnt lgkmcnt(3)
    v_mfma_f32_16x16x32_bf16 v[132:135], v[192:195], v[64:67], 0
    ds_read_b64_tr_b16 v[184:185], v228 offset:8192
    v_mfma_f32_16x16x32_bf16 v[140:143], v[192:195], v[80:83], 0
    ds_read_b64_tr_b16 v[186:187], v228 offset:12288
    s_add_u32 m0, s58, 0x400
    s_nop 0
    buffer_load_dwordx4 v241, s[12:15], s30 offen offset:0 nt lds
    s_waitcnt lgkmcnt(4)
    v_mfma_f32_16x16x32_bf16 v[140:143], v[196:199], v[84:87], v[140:143]
    ds_read_b64_tr_b16 v[188:189], v229 offset:8192
    v_mfma_f32_16x16x32_bf16 v[132:135], v[196:199], v[68:71], v[132:135]
    ds_read_b64_tr_b16 v[190:191], v229 offset:12288
    s_waitcnt lgkmcnt(5)
    v_mfma_f32_16x16x32_bf16 v[132:135], v[176:179], v[72:75], v[132:135]
    ds_read_b64_tr_b16 v[192:193], v230 offset:8192
    v_mfma_f32_16x16x32_bf16 v[140:143], v[176:179], v[88:91], v[140:143]
    ds_read_b64_tr_b16 v[194:195], v230 offset:12288
    s_waitcnt lgkmcnt(6)
    v_mfma_f32_16x16x32_bf16 v[140:143], v[180:183], v[92:95], v[140:143]
    ds_read_b64_tr_b16 v[176:177], v231 offset:8192
    v_mfma_f32_16x16x32_bf16 v[132:135], v[180:183], v[76:79], v[132:135]
    ds_read_b64_tr_b16 v[178:179], v231 offset:12288
    s_waitcnt lgkmcnt(6)
    v_mfma_f32_16x16x32_bf16 v[0:3], v[184:187], v[160:163], v[0:3]
    ds_read_b64_tr_b16 v[180:181], v232 offset:8192
    v_mfma_f32_16x16x32_bf16 v[32:35], v[184:187], v[164:167], v[32:35]
    ds_read_b64_tr_b16 v[182:183], v232 offset:12288
    s_waitcnt lgkmcnt(6)
    v_mfma_f32_16x16x32_bf16 v[36:39], v[188:191], v[164:167], v[36:39]
    ds_read_b64_tr_b16 v[184:185], v233 offset:8192
    v_mfma_f32_16x16x32_bf16 v[4:7], v[188:191], v[160:163], v[4:7]
    ds_read_b64_tr_b16 v[186:187], v233 offset:12288
    s_waitcnt lgkmcnt(6)
    v_mfma_f32_16x16x32_bf16 v[8:11], v[192:195], v[160:163], v[8:11]
    ds_read_b64_tr_b16 v[196:197], v234 offset:8192
    v_mfma_f32_16x16x32_bf16 v[40:43], v[192:195], v[164:167], v[40:43]
    ds_read_b64_tr_b16 v[198:199], v234 offset:12288
    s_waitcnt lgkmcnt(6)
    v_mfma_f32_16x16x32_bf16 v[44:47], v[176:179], v[164:167], v[44:47]
    ds_read_b64_tr_b16 v[192:193], v235 offset:8192
    v_mfma_f32_16x16x32_bf16 v[12:15], v[176:179], v[160:163], v[12:15]
    ds_read_b64_tr_b16 v[194:195], v235 offset:12288
    s_waitcnt lgkmcnt(6)
    v_mfma_f32_16x16x32_bf16 v[16:19], v[180:183], v[160:163], v[16:19]
    v_mfma_f32_16x16x32_bf16 v[48:51], v[180:183], v[164:167], v[48:51]
    s_waitcnt lgkmcnt(4)
    v_mfma_f32_16x16x32_bf16 v[52:55], v[184:187], v[164:167], v[52:55]
    v_mfma_f32_16x16x32_bf16 v[20:23], v[184:187], v[160:163], v[20:23]
    s_waitcnt lgkmcnt(2)
    v_mfma_f32_16x16x32_bf16 v[24:27], v[196:199], v[160:163], v[24:27]
    ds_read_b128 v[176:179], v224 offset:24576
    v_mfma_f32_16x16x32_bf16 v[56:59], v[196:199], v[164:167], v[56:59]
    ds_read_b128 v[180:183], v225 offset:24576
    s_waitcnt lgkmcnt(2)
    v_mfma_f32_16x16x32_bf16 v[60:63], v[192:195], v[164:167], v[60:63]
    ds_read_b128 v[184:187], v226 offset:24576
    v_mfma_f32_16x16x32_bf16 v[28:31], v[192:195], v[160:163], v[28:31]
    ds_read_b128 v[188:191], v227 offset:24576
    s_setprio 0
.p2align 3
    v_fmamk_f32 v168, v128, 0x3e0293ee, v248
    v_fmamk_f32 v169, v129, 0x3e0293ee, v248
    v_fmamk_f32 v170, v130, 0x3e0293ee, v248
    v_fmamk_f32 v171, v131, 0x3e0293ee, v248
    v_exp_f32 v168, v168
    v_exp_f32 v169, v169
    v_exp_f32 v170, v170
    v_exp_f32 v171, v171
    v_fmamk_f32 v172, v136, 0x3e0293ee, v249
    v_fmamk_f32 v173, v137, 0x3e0293ee, v249
    v_fmamk_f32 v174, v138, 0x3e0293ee, v249
    v_fmamk_f32 v175, v139, 0x3e0293ee, v249
    v_cvt_pk_bf16_f32 v160, v168, v169
    v_cvt_pk_bf16_f32 v161, v170, v171
    v_exp_f32 v172, v172
    v_exp_f32 v173, v173
    v_exp_f32 v174, v174
    v_exp_f32 v175, v175
    v_fmamk_f32 v168, v132, 0x3e0293ee, v248
    v_fmamk_f32 v169, v133, 0x3e0293ee, v248
    v_fmamk_f32 v170, v134, 0x3e0293ee, v248
    v_fmamk_f32 v171, v135, 0x3e0293ee, v248
    s_setprio 1
    s_nop 0
    v_cvt_pk_bf16_f32 v164, v172, v173
    v_cvt_pk_bf16_f32 v165, v174, v175
    v_exp_f32 v168, v168
    v_exp_f32 v169, v169
    v_exp_f32 v170, v170
    v_exp_f32 v171, v171
    v_fmamk_f32 v172, v140, 0x3e0293ee, v249
    v_fmamk_f32 v173, v141, 0x3e0293ee, v249
    v_fmamk_f32 v174, v142, 0x3e0293ee, v249
    v_fmamk_f32 v175, v143, 0x3e0293ee, v249
    v_cvt_pk_bf16_f32 v162, v168, v169
    v_cvt_pk_bf16_f32 v163, v170, v171
    v_exp_f32 v172, v172
    v_exp_f32 v173, v173
    v_exp_f32 v174, v174
    v_exp_f32 v175, v175
    v_cvt_pk_bf16_f32 v166, v172, v173
    v_cvt_pk_bf16_f32 v167, v174, v175
    s_waitcnt vmcnt(1)
    s_barrier
    s_waitcnt vmcnt(0)
    v_mfma_f32_16x16x32_bf16 v[200:203], v[216:219], v[160:163], v[208:211]
    v_mfma_f32_16x16x32_bf16 v[204:207], v[216:219], v[164:167], v[212:215]
    s_waitcnt lgkmcnt(3)
    v_mfma_f32_16x16x32_bf16 v[144:147], v[176:179], v[64:67], 0
    s_setprio 3
    ds_read_b128 v[192:195], v224 offset:28672
    v_mfma_f32_16x16x32_bf16 v[152:155], v[176:179], v[80:83], 0
    s_add_u32 m0, s37, 0xa000
    s_xor_b32 s38, s36, 0x5000
    buffer_load_dwordx4 v245, s[16:19], s38 offen offset:0 nt lds
    s_add_u32 m0, s37, 0x16000
    s_xor_b32 s38, s36, 0x3000
    buffer_load_dwordx4 v246, s[20:23], s38 offen offset:0 nt lds
    s_waitcnt lgkmcnt(3)
    v_mfma_f32_16x16x32_bf16 v[152:155], v[180:183], v[84:87], v[152:155]
    ds_read_b128 v[196:199], v225 offset:28672
    v_mfma_f32_16x16x32_bf16 v[144:147], v[180:183], v[68:71], v[144:147]
    s_waitcnt lgkmcnt(3)
    v_mfma_f32_16x16x32_bf16 v[144:147], v[184:187], v[72:75], v[144:147]
    ds_read_b128 v[176:179], v226 offset:28672
    v_mfma_f32_16x16x32_bf16 v[152:155], v[184:187], v[88:91], v[152:155]
    v_max_f32_e64 v250, v200, v204
    v_cmp_nle_f32_e64 s[42:43], v250, s40
    s_add_u32 m0, s37, 0xc000
    s_xor_b32 s38, s36, 0x6000
    buffer_load_dwordx4 v245, s[16:19], s38 offen offset:0 nt lds
    s_waitcnt lgkmcnt(3)
    v_mfma_f32_16x16x32_bf16 v[152:155], v[188:191], v[92:95], v[152:155]
    ds_read_b128 v[180:183], v227 offset:28672
    v_mfma_f32_16x16x32_bf16 v[144:147], v[188:191], v[76:79], v[144:147]
    s_cmp_lg_u64 s[42:43], 0
    s_cbranch_scc1 L_stublead1
L_retlead1:
    s_waitcnt lgkmcnt(3)
    v_mfma_f32_16x16x32_bf16 v[148:151], v[192:195], v[64:67], 0
    ds_read_b64_tr_b16 v[184:185], v228 offset:16384
    v_mfma_f32_16x16x32_bf16 v[156:159], v[192:195], v[80:83], 0
    ds_read_b64_tr_b16 v[186:187], v228 offset:20480
    s_add_u32 m0, s37, 0x18000
    s_xor_b32 s38, s36, 0x4000
    buffer_load_dwordx4 v246, s[20:23], s38 offen offset:0 nt lds
    s_waitcnt lgkmcnt(4)
    v_mfma_f32_16x16x32_bf16 v[156:159], v[196:199], v[84:87], v[156:159]
    ds_read_b64_tr_b16 v[188:189], v229 offset:16384
    v_mfma_f32_16x16x32_bf16 v[148:151], v[196:199], v[68:71], v[148:151]
    ds_read_b64_tr_b16 v[190:191], v229 offset:20480
    s_waitcnt lgkmcnt(5)
    v_mfma_f32_16x16x32_bf16 v[148:151], v[176:179], v[72:75], v[148:151]
    ds_read_b64_tr_b16 v[192:193], v230 offset:16384
    v_mfma_f32_16x16x32_bf16 v[156:159], v[176:179], v[88:91], v[156:159]
    ds_read_b64_tr_b16 v[194:195], v230 offset:20480
    s_waitcnt lgkmcnt(6)
    v_mfma_f32_16x16x32_bf16 v[156:159], v[180:183], v[92:95], v[156:159]
    ds_read_b64_tr_b16 v[176:177], v231 offset:16384
    v_mfma_f32_16x16x32_bf16 v[148:151], v[180:183], v[76:79], v[148:151]
    ds_read_b64_tr_b16 v[178:179], v231 offset:20480
    s_waitcnt lgkmcnt(6)
    v_mfma_f32_16x16x32_bf16 v[0:3], v[184:187], v[160:163], v[0:3]
    ds_read_b64_tr_b16 v[180:181], v232 offset:16384
    v_mfma_f32_16x16x32_bf16 v[32:35], v[184:187], v[164:167], v[32:35]
    ds_read_b64_tr_b16 v[182:183], v232 offset:20480
    s_waitcnt lgkmcnt(6)
    v_mfma_f32_16x16x32_bf16 v[36:39], v[188:191], v[164:167], v[36:39]
    ds_read_b64_tr_b16 v[184:185], v233 offset:16384
    v_mfma_f32_16x16x32_bf16 v[4:7], v[188:191], v[160:163], v[4:7]
    ds_read_b64_tr_b16 v[186:187], v233 offset:20480
    s_waitcnt lgkmcnt(6)
    v_mfma_f32_16x16x32_bf16 v[8:11], v[192:195], v[160:163], v[8:11]
    ds_read_b64_tr_b16 v[196:197], v234 offset:16384
    v_mfma_f32_16x16x32_bf16 v[40:43], v[192:195], v[164:167], v[40:43]
    ds_read_b64_tr_b16 v[198:199], v234 offset:20480
    s_waitcnt lgkmcnt(6)
    v_mfma_f32_16x16x32_bf16 v[44:47], v[176:179], v[164:167], v[44:47]
    ds_read_b64_tr_b16 v[192:193], v235 offset:16384
    v_mfma_f32_16x16x32_bf16 v[12:15], v[176:179], v[160:163], v[12:15]
    ds_read_b64_tr_b16 v[194:195], v235 offset:20480
    s_waitcnt lgkmcnt(6)
    v_mfma_f32_16x16x32_bf16 v[16:19], v[180:183], v[160:163], v[16:19]
    v_mfma_f32_16x16x32_bf16 v[48:51], v[180:183], v[164:167], v[48:51]
    s_waitcnt lgkmcnt(4)
    v_mfma_f32_16x16x32_bf16 v[52:55], v[184:187], v[164:167], v[52:55]
    v_mfma_f32_16x16x32_bf16 v[20:23], v[184:187], v[160:163], v[20:23]
    s_waitcnt lgkmcnt(2)
    v_mfma_f32_16x16x32_bf16 v[24:27], v[196:199], v[160:163], v[24:27]
    ds_read_b128 v[176:179], v224 offset:32768
    v_mfma_f32_16x16x32_bf16 v[56:59], v[196:199], v[164:167], v[56:59]
    ds_read_b128 v[180:183], v225 offset:32768
    s_waitcnt lgkmcnt(2)
    v_mfma_f32_16x16x32_bf16 v[60:63], v[192:195], v[164:167], v[60:63]
    ds_read_b128 v[184:187], v226 offset:32768
    v_mfma_f32_16x16x32_bf16 v[28:31], v[192:195], v[160:163], v[28:31]
    ds_read_b128 v[188:191], v227 offset:32768
    s_setprio 0
.p2align 3
    v_fmamk_f32 v168, v144, 0x3e0293ee, v248
    v_fmamk_f32 v169, v145, 0x3e0293ee, v248
    v_fmamk_f32 v170, v146, 0x3e0293ee, v248
    v_fmamk_f32 v171, v147, 0x3e0293ee, v248
    v_exp_f32 v168, v168
    v_exp_f32 v169, v169
    v_exp_f32 v170, v170
    v_exp_f32 v171, v171
    v_fmamk_f32 v172, v152, 0x3e0293ee, v249
    v_fmamk_f32 v173, v153, 0x3e0293ee, v249
    v_fmamk_f32 v174, v154, 0x3e0293ee, v249
    v_fmamk_f32 v175, v155, 0x3e0293ee, v249
    v_cvt_pk_bf16_f32 v160, v168, v169
    v_cvt_pk_bf16_f32 v161, v170, v171
    v_exp_f32 v172, v172
    v_exp_f32 v173, v173
    v_exp_f32 v174, v174
    v_exp_f32 v175, v175
    v_fmamk_f32 v168, v148, 0x3e0293ee, v248
    v_fmamk_f32 v169, v149, 0x3e0293ee, v248
    v_fmamk_f32 v170, v150, 0x3e0293ee, v248
    v_fmamk_f32 v171, v151, 0x3e0293ee, v248
    s_setprio 1
    s_nop 0
    v_cvt_pk_bf16_f32 v164, v172, v173
    v_cvt_pk_bf16_f32 v165, v174, v175
    v_exp_f32 v168, v168
    v_exp_f32 v169, v169
    v_exp_f32 v170, v170
    v_exp_f32 v171, v171
    v_fmamk_f32 v172, v156, 0x3e0293ee, v249
    v_fmamk_f32 v173, v157, 0x3e0293ee, v249
    v_fmamk_f32 v174, v158, 0x3e0293ee, v249
    v_fmamk_f32 v175, v159, 0x3e0293ee, v249
    v_cvt_pk_bf16_f32 v162, v168, v169
    v_cvt_pk_bf16_f32 v163, v170, v171
    v_exp_f32 v172, v172
    v_exp_f32 v173, v173
    v_exp_f32 v174, v174
    v_exp_f32 v175, v175
    v_cvt_pk_bf16_f32 v166, v172, v173
    v_cvt_pk_bf16_f32 v167, v174, v175
    s_waitcnt vmcnt(2)
    s_barrier
    s_waitcnt vmcnt(0)
    v_mfma_f32_16x16x32_bf16 v[208:211], v[216:219], v[160:163], v[200:203]
    v_mfma_f32_16x16x32_bf16 v[212:215], v[216:219], v[164:167], v[204:207]
    s_waitcnt lgkmcnt(3)
    v_mfma_f32_16x16x32_bf16 v[128:131], v[176:179], v[64:67], 0
    s_setprio 3
    ds_read_b128 v[192:195], v224 offset:36864
    v_mfma_f32_16x16x32_bf16 v[136:139], v[176:179], v[80:83], 0
    s_add_u32 m0, s58, 0x800
    s_nop 0
    buffer_load_dwordx4 v242, s[12:15], s30 offen offset:0 nt lds
    s_add_u32 m0, s58, 0xc00
    s_nop 0
    buffer_load_dwordx4 v243, s[12:15], s30 offen offset:0 nt lds
    s_waitcnt lgkmcnt(3)
    v_mfma_f32_16x16x32_bf16 v[136:139], v[180:183], v[84:87], v[136:139]
    ds_read_b128 v[196:199], v225 offset:36864
    v_mfma_f32_16x16x32_bf16 v[128:131], v[180:183], v[68:71], v[128:131]
    s_waitcnt lgkmcnt(3)
    v_mfma_f32_16x16x32_bf16 v[128:131], v[184:187], v[72:75], v[128:131]
    ds_read_b128 v[176:179], v226 offset:36864
    v_mfma_f32_16x16x32_bf16 v[136:139], v[184:187], v[88:91], v[136:139]
    v_max_f32_e64 v250, v208, v212
    v_cmp_nle_f32_e64 s[42:43], v250, s40
    s_add_u32 m0, s37, 0xe000
    s_xor_b32 s38, s36, 0x7000
    buffer_load_dwordx4 v245, s[16:19], s38 offen offset:0 nt lds
    s_waitcnt lgkmcnt(3)
    v_mfma_f32_16x16x32_bf16 v[136:139], v[188:191], v[92:95], v[136:139]
    ds_read_b128 v[180:183], v227 offset:36864
    v_mfma_f32_16x16x32_bf16 v[128:131], v[188:191], v[76:79], v[128:131]
    s_cmp_lg_u64 s[42:43], 0
    s_cbranch_scc1 L_stublead2
L_retlead2:
    s_waitcnt lgkmcnt(3)
    v_mfma_f32_16x16x32_bf16 v[132:135], v[192:195], v[64:67], 0
    ds_read_b64_tr_b16 v[184:185], v228 offset:24576
    v_mfma_f32_16x16x32_bf16 v[140:143], v[192:195], v[80:83], 0
    ds_read_b64_tr_b16 v[186:187], v228 offset:28672
    s_add_u32 m0, s37, 0x1a000
    s_xor_b32 s38, s36, 0x5000
    buffer_load_dwordx4 v246, s[20:23], s38 offen offset:0 nt lds
    s_waitcnt lgkmcnt(4)
    v_mfma_f32_16x16x32_bf16 v[140:143], v[196:199], v[84:87], v[140:143]
    ds_read_b64_tr_b16 v[188:189], v229 offset:24576
    v_mfma_f32_16x16x32_bf16 v[132:135], v[196:199], v[68:71], v[132:135]
    ds_read_b64_tr_b16 v[190:191], v229 offset:28672
    s_waitcnt lgkmcnt(5)
    v_mfma_f32_16x16x32_bf16 v[132:135], v[176:179], v[72:75], v[132:135]
    ds_read_b64_tr_b16 v[192:193], v230 offset:24576
    v_mfma_f32_16x16x32_bf16 v[140:143], v[176:179], v[88:91], v[140:143]
    ds_read_b64_tr_b16 v[194:195], v230 offset:28672
    s_waitcnt lgkmcnt(6)
    v_mfma_f32_16x16x32_bf16 v[140:143], v[180:183], v[92:95], v[140:143]
    ds_read_b64_tr_b16 v[176:177], v231 offset:24576
    v_mfma_f32_16x16x32_bf16 v[132:135], v[180:183], v[76:79], v[132:135]
    ds_read_b64_tr_b16 v[178:179], v231 offset:28672
    s_waitcnt lgkmcnt(6)
    v_mfma_f32_16x16x32_bf16 v[0:3], v[184:187], v[160:163], v[0:3]
    ds_read_b64_tr_b16 v[180:181], v232 offset:24576
    v_mfma_f32_16x16x32_bf16 v[32:35], v[184:187], v[164:167], v[32:35]
    ds_read_b64_tr_b16 v[182:183], v232 offset:28672
    s_waitcnt lgkmcnt(6)
    v_mfma_f32_16x16x32_bf16 v[36:39], v[188:191], v[164:167], v[36:39]
    ds_read_b64_tr_b16 v[184:185], v233 offset:24576
    v_mfma_f32_16x16x32_bf16 v[4:7], v[188:191], v[160:163], v[4:7]
    ds_read_b64_tr_b16 v[186:187], v233 offset:28672
    s_waitcnt lgkmcnt(6)
    v_mfma_f32_16x16x32_bf16 v[8:11], v[192:195], v[160:163], v[8:11]
    ds_read_b64_tr_b16 v[196:197], v234 offset:24576
    v_mfma_f32_16x16x32_bf16 v[40:43], v[192:195], v[164:167], v[40:43]
    ds_read_b64_tr_b16 v[198:199], v234 offset:28672
    s_waitcnt lgkmcnt(6)
    v_mfma_f32_16x16x32_bf16 v[44:47], v[176:179], v[164:167], v[44:47]
    ds_read_b64_tr_b16 v[192:193], v235 offset:24576
    v_mfma_f32_16x16x32_bf16 v[12:15], v[176:179], v[160:163], v[12:15]
    ds_read_b64_tr_b16 v[194:195], v235 offset:28672
    s_waitcnt lgkmcnt(6)
    v_mfma_f32_16x16x32_bf16 v[16:19], v[180:183], v[160:163], v[16:19]
    v_mfma_f32_16x16x32_bf16 v[48:51], v[180:183], v[164:167], v[48:51]
    s_waitcnt lgkmcnt(4)
    v_mfma_f32_16x16x32_bf16 v[52:55], v[184:187], v[164:167], v[52:55]
    v_mfma_f32_16x16x32_bf16 v[20:23], v[184:187], v[160:163], v[20:23]
    s_waitcnt lgkmcnt(2)
    v_mfma_f32_16x16x32_bf16 v[24:27], v[196:199], v[160:163], v[24:27]
    ds_read_b128 v[176:179], v224 offset:40960
    v_mfma_f32_16x16x32_bf16 v[56:59], v[196:199], v[164:167], v[56:59]
    ds_read_b128 v[180:183], v225 offset:40960
    s_waitcnt lgkmcnt(2)
    v_mfma_f32_16x16x32_bf16 v[60:63], v[192:195], v[164:167], v[60:63]
    ds_read_b128 v[184:187], v226 offset:40960
    v_mfma_f32_16x16x32_bf16 v[28:31], v[192:195], v[160:163], v[28:31]
    ds_read_b128 v[188:191], v227 offset:40960
    s_setprio 0
.p2align 3
    v_fmamk_f32 v168, v128, 0x3e0293ee, v248
    v_fmamk_f32 v169, v129, 0x3e0293ee, v248
    v_fmamk_f32 v170, v130, 0x3e0293ee, v248
    v_fmamk_f32 v171, v131, 0x3e0293ee, v248
    v_exp_f32 v168, v168
    v_exp_f32 v169, v169
    v_exp_f32 v170, v170
    v_exp_f32 v171, v171
    v_fmamk_f32 v172, v136, 0x3e0293ee, v249
    v_fmamk_f32 v173, v137, 0x3e0293ee, v249
    v_fmamk_f32 v174, v138, 0x3e0293ee, v249
    v_fmamk_f32 v175, v139, 0x3e0293ee, v249
    v_cvt_pk_bf16_f32 v160, v168, v169
    v_cvt_pk_bf16_f32 v161, v170, v171
    v_exp_f32 v172, v172
    v_exp_f32 v173, v173
    v_exp_f32 v174, v174
    v_exp_f32 v175, v175
    v_fmamk_f32 v168, v132, 0x3e0293ee, v248
    v_fmamk_f32 v169, v133, 0x3e0293ee, v248
    v_fmamk_f32 v170, v134, 0x3e0293ee, v248
    v_fmamk_f32 v171, v135, 0x3e0293ee, v248
    s_setprio 1
    s_nop 0
    v_cvt_pk_bf16_f32 v164, v172, v173
    v_cvt_pk_bf16_f32 v165, v174, v175
    v_exp_f32 v168, v168
    v_exp_f32 v169, v169
    v_exp_f32 v170, v170
    v_exp_f32 v171, v171
    v_fmamk_f32 v172, v140, 0x3e0293ee, v249
    v_fmamk_f32 v173, v141, 0x3e0293ee, v249
    v_fmamk_f32 v174, v142, 0x3e0293ee, v249
    v_fmamk_f32 v175, v143, 0x3e0293ee, v249
    v_cvt_pk_bf16_f32 v162, v168, v169
    v_cvt_pk_bf16_f32 v163, v170, v171
    s_waitcnt vmcnt(2)
    s_nop 0
    ds_read_b128 v[96:99], v236 offset:0
    ds_read_b128 v[100:103], v237 offset:0
    ds_read_b128 v[104:107], v238 offset:0
    ds_read_b128 v[108:111], v239 offset:0
    v_exp_f32 v172, v172
    v_exp_f32 v173, v173
    v_exp_f32 v174, v174
    v_exp_f32 v175, v175
    v_cvt_pk_bf16_f32 v166, v172, v173
    v_cvt_pk_bf16_f32 v167, v174, v175
    s_waitcnt vmcnt(4)
    s_barrier
    s_waitcnt vmcnt(0)
    v_mfma_f32_16x16x32_bf16 v[200:203], v[216:219], v[160:163], v[208:211]
    v_mfma_f32_16x16x32_bf16 v[204:207], v[216:219], v[164:167], v[212:215]
    s_waitcnt lgkmcnt(7)
    v_mfma_f32_16x16x32_bf16 v[144:147], v[176:179], v[64:67], 0
    s_setprio 3
    ds_read_b128 v[192:195], v224 offset:45056
    v_mfma_f32_16x16x32_bf16 v[152:155], v[176:179], v[80:83], 0
    s_waitcnt lgkmcnt(7)
    v_mfma_f32_16x16x32_bf16 v[152:155], v[180:183], v[84:87], v[152:155]
    ds_read_b128 v[196:199], v225 offset:45056
    v_mfma_f32_16x16x32_bf16 v[144:147], v[180:183], v[68:71], v[144:147]
    s_waitcnt lgkmcnt(7)
    v_mfma_f32_16x16x32_bf16 v[144:147], v[184:187], v[72:75], v[144:147]
    ds_read_b128 v[176:179], v226 offset:45056
    v_mfma_f32_16x16x32_bf16 v[152:155], v[184:187], v[88:91], v[152:155]
    v_max_f32_e64 v250, v200, v204
    v_cmp_nle_f32_e64 s[42:43], v250, s40
    s_waitcnt lgkmcnt(3)
    s_add_u32 m0, s58, 0x0
    s_nop 0
    buffer_load_dwordx4 v240, s[12:15], s31 offen offset:0 nt lds
    v_mfma_f32_16x16x32_bf16 v[152:155], v[188:191], v[92:95], v[152:155]
    ds_read_b128 v[180:183], v227 offset:45056
    v_mfma_f32_16x16x32_bf16 v[144:147], v[188:191], v[76:79], v[144:147]
    s_cmp_lg_u64 s[42:43], 0
    s_cbranch_scc1 L_stublead3
L_retlead3:
    s_waitcnt lgkmcnt(3)
    v_mfma_f32_16x16x32_bf16 v[148:151], v[192:195], v[64:67], 0
    ds_read_b64_tr_b16 v[184:185], v228 offset:32768
    v_mfma_f32_16x16x32_bf16 v[156:159], v[192:195], v[80:83], 0
    ds_read_b64_tr_b16 v[186:187], v228 offset:36864
    s_add_u32 m0, s37, 0x1c000
    s_xor_b32 s38, s36, 0x6000
    buffer_load_dwordx4 v246, s[20:23], s38 offen offset:0 nt lds
    s_waitcnt lgkmcnt(4)
    v_mfma_f32_16x16x32_bf16 v[156:159], v[196:199], v[84:87], v[156:159]
    ds_read_b64_tr_b16 v[188:189], v229 offset:32768
    v_mfma_f32_16x16x32_bf16 v[148:151], v[196:199], v[68:71], v[148:151]
    ds_read_b64_tr_b16 v[190:191], v229 offset:36864
    s_waitcnt lgkmcnt(5)
    v_mfma_f32_16x16x32_bf16 v[148:151], v[176:179], v[72:75], v[148:151]
    ds_read_b64_tr_b16 v[192:193], v230 offset:32768
    v_mfma_f32_16x16x32_bf16 v[156:159], v[176:179], v[88:91], v[156:159]
    ds_read_b64_tr_b16 v[194:195], v230 offset:36864
    s_waitcnt lgkmcnt(6)
    v_mfma_f32_16x16x32_bf16 v[156:159], v[180:183], v[92:95], v[156:159]
    ds_read_b64_tr_b16 v[176:177], v231 offset:32768
    v_mfma_f32_16x16x32_bf16 v[148:151], v[180:183], v[76:79], v[148:151]
    ds_read_b64_tr_b16 v[178:179], v231 offset:36864
    s_waitcnt lgkmcnt(6)
    v_mfma_f32_16x16x32_bf16 v[0:3], v[184:187], v[160:163], v[0:3]
    ds_read_b64_tr_b16 v[180:181], v232 offset:32768
    v_mfma_f32_16x16x32_bf16 v[32:35], v[184:187], v[164:167], v[32:35]
    ds_read_b64_tr_b16 v[182:183], v232 offset:36864
    s_waitcnt lgkmcnt(6)
    v_mfma_f32_16x16x32_bf16 v[36:39], v[188:191], v[164:167], v[36:39]
    ds_read_b64_tr_b16 v[184:185], v233 offset:32768
    v_mfma_f32_16x16x32_bf16 v[4:7], v[188:191], v[160:163], v[4:7]
    ds_read_b64_tr_b16 v[186:187], v233 offset:36864
    s_waitcnt lgkmcnt(6)
    v_mfma_f32_16x16x32_bf16 v[8:11], v[192:195], v[160:163], v[8:11]
    ds_read_b64_tr_b16 v[196:197], v234 offset:32768
    v_mfma_f32_16x16x32_bf16 v[40:43], v[192:195], v[164:167], v[40:43]
    ds_read_b64_tr_b16 v[198:199], v234 offset:36864
    s_waitcnt lgkmcnt(6)
    v_mfma_f32_16x16x32_bf16 v[44:47], v[176:179], v[164:167], v[44:47]
    ds_read_b64_tr_b16 v[192:193], v235 offset:32768
    v_mfma_f32_16x16x32_bf16 v[12:15], v[176:179], v[160:163], v[12:15]
    ds_read_b64_tr_b16 v[194:195], v235 offset:36864
    s_waitcnt lgkmcnt(6)
    v_mfma_f32_16x16x32_bf16 v[16:19], v[180:183], v[160:163], v[16:19]
    v_mfma_f32_16x16x32_bf16 v[48:51], v[180:183], v[164:167], v[48:51]
    s_waitcnt lgkmcnt(4)
    v_mfma_f32_16x16x32_bf16 v[52:55], v[184:187], v[164:167], v[52:55]
    v_mfma_f32_16x16x32_bf16 v[20:23], v[184:187], v[160:163], v[20:23]
    s_waitcnt lgkmcnt(2)
    v_mfma_f32_16x16x32_bf16 v[24:27], v[196:199], v[160:163], v[24:27]
    ds_read_b128 v[176:179], v224 offset:49152
    v_mfma_f32_16x16x32_bf16 v[56:59], v[196:199], v[164:167], v[56:59]
    ds_read_b128 v[180:183], v225 offset:49152
    s_waitcnt lgkmcnt(2)
    v_mfma_f32_16x16x32_bf16 v[60:63], v[192:195], v[164:167], v[60:63]
    ds_read_b128 v[184:187], v226 offset:49152
    v_mfma_f32_16x16x32_bf16 v[28:31], v[192:195], v[160:163], v[28:31]
    ds_read_b128 v[188:191], v227 offset:49152
    s_setprio 0
.p2align 3
    v_fmamk_f32 v168, v144, 0x3e0293ee, v248
    v_fmamk_f32 v169, v145, 0x3e0293ee, v248
    v_fmamk_f32 v170, v146, 0x3e0293ee, v248
    v_fmamk_f32 v171, v147, 0x3e0293ee, v248
    v_exp_f32 v168, v168
    v_exp_f32 v169, v169
    v_exp_f32 v170, v170
    v_exp_f32 v171, v171
    v_fmamk_f32 v172, v152, 0x3e0293ee, v249
    v_fmamk_f32 v173, v153, 0x3e0293ee, v249
    v_fmamk_f32 v174, v154, 0x3e0293ee, v249
    v_fmamk_f32 v175, v155, 0x3e0293ee, v249
    v_cvt_pk_bf16_f32 v160, v168, v169
    v_cvt_pk_bf16_f32 v161, v170, v171
    v_exp_f32 v172, v172
    v_exp_f32 v173, v173
    v_exp_f32 v174, v174
    v_exp_f32 v175, v175
    v_fmamk_f32 v168, v148, 0x3e0293ee, v248
    v_fmamk_f32 v169, v149, 0x3e0293ee, v248
    v_fmamk_f32 v170, v150, 0x3e0293ee, v248
    v_fmamk_f32 v171, v151, 0x3e0293ee, v248
    s_setprio 1
    s_nop 0
    v_cvt_pk_bf16_f32 v164, v172, v173
    v_cvt_pk_bf16_f32 v165, v174, v175
    v_exp_f32 v168, v168
    v_exp_f32 v169, v169
    v_exp_f32 v170, v170
    v_exp_f32 v171, v171
    v_fmamk_f32 v172, v156, 0x3e0293ee, v249
    v_fmamk_f32 v173, v157, 0x3e0293ee, v249
    v_fmamk_f32 v174, v158, 0x3e0293ee, v249
    v_fmamk_f32 v175, v159, 0x3e0293ee, v249
    v_cvt_pk_bf16_f32 v162, v168, v169
    v_cvt_pk_bf16_f32 v163, v170, v171
    v_exp_f32 v172, v172
    v_exp_f32 v173, v173
    v_exp_f32 v174, v174
    v_exp_f32 v175, v175
    v_cvt_pk_bf16_f32 v166, v172, v173
    v_cvt_pk_bf16_f32 v167, v174, v175
    s_waitcnt vmcnt(2)
    s_barrier
    s_waitcnt vmcnt(0)
    v_mfma_f32_16x16x32_bf16 v[208:211], v[216:219], v[160:163], v[200:203]
    v_mfma_f32_16x16x32_bf16 v[212:215], v[216:219], v[164:167], v[204:207]
    s_waitcnt lgkmcnt(3)
    v_mfma_f32_16x16x32_bf16 v[128:131], v[176:179], v[64:67], 0
    s_setprio 3
    ds_read_b128 v[192:195], v224 offset:53248
    v_mfma_f32_16x16x32_bf16 v[136:139], v[176:179], v[80:83], 0
    s_add_u32 m0, s58, 0x400
    s_nop 0
    buffer_load_dwordx4 v241, s[12:15], s31 offen offset:0 nt lds
    s_waitcnt lgkmcnt(3)
    v_mfma_f32_16x16x32_bf16 v[136:139], v[180:183], v[84:87], v[136:139]
    ds_read_b128 v[196:199], v225 offset:53248
    v_mfma_f32_16x16x32_bf16 v[128:131], v[180:183], v[68:71], v[128:131]
    s_waitcnt lgkmcnt(3)
    v_mfma_f32_16x16x32_bf16 v[128:131], v[184:187], v[72:75], v[128:131]
    ds_read_b128 v[176:179], v226 offset:53248
    v_mfma_f32_16x16x32_bf16 v[136:139], v[184:187], v[88:91], v[136:139]
    v_max_f32_e64 v250, v208, v212
    v_cmp_nle_f32_e64 s[42:43], v250, s40
    s_add_u32 m0, s58, 0x800
    s_nop 0
    buffer_load_dwordx4 v242, s[12:15], s31 offen offset:0 nt lds
    s_waitcnt lgkmcnt(3)
    v_mfma_f32_16x16x32_bf16 v[136:139], v[188:191], v[92:95], v[136:139]
    ds_read_b128 v[180:183], v227 offset:53248
    v_mfma_f32_16x16x32_bf16 v[128:131], v[188:191], v[76:79], v[128:131]
    s_cmp_lg_u64 s[42:43], 0
    s_cbranch_scc1 L_stublead4
L_retlead4:
    s_waitcnt lgkmcnt(3)
    v_mfma_f32_16x16x32_bf16 v[132:135], v[192:195], v[64:67], 0
    ds_read_b64_tr_b16 v[184:185], v228 offset:40960
    v_mfma_f32_16x16x32_bf16 v[140:143], v[192:195], v[80:83], 0
    ds_read_b64_tr_b16 v[186:187], v228 offset:45056
    s_add_u32 m0, s37, 0x1e000
    s_xor_b32 s38, s36, 0x7000
    buffer_load_dwordx4 v246, s[20:23], s38 offen offset:0 nt lds
    s_waitcnt lgkmcnt(4)
    v_mfma_f32_16x16x32_bf16 v[140:143], v[196:199], v[84:87], v[140:143]
    ds_read_b64_tr_b16 v[188:189], v229 offset:40960
    v_mfma_f32_16x16x32_bf16 v[132:135], v[196:199], v[68:71], v[132:135]
    ds_read_b64_tr_b16 v[190:191], v229 offset:45056
    s_waitcnt lgkmcnt(5)
    v_mfma_f32_16x16x32_bf16 v[132:135], v[176:179], v[72:75], v[132:135]
    ds_read_b64_tr_b16 v[192:193], v230 offset:40960
    v_mfma_f32_16x16x32_bf16 v[140:143], v[176:179], v[88:91], v[140:143]
    ds_read_b64_tr_b16 v[194:195], v230 offset:45056
    s_waitcnt lgkmcnt(6)
    v_mfma_f32_16x16x32_bf16 v[140:143], v[180:183], v[92:95], v[140:143]
    ds_read_b64_tr_b16 v[176:177], v231 offset:40960
    v_mfma_f32_16x16x32_bf16 v[132:135], v[180:183], v[76:79], v[132:135]
    ds_read_b64_tr_b16 v[178:179], v231 offset:45056
    s_waitcnt lgkmcnt(6)
    v_mfma_f32_16x16x32_bf16 v[0:3], v[184:187], v[160:163], v[0:3]
    ds_read_b64_tr_b16 v[180:181], v232 offset:40960
    v_mfma_f32_16x16x32_bf16 v[32:35], v[184:187], v[164:167], v[32:35]
    ds_read_b64_tr_b16 v[182:183], v232 offset:45056
    s_waitcnt lgkmcnt(6)
    v_mfma_f32_16x16x32_bf16 v[36:39], v[188:191], v[164:167], v[36:39]
    ds_read_b64_tr_b16 v[184:185], v233 offset:40960
    v_mfma_f32_16x16x32_bf16 v[4:7], v[188:191], v[160:163], v[4:7]
    ds_read_b64_tr_b16 v[186:187], v233 offset:45056
    s_waitcnt lgkmcnt(6)
    v_mfma_f32_16x16x32_bf16 v[8:11], v[192:195], v[160:163], v[8:11]
    ds_read_b64_tr_b16 v[196:197], v234 offset:40960
    v_mfma_f32_16x16x32_bf16 v[40:43], v[192:195], v[164:167], v[40:43]
    ds_read_b64_tr_b16 v[198:199], v234 offset:45056
    s_waitcnt lgkmcnt(6)
    v_mfma_f32_16x16x32_bf16 v[44:47], v[176:179], v[164:167], v[44:47]
    ds_read_b64_tr_b16 v[192:193], v235 offset:40960
    v_mfma_f32_16x16x32_bf16 v[12:15], v[176:179], v[160:163], v[12:15]
    ds_read_b64_tr_b16 v[194:195], v235 offset:45056
    s_waitcnt lgkmcnt(6)
    v_mfma_f32_16x16x32_bf16 v[16:19], v[180:183], v[160:163], v[16:19]
    v_mfma_f32_16x16x32_bf16 v[48:51], v[180:183], v[164:167], v[48:51]
    s_waitcnt lgkmcnt(4)
    v_mfma_f32_16x16x32_bf16 v[52:55], v[184:187], v[164:167], v[52:55]
    v_mfma_f32_16x16x32_bf16 v[20:23], v[184:187], v[160:163], v[20:23]
    s_waitcnt lgkmcnt(2)
    v_mfma_f32_16x16x32_bf16 v[24:27], v[196:199], v[160:163], v[24:27]
    ds_read_b128 v[176:179], v224 offset:57344
    v_mfma_f32_16x16x32_bf16 v[56:59], v[196:199], v[164:167], v[56:59]
    ds_read_b128 v[180:183], v225 offset:57344
    s_waitcnt lgkmcnt(2)
    v_mfma_f32_16x16x32_bf16 v[60:63], v[192:195], v[164:167], v[60:63]
    ds_read_b128 v[184:187], v226 offset:57344
    v_mfma_f32_16x16x32_bf16 v[28:31], v[192:195], v[160:163], v[28:31]
    ds_read_b128 v[188:191], v227 offset:57344
    s_setprio 0
.p2align 3
    v_fmamk_f32 v168, v128, 0x3e0293ee, v248
    v_fmamk_f32 v169, v129, 0x3e0293ee, v248
    v_fmamk_f32 v170, v130, 0x3e0293ee, v248
    v_fmamk_f32 v171, v131, 0x3e0293ee, v248
    v_exp_f32 v168, v168
    v_exp_f32 v169, v169
    v_exp_f32 v170, v170
    v_exp_f32 v171, v171
    v_fmamk_f32 v172, v136, 0x3e0293ee, v249
    v_fmamk_f32 v173, v137, 0x3e0293ee, v249
    v_fmamk_f32 v174, v138, 0x3e0293ee, v249
    v_fmamk_f32 v175, v139, 0x3e0293ee, v249
    v_cvt_pk_bf16_f32 v160, v168, v169
    v_cvt_pk_bf16_f32 v161, v170, v171
    v_exp_f32 v172, v172
    v_exp_f32 v173, v173
    v_exp_f32 v174, v174
    v_exp_f32 v175, v175
    v_fmamk_f32 v168, v132, 0x3e0293ee, v248
    v_fmamk_f32 v169, v133, 0x3e0293ee, v248
    v_fmamk_f32 v170, v134, 0x3e0293ee, v248
    v_fmamk_f32 v171, v135, 0x3e0293ee, v248
    s_setprio 1
    s_nop 0
    v_cvt_pk_bf16_f32 v164, v172, v173
    v_cvt_pk_bf16_f32 v165, v174, v175
    v_exp_f32 v168, v168
    v_exp_f32 v169, v169
    v_exp_f32 v170, v170
    v_exp_f32 v171, v171
    v_fmamk_f32 v172, v140, 0x3e0293ee, v249
    v_fmamk_f32 v173, v141, 0x3e0293ee, v249
    v_fmamk_f32 v174, v142, 0x3e0293ee, v249
    v_fmamk_f32 v175, v143, 0x3e0293ee, v249
    v_cvt_pk_bf16_f32 v162, v168, v169
    v_cvt_pk_bf16_f32 v163, v170, v171
    v_exp_f32 v172, v172
    v_exp_f32 v173, v173
    v_exp_f32 v174, v174
    v_exp_f32 v175, v175
    v_cvt_pk_bf16_f32 v166, v172, v173
    v_cvt_pk_bf16_f32 v167, v174, v175
    s_waitcnt vmcnt(3)
    s_barrier
    s_waitcnt vmcnt(0)
    v_mfma_f32_16x16x32_bf16 v[200:203], v[216:219], v[160:163], v[208:211]
    v_mfma_f32_16x16x32_bf16 v[204:207], v[216:219], v[164:167], v[212:215]
    s_waitcnt lgkmcnt(3)
    v_mfma_f32_16x16x32_bf16 v[144:147], v[176:179], v[64:67], 0
    s_setprio 3
    ds_read_b128 v[192:195], v224 offset:61440
    v_mfma_f32_16x16x32_bf16 v[152:155], v[176:179], v[80:83], 0
    s_waitcnt lgkmcnt(3)
    v_mfma_f32_16x16x32_bf16 v[152:155], v[180:183], v[84:87], v[152:155]
    ds_read_b128 v[196:199], v225 offset:61440
    v_mfma_f32_16x16x32_bf16 v[144:147], v[180:183], v[68:71], v[144:147]
    s_waitcnt lgkmcnt(3)
    v_mfma_f32_16x16x32_bf16 v[144:147], v[184:187], v[72:75], v[144:147]
    ds_read_b128 v[176:179], v226 offset:61440
    v_mfma_f32_16x16x32_bf16 v[152:155], v[184:187], v[88:91], v[152:155]
    v_max_f32_e64 v250, v200, v204
    v_cmp_nle_f32_e64 s[42:43], v250, s40
    s_waitcnt lgkmcnt(3)
    v_mfma_f32_16x16x32_bf16 v[152:155], v[188:191], v[92:95], v[152:155]
    ds_read_b128 v[180:183], v227 offset:61440
    v_mfma_f32_16x16x32_bf16 v[144:147], v[188:191], v[76:79], v[144:147]
    s_cmp_lg_u64 s[42:43], 0
    s_cbranch_scc1 L_stublead5
L_retlead5:
    s_waitcnt lgkmcnt(3)
    v_mfma_f32_16x16x32_bf16 v[148:151], v[192:195], v[64:67], 0
    ds_read_b64_tr_b16 v[184:185], v228 offset:49152
    v_mfma_f32_16x16x32_bf16 v[156:159], v[192:195], v[80:83], 0
    ds_read_b64_tr_b16 v[186:187], v228 offset:53248
    s_add_u32 m0, s58, 0xc00
    s_nop 0
    buffer_load_dwordx4 v243, s[12:15], s31 offen offset:0 nt lds
    s_waitcnt lgkmcnt(4)
    v_mfma_f32_16x16x32_bf16 v[156:159], v[196:199], v[84:87], v[156:159]
    ds_read_b64_tr_b16 v[188:189], v229 offset:49152
    v_mfma_f32_16x16x32_bf16 v[148:151], v[196:199], v[68:71], v[148:151]
    ds_read_b64_tr_b16 v[190:191], v229 offset:53248
    s_waitcnt lgkmcnt(5)
    v_mfma_f32_16x16x32_bf16 v[148:151], v[176:179], v[72:75], v[148:151]
    ds_read_b64_tr_b16 v[192:193], v230 offset:49152
    v_mfma_f32_16x16x32_bf16 v[156:159], v[176:179], v[88:91], v[156:159]
    ds_read_b64_tr_b16 v[194:195], v230 offset:53248
    s_waitcnt lgkmcnt(6)
    v_mfma_f32_16x16x32_bf16 v[156:159], v[180:183], v[92:95], v[156:159]
    ds_read_b64_tr_b16 v[176:177], v231 offset:49152
    v_mfma_f32_16x16x32_bf16 v[148:151], v[180:183], v[76:79], v[148:151]
    ds_read_b64_tr_b16 v[178:179], v231 offset:53248
    s_waitcnt lgkmcnt(6)
    v_mfma_f32_16x16x32_bf16 v[0:3], v[184:187], v[160:163], v[0:3]
    ds_read_b64_tr_b16 v[180:181], v232 offset:49152
    v_mfma_f32_16x16x32_bf16 v[32:35], v[184:187], v[164:167], v[32:35]
    ds_read_b64_tr_b16 v[182:183], v232 offset:53248
    s_waitcnt lgkmcnt(6)
    v_mfma_f32_16x16x32_bf16 v[36:39], v[188:191], v[164:167], v[36:39]
    ds_read_b64_tr_b16 v[184:185], v233 offset:49152
    v_mfma_f32_16x16x32_bf16 v[4:7], v[188:191], v[160:163], v[4:7]
    ds_read_b64_tr_b16 v[186:187], v233 offset:53248
    s_waitcnt lgkmcnt(6)
    v_mfma_f32_16x16x32_bf16 v[8:11], v[192:195], v[160:163], v[8:11]
    ds_read_b64_tr_b16 v[196:197], v234 offset:49152
    v_mfma_f32_16x16x32_bf16 v[40:43], v[192:195], v[164:167], v[40:43]
    ds_read_b64_tr_b16 v[198:199], v234 offset:53248
    s_waitcnt lgkmcnt(6)
    v_mfma_f32_16x16x32_bf16 v[44:47], v[176:179], v[164:167], v[44:47]
    ds_read_b64_tr_b16 v[192:193], v235 offset:49152
    v_mfma_f32_16x16x32_bf16 v[12:15], v[176:179], v[160:163], v[12:15]
    ds_read_b64_tr_b16 v[194:195], v235 offset:53248
    s_waitcnt lgkmcnt(6)
    v_mfma_f32_16x16x32_bf16 v[16:19], v[180:183], v[160:163], v[16:19]
    v_mfma_f32_16x16x32_bf16 v[48:51], v[180:183], v[164:167], v[48:51]
    s_waitcnt lgkmcnt(4)
    v_mfma_f32_16x16x32_bf16 v[52:55], v[184:187], v[164:167], v[52:55]
    v_mfma_f32_16x16x32_bf16 v[20:23], v[184:187], v[160:163], v[20:23]
    s_waitcnt lgkmcnt(2)
    v_mfma_f32_16x16x32_bf16 v[24:27], v[196:199], v[160:163], v[24:27]
    ds_read_b128 v[176:179], v224 offset:0
    v_mfma_f32_16x16x32_bf16 v[56:59], v[196:199], v[164:167], v[56:59]
    ds_read_b128 v[180:183], v225 offset:0
    s_waitcnt lgkmcnt(2)
    v_mfma_f32_16x16x32_bf16 v[60:63], v[192:195], v[164:167], v[60:63]
    ds_read_b128 v[184:187], v226 offset:0
    v_mfma_f32_16x16x32_bf16 v[28:31], v[192:195], v[160:163], v[28:31]
    ds_read_b128 v[188:191], v227 offset:0
    s_setprio 0
.p2align 3
    v_fmamk_f32 v168, v144, 0x3e0293ee, v248
    v_fmamk_f32 v169, v145, 0x3e0293ee, v248
    v_fmamk_f32 v170, v146, 0x3e0293ee, v248
    v_fmamk_f32 v171, v147, 0x3e0293ee, v248
    v_exp_f32 v168, v168
    v_exp_f32 v169, v169
    v_exp_f32 v170, v170
    v_exp_f32 v171, v171
    v_fmamk_f32 v172, v152, 0x3e0293ee, v249
    v_fmamk_f32 v173, v153, 0x3e0293ee, v249
    v_fmamk_f32 v174, v154, 0x3e0293ee, v249
    v_fmamk_f32 v175, v155, 0x3e0293ee, v249
    v_cvt_pk_bf16_f32 v160, v168, v169
    v_cvt_pk_bf16_f32 v161, v170, v171
    v_exp_f32 v172, v172
    v_exp_f32 v173, v173
    v_exp_f32 v174, v174
    v_exp_f32 v175, v175
    v_fmamk_f32 v168, v148, 0x3e0293ee, v248
    v_fmamk_f32 v169, v149, 0x3e0293ee, v248
    v_fmamk_f32 v170, v150, 0x3e0293ee, v248
    v_fmamk_f32 v171, v151, 0x3e0293ee, v248
    s_setprio 1
    s_nop 0
    v_cvt_pk_bf16_f32 v164, v172, v173
    v_cvt_pk_bf16_f32 v165, v174, v175
    v_exp_f32 v168, v168
    v_exp_f32 v169, v169
    v_exp_f32 v170, v170
    v_exp_f32 v171, v171
    v_fmamk_f32 v172, v156, 0x3e0293ee, v249
    v_fmamk_f32 v173, v157, 0x3e0293ee, v249
    v_fmamk_f32 v174, v158, 0x3e0293ee, v249
    v_fmamk_f32 v175, v159, 0x3e0293ee, v249
    v_cvt_pk_bf16_f32 v162, v168, v169
    v_cvt_pk_bf16_f32 v163, v170, v171
    s_waitcnt vmcnt(0)
    s_nop 0
    ds_read_b128 v[112:115], v236 offset:0
    ds_read_b128 v[116:119], v237 offset:0
    ds_read_b128 v[120:123], v238 offset:0
    ds_read_b128 v[124:127], v239 offset:0
    v_exp_f32 v172, v172
    v_exp_f32 v173, v173
    v_exp_f32 v174, v174
    v_exp_f32 v175, v175
    v_cvt_pk_bf16_f32 v166, v172, v173
    v_cvt_pk_bf16_f32 v167, v174, v175
    s_waitcnt vmcnt(1)
    s_barrier
    s_waitcnt vmcnt(0)
    v_mfma_f32_16x16x32_bf16 v[208:211], v[216:219], v[160:163], v[200:203]
    v_mfma_f32_16x16x32_bf16 v[212:215], v[216:219], v[164:167], v[204:207]
    s_waitcnt lgkmcnt(7)
    v_mfma_f32_16x16x32_bf16 v[128:131], v[176:179], v[96:99], 0
    s_setprio 3
    ds_read_b128 v[192:195], v224 offset:4096
    s_waitcnt lgkmcnt(4)
    v_mfma_f32_16x16x32_bf16 v[136:139], v[176:179], v[112:115], 0
    s_waitcnt lgkmcnt(3)
    v_mfma_f32_16x16x32_bf16 v[136:139], v[180:183], v[116:119], v[136:139]
    ds_read_b128 v[196:199], v225 offset:4096
    v_mfma_f32_16x16x32_bf16 v[128:131], v[180:183], v[100:103], v[128:131]
    v_mfma_f32_16x16x32_bf16 v[128:131], v[184:187], v[104:107], v[128:131]
    ds_read_b128 v[176:179], v226 offset:4096
    s_waitcnt lgkmcnt(4)
    v_mfma_f32_16x16x32_bf16 v[136:139], v[184:187], v[120:123], v[136:139]
    v_max_f32_e64 v250, v208, v212
    v_cmp_nle_f32_e64 s[42:43], v250, s40
    s_waitcnt lgkmcnt(3)
    s_cmp_eq_u32 s29, 3
    s_cselect_b32 s14, 0, s14
    s_add_u32 m0, s58, 0x0
    s_add_u32 s38, s32, 0x2000000
    buffer_load_dwordx4 v240, s[12:15], s38 offen offset:0 nt lds
    v_mfma_f32_16x16x32_bf16 v[136:139], v[188:191], v[124:127], v[136:139]
    ds_read_b128 v[180:183], v227 offset:4096
    v_mfma_f32_16x16x32_bf16 v[128:131], v[188:191], v[108:111], v[128:131]
    s_cmp_lg_u64 s[42:43], 0
    s_cbranch_scc1 L_stublead6
L_retlead6:
    s_waitcnt lgkmcnt(3)
    v_mfma_f32_16x16x32_bf16 v[132:135], v[192:195], v[96:99], 0
    ds_read_b64_tr_b16 v[184:185], v228 offset:57344
    v_mfma_f32_16x16x32_bf16 v[140:143], v[192:195], v[112:115], 0
    ds_read_b64_tr_b16 v[186:187], v228 offset:61440
    s_add_u32 m0, s58, 0x400
    s_add_u32 s38, s32, 0x2000000
    buffer_load_dwordx4 v241, s[12:15], s38 offen offset:0 nt lds
    s_waitcnt lgkmcnt(4)
    v_mfma_f32_16x16x32_bf16 v[140:143], v[196:199], v[116:119], v[140:143]
    ds_read_b64_tr_b16 v[188:189], v229 offset:57344
    v_mfma_f32_16x16x32_bf16 v[132:135], v[196:199], v[100:103], v[132:135]
    ds_read_b64_tr_b16 v[190:191], v229 offset:61440
    s_waitcnt lgkmcnt(5)
    v_mfma_f32_16x16x32_bf16 v[132:135], v[176:179], v[104:107], v[132:135]
    ds_read_b64_tr_b16 v[192:193], v230 offset:57344
    v_mfma_f32_16x16x32_bf16 v[140:143], v[176:179], v[120:123], v[140:143]
    ds_read_b64_tr_b16 v[194:195], v230 offset:61440
    s_waitcnt lgkmcnt(6)
    v_mfma_f32_16x16x32_bf16 v[140:143], v[180:183], v[124:127], v[140:143]
    ds_read_b64_tr_b16 v[176:177], v231 offset:57344
    v_mfma_f32_16x16x32_bf16 v[132:135], v[180:183], v[108:111], v[132:135]
    ds_read_b64_tr_b16 v[178:179], v231 offset:61440
    s_waitcnt lgkmcnt(6)
    v_mfma_f32_16x16x32_bf16 v[0:3], v[184:187], v[160:163], v[0:3]
    ds_read_b64_tr_b16 v[180:181], v232 offset:57344
    v_mfma_f32_16x16x32_bf16 v[32:35], v[184:187], v[164:167], v[32:35]
    ds_read_b64_tr_b16 v[182:183], v232 offset:61440
    s_waitcnt lgkmcnt(6)
    v_mfma_f32_16x16x32_bf16 v[36:39], v[188:191], v[164:167], v[36:39]
    ds_read_b64_tr_b16 v[184:185], v233 offset:57344
    v_mfma_f32_16x16x32_bf16 v[4:7], v[188:191], v[160:163], v[4:7]
    ds_read_b64_tr_b16 v[186:187], v233 offset:61440
    s_waitcnt lgkmcnt(6)
    v_mfma_f32_16x16x32_bf16 v[8:11], v[192:195], v[160:163], v[8:11]
    ds_read_b64_tr_b16 v[196:197], v234 offset:57344
    v_mfma_f32_16x16x32_bf16 v[40:43], v[192:195], v[164:167], v[40:43]
    ds_read_b64_tr_b16 v[198:199], v234 offset:61440
    s_waitcnt lgkmcnt(6)
    v_mfma_f32_16x16x32_bf16 v[44:47], v[176:179], v[164:167], v[44:47]
    ds_read_b64_tr_b16 v[192:193], v235 offset:57344
    v_mfma_f32_16x16x32_bf16 v[12:15], v[176:179], v[160:163], v[12:15]
    ds_read_b64_tr_b16 v[194:195], v235 offset:61440
    s_waitcnt lgkmcnt(6)
    v_mfma_f32_16x16x32_bf16 v[16:19], v[180:183], v[160:163], v[16:19]
    v_mfma_f32_16x16x32_bf16 v[48:51], v[180:183], v[164:167], v[48:51]
    s_waitcnt lgkmcnt(4)
    v_mfma_f32_16x16x32_bf16 v[52:55], v[184:187], v[164:167], v[52:55]
    v_mfma_f32_16x16x32_bf16 v[20:23], v[184:187], v[160:163], v[20:23]
    s_waitcnt lgkmcnt(2)
    v_mfma_f32_16x16x32_bf16 v[24:27], v[196:199], v[160:163], v[24:27]
    ds_read_b128 v[176:179], v224 offset:8192
    v_mfma_f32_16x16x32_bf16 v[56:59], v[196:199], v[164:167], v[56:59]
    ds_read_b128 v[180:183], v225 offset:8192
    s_waitcnt lgkmcnt(2)
    v_mfma_f32_16x16x32_bf16 v[60:63], v[192:195], v[164:167], v[60:63]
    ds_read_b128 v[184:187], v226 offset:8192
    v_mfma_f32_16x16x32_bf16 v[28:31], v[192:195], v[160:163], v[28:31]
    ds_read_b128 v[188:191], v227 offset:8192
L_looplead:
    s_mov_b32 s50, s35
    s_mov_b32 s34, s32
    s_mov_b32 s32, s30
    s_xor_b32 s30, s30, 0x4000
    s_add_u32 s30, s30, 0x2000000
    s_mov_b32 s35, s33
    s_mov_b32 s33, s31
    s_xor_b32 s31, s31, 0x4000
    s_add_u32 s31, s31, 0x2000000
    s_add_u32 s36, s36, 0x1000000
    s_setprio 0
.p2align 3
    v_rcp_f32 v208, v208
    v_rcp_f32 v212, v212
    buffer_store_dwordx4 v[220:223], v244, s[52:55], s50 offen offset:0 sc0 sc1
    v_max_f32_e64 v248, v128, v129
    v_max_f32_e64 v249, v136, v137
    v_max3_f32 v248, v248, v130, v131
    v_max3_f32 v249, v249, v138, v139
    v_max3_f32 v248, v248, v132, v133
    v_max3_f32 v249, v249, v140, v141
    v_max3_f32 v248, v248, v134, v135
    v_max3_f32 v249, v249, v142, v143
    s_nop 1
    v_permlane32_swap_b32 v248, v249
    v_max_f32 v248, v248, v249
    v_mov_b32 v249, v248
    s_nop 1
    v_permlane16_swap_b32 v248, v249
    v_max_f32 v248, v248, v249
    v_mul_f32 v248, 0xbe0293ee, v248
    v_mov_b32 v249, v248
    s_nop 1
    v_permlane32_swap_b32 v248, v249
.p2align 3
    v_fmamk_f32 v168, v128, 0x3e0293ee, v248
    v_fmamk_f32 v169, v129, 0x3e0293ee, v248
    v_fmamk_f32 v170, v130, 0x3e0293ee, v248
    v_fmamk_f32 v171, v131, 0x3e0293ee, v248
    v_exp_f32 v168, v168
    v_exp_f32 v169, v169
    v_exp_f32 v170, v170
    v_exp_f32 v171, v171
    v_fmamk_f32 v172, v136, 0x3e0293ee, v249
    v_fmamk_f32 v173, v137, 0x3e0293ee, v249
    v_fmamk_f32 v174, v138, 0x3e0293ee, v249
    v_fmamk_f32 v175, v139, 0x3e0293ee, v249
    s_setprio 2
    s_nop 0
    v_cvt_pk_bf16_f32 v160, v168, v169
    v_cvt_pk_bf16_f32 v161, v170, v171
    v_exp_f32 v172, v172
    v_exp_f32 v173, v173
    v_exp_f32 v174, v174
    v_exp_f32 v175, v175
    v_fmamk_f32 v168, v132, 0x3e0293ee, v248
    v_fmamk_f32 v169, v133, 0x3e0293ee, v248
    v_fmamk_f32 v170, v134, 0x3e0293ee, v248
    v_fmamk_f32 v171, v135, 0x3e0293ee, v248
    v_cvt_pk_bf16_f32 v164, v172, v173
    v_cvt_pk_bf16_f32 v165, v174, v175
    v_exp_f32 v168, v168
    v_exp_f32 v169, v169
    v_exp_f32 v170, v170
    v_exp_f32 v171, v171
    v_fmamk_f32 v172, v140, 0x3e0293ee, v249
    v_fmamk_f32 v173, v141, 0x3e0293ee, v249
    v_fmamk_f32 v174, v142, 0x3e0293ee, v249
    v_fmamk_f32 v175, v143, 0x3e0293ee, v249
    v_cvt_pk_bf16_f32 v162, v168, v169
    v_cvt_pk_bf16_f32 v163, v170, v171
    v_exp_f32 v172, v172
    v_exp_f32 v173, v173
    v_exp_f32 v174, v174
    v_exp_f32 v175, v175
    v_cvt_pk_bf16_f32 v166, v172, v173
    v_cvt_pk_bf16_f32 v167, v174, v175
    v_pk_mul_f32 v[0:1], v[0:1], v[208:209] op_sel_hi:[1,0]
    v_pk_mul_f32 v[2:3], v[2:3], v[208:209] op_sel_hi:[1,0]
    v_pk_mul_f32 v[4:5], v[4:5], v[208:209] op_sel_hi:[1,0]
    v_pk_mul_f32 v[6:7], v[6:7], v[208:209] op_sel_hi:[1,0]
    v_cvt_pk_bf16_f32 v64, v0, v1
    v_cvt_pk_bf16_f32 v65, v2, v3
    v_cvt_pk_bf16_f32 v66, v4, v5
    v_cvt_pk_bf16_f32 v67, v6, v7
    v_pk_mul_f32 v[8:9], v[8:9], v[208:209] op_sel_hi:[1,0]
    v_pk_mul_f32 v[10:11], v[10:11], v[208:209] op_sel_hi:[1,0]
    v_pk_mul_f32 v[12:13], v[12:13], v[208:209] op_sel_hi:[1,0]
    v_pk_mul_f32 v[14:15], v[14:15], v[208:209] op_sel_hi:[1,0]
    v_cvt_pk_bf16_f32 v68, v8, v9
    v_cvt_pk_bf16_f32 v69, v10, v11
    v_cvt_pk_bf16_f32 v70, v12, v13
    v_cvt_pk_bf16_f32 v71, v14, v15
    v_pk_mul_f32 v[16:17], v[16:17], v[208:209] op_sel_hi:[1,0]
    v_pk_mul_f32 v[18:19], v[18:19], v[208:209] op_sel_hi:[1,0]
    v_pk_mul_f32 v[20:21], v[20:21], v[208:209] op_sel_hi:[1,0]
    v_pk_mul_f32 v[22:23], v[22:23], v[208:209] op_sel_hi:[1,0]
    v_cvt_pk_bf16_f32 v72, v16, v17
    v_cvt_pk_bf16_f32 v73, v18, v19
    v_cvt_pk_bf16_f32 v74, v20, v21
    v_cvt_pk_bf16_f32 v75, v22, v23
    v_pk_mul_f32 v[24:25], v[24:25], v[208:209] op_sel_hi:[1,0]
    v_pk_mul_f32 v[26:27], v[26:27], v[208:209] op_sel_hi:[1,0]
    v_pk_mul_f32 v[28:29], v[28:29], v[208:209] op_sel_hi:[1,0]
    v_pk_mul_f32 v[30:31], v[30:31], v[208:209] op_sel_hi:[1,0]
    v_cvt_pk_bf16_f32 v76, v24, v25
    v_cvt_pk_bf16_f32 v77, v26, v27
    v_cvt_pk_bf16_f32 v78, v28, v29
    v_cvt_pk_bf16_f32 v79, v30, v31
    v_pk_mul_f32 v[32:33], v[32:33], v[212:213] op_sel_hi:[1,0]
    v_pk_mul_f32 v[34:35], v[34:35], v[212:213] op_sel_hi:[1,0]
    v_pk_mul_f32 v[36:37], v[36:37], v[212:213] op_sel_hi:[1,0]
    v_pk_mul_f32 v[38:39], v[38:39], v[212:213] op_sel_hi:[1,0]
    v_cvt_pk_bf16_f32 v80, v32, v33
    v_cvt_pk_bf16_f32 v81, v34, v35
    v_cvt_pk_bf16_f32 v82, v36, v37
    v_cvt_pk_bf16_f32 v83, v38, v39
    v_pk_mul_f32 v[40:41], v[40:41], v[212:213] op_sel_hi:[1,0]
    v_pk_mul_f32 v[42:43], v[42:43], v[212:213] op_sel_hi:[1,0]
    v_pk_mul_f32 v[44:45], v[44:45], v[212:213] op_sel_hi:[1,0]
    v_pk_mul_f32 v[46:47], v[46:47], v[212:213] op_sel_hi:[1,0]
    v_cvt_pk_bf16_f32 v84, v40, v41
    v_cvt_pk_bf16_f32 v85, v42, v43
    v_cvt_pk_bf16_f32 v86, v44, v45
    v_cvt_pk_bf16_f32 v87, v46, v47
    v_pk_mul_f32 v[48:49], v[48:49], v[212:213] op_sel_hi:[1,0]
    v_pk_mul_f32 v[50:51], v[50:51], v[212:213] op_sel_hi:[1,0]
    v_pk_mul_f32 v[52:53], v[52:53], v[212:213] op_sel_hi:[1,0]
    v_pk_mul_f32 v[54:55], v[54:55], v[212:213] op_sel_hi:[1,0]
    v_cvt_pk_bf16_f32 v88, v48, v49
    v_cvt_pk_bf16_f32 v89, v50, v51
    v_cvt_pk_bf16_f32 v90, v52, v53
    v_cvt_pk_bf16_f32 v91, v54, v55
    v_pk_mul_f32 v[56:57], v[56:57], v[212:213] op_sel_hi:[1,0]
    v_pk_mul_f32 v[58:59], v[58:59], v[212:213] op_sel_hi:[1,0]
    v_pk_mul_f32 v[60:61], v[60:61], v[212:213] op_sel_hi:[1,0]
    v_pk_mul_f32 v[62:63], v[62:63], v[212:213] op_sel_hi:[1,0]
    v_cvt_pk_bf16_f32 v92, v56, v57
    v_cvt_pk_bf16_f32 v93, v58, v59
    v_cvt_pk_bf16_f32 v94, v60, v61
    v_cvt_pk_bf16_f32 v95, v62, v63
    s_barrier
    s_waitcnt vmcnt(1)
    v_mfma_f32_16x16x32_bf16 v[200:203], v[216:219], v[160:163], 0
    v_mfma_f32_16x16x32_bf16 v[204:207], v[216:219], v[164:167], 0
    s_waitcnt lgkmcnt(3)
    v_mfma_f32_16x16x32_bf16 v[144:147], v[176:179], v[96:99], 0
    s_setprio 3
    ds_read_b128 v[192:195], v224 offset:12288
    v_mfma_f32_16x16x32_bf16 v[152:155], v[176:179], v[112:115], 0
    s_waitcnt lgkmcnt(3)
    v_mfma_f32_16x16x32_bf16 v[152:155], v[180:183], v[116:119], v[152:155]
    ds_read_b128 v[196:199], v225 offset:12288
    v_mfma_f32_16x16x32_bf16 v[144:147], v[180:183], v[100:103], v[144:147]
    s_add_u32 m0, s58, 0x800
    s_nop 0
    buffer_load_dwordx4 v242, s[12:15], s30 offen offset:0 nt lds
    s_waitcnt lgkmcnt(3)
    v_mfma_f32_16x16x32_bf16 v[144:147], v[184:187], v[104:107], v[144:147]
    ds_read_b128 v[176:179], v226 offset:12288
    v_mfma_f32_16x16x32_bf16 v[152:155], v[184:187], v[120:123], v[152:155]
    s_waitcnt lgkmcnt(3)
    v_mfma_f32_16x16x32_bf16 v[152:155], v[188:191], v[124:127], v[152:155]
    ds_read_b128 v[180:183], v227 offset:12288
    v_mfma_f32_16x16x32_bf16 v[144:147], v[188:191], v[108:111], v[144:147]
    s_add_u32 m0, s37, 0x0
    s_xor_b32 s38, s36, 0x0
    buffer_load_dwordx4 v245, s[16:19], s38 offen offset:0 nt lds
    s_waitcnt lgkmcnt(3)
    v_mfma_f32_16x16x32_bf16 v[148:151], v[192:195], v[96:99], 0
    ds_read_b64_tr_b16 v[184:185], v228 offset:0
    v_mfma_f32_16x16x32_bf16 v[156:159], v[192:195], v[112:115], 0
    ds_read_b64_tr_b16 v[186:187], v228 offset:4096
    s_waitcnt lgkmcnt(4)
    v_mfma_f32_16x16x32_bf16 v[156:159], v[196:199], v[116:119], v[156:159]
    ds_read_b64_tr_b16 v[188:189], v229 offset:0
    v_mfma_f32_16x16x32_bf16 v[148:151], v[196:199], v[100:103], v[148:151]
    ds_read_b64_tr_b16 v[190:191], v229 offset:4096
    s_waitcnt lgkmcnt(5)
    v_mfma_f32_16x16x32_bf16 v[148:151], v[176:179], v[104:107], v[148:151]
    ds_read_b64_tr_b16 v[192:193], v230 offset:0
    v_mfma_f32_16x16x32_bf16 v[156:159], v[176:179], v[120:123], v[156:159]
    ds_read_b64_tr_b16 v[194:195], v230 offset:4096
    s_waitcnt lgkmcnt(6)
    v_mfma_f32_16x16x32_bf16 v[156:159], v[180:183], v[124:127], v[156:159]
    ds_read_b64_tr_b16 v[176:177], v231 offset:0
    v_mfma_f32_16x16x32_bf16 v[148:151], v[180:183], v[108:111], v[148:151]
    ds_read_b64_tr_b16 v[178:179], v231 offset:4096
    s_waitcnt lgkmcnt(6)
    v_mfma_f32_16x16x32_bf16 v[0:3], v[184:187], v[160:163], 0
    ds_read_b64_tr_b16 v[180:181], v232 offset:0
    v_mfma_f32_16x16x32_bf16 v[32:35], v[184:187], v[164:167], 0
    ds_read_b64_tr_b16 v[182:183], v232 offset:4096
    s_waitcnt lgkmcnt(6)
    v_mfma_f32_16x16x32_bf16 v[36:39], v[188:191], v[164:167], 0
    ds_read_b64_tr_b16 v[184:185], v233 offset:0
    v_mfma_f32_16x16x32_bf16 v[4:7], v[188:191], v[160:163], 0
    ds_read_b64_tr_b16 v[186:187], v233 offset:4096
    s_waitcnt lgkmcnt(6)
    v_mfma_f32_16x16x32_bf16 v[8:11], v[192:195], v[160:163], 0
    ds_read_b64_tr_b16 v[196:197], v234 offset:0
    v_mfma_f32_16x16x32_bf16 v[40:43], v[192:195], v[164:167], 0
    ds_read_b64_tr_b16 v[198:199], v234 offset:4096
    s_waitcnt lgkmcnt(6)
    v_mfma_f32_16x16x32_bf16 v[44:47], v[176:179], v[164:167], 0
    ds_read_b64_tr_b16 v[192:193], v235 offset:0
    v_mfma_f32_16x16x32_bf16 v[12:15], v[176:179], v[160:163], 0
    ds_read_b64_tr_b16 v[194:195], v235 offset:4096
    s_waitcnt lgkmcnt(6)
    v_mfma_f32_16x16x32_bf16 v[16:19], v[180:183], v[160:163], 0
    v_mfma_f32_16x16x32_bf16 v[48:51], v[180:183], v[164:167], 0
    s_waitcnt lgkmcnt(4)
    v_mfma_f32_16x16x32_bf16 v[52:55], v[184:187], v[164:167], 0
    v_mfma_f32_16x16x32_bf16 v[20:23], v[184:187], v[160:163], 0
    s_waitcnt lgkmcnt(2)
    v_mfma_f32_16x16x32_bf16 v[24:27], v[196:199], v[160:163], 0
    ds_read_b128 v[176:179], v224 offset:16384
    v_mfma_f32_16x16x32_bf16 v[56:59], v[196:199], v[164:167], 0
    ds_read_b128 v[180:183], v225 offset:16384
    s_waitcnt lgkmcnt(2)
    v_mfma_f32_16x16x32_bf16 v[60:63], v[192:195], v[164:167], 0
    ds_read_b128 v[184:187], v226 offset:16384
    v_mfma_f32_16x16x32_bf16 v[28:31], v[192:195], v[160:163], 0
    ds_read_b128 v[188:191], v227 offset:16384
    s_setprio 0
.p2align 3
    v_fmamk_f32 v168, v144, 0x3e0293ee, v248
    v_fmamk_f32 v169, v145, 0x3e0293ee, v248
    v_permlane16_swap_b32 v64, v66
    v_permlane16_swap_b32 v65, v67
    v_fmamk_f32 v170, v146, 0x3e0293ee, v248
    v_fmamk_f32 v171, v147, 0x3e0293ee, v248
    v_exp_f32 v168, v168
    v_exp_f32 v169, v169
    v_permlane16_swap_b32 v68, v70
    v_permlane16_swap_b32 v69, v71
    v_exp_f32 v170, v170
    v_exp_f32 v171, v171
    v_fmamk_f32 v172, v152, 0x3e0293ee, v249
    v_fmamk_f32 v173, v153, 0x3e0293ee, v249
    v_cndmask_b32_dpp v220, v68, v64, vcc quad_perm:[1,0,3,2] row_mask:0xf bank_mask:0xf
    v_cndmask_b32_dpp v221, v69, v65, vcc quad_perm:[1,0,3,2] row_mask:0xf bank_mask:0xf
    v_fmamk_f32 v174, v154, 0x3e0293ee, v249
    v_fmamk_f32 v175, v155, 0x3e0293ee, v249
    v_cvt_pk_bf16_f32 v160, v168, v169
    v_cvt_pk_bf16_f32 v161, v170, v171
    v_cndmask_b32_dpp v222, v70, v66, vcc quad_perm:[1,0,3,2] row_mask:0xf bank_mask:0xf
    v_cndmask_b32_dpp v223, v71, v67, vcc quad_perm:[1,0,3,2] row_mask:0xf bank_mask:0xf
    s_not_b64 vcc, vcc
    s_nop 0
    v_exp_f32 v172, v172
    v_exp_f32 v173, v173
    v_exp_f32 v174, v174
    v_exp_f32 v175, v175
    v_cndmask_b32_dpp v68, v64, v68, vcc quad_perm:[1,0,3,2] row_mask:0xf bank_mask:0xf
    v_cndmask_b32_dpp v69, v65, v69, vcc quad_perm:[1,0,3,2] row_mask:0xf bank_mask:0xf
    v_fmamk_f32 v168, v148, 0x3e0293ee, v248
    v_fmamk_f32 v169, v149, 0x3e0293ee, v248
    v_fmamk_f32 v170, v150, 0x3e0293ee, v248
    v_fmamk_f32 v171, v151, 0x3e0293ee, v248
    s_setprio 1
    s_nop 0
    v_cndmask_b32_dpp v70, v66, v70, vcc quad_perm:[1,0,3,2] row_mask:0xf bank_mask:0xf
    v_cndmask_b32_dpp v71, v67, v71, vcc quad_perm:[1,0,3,2] row_mask:0xf bank_mask:0xf
    s_not_b64 vcc, vcc
    s_nop 0
    v_cvt_pk_bf16_f32 v164, v172, v173
    v_cvt_pk_bf16_f32 v165, v174, v175
    v_exp_f32 v168, v168
    v_exp_f32 v169, v169
    buffer_store_dwordx4 v[68:71], v244, s[24:27], s34 offen offset:256 sc0 sc1
    v_exp_f32 v170, v170
    v_exp_f32 v171, v171
    v_fmamk_f32 v172, v156, 0x3e0293ee, v249
    v_fmamk_f32 v173, v157, 0x3e0293ee, v249
    v_fmamk_f32 v174, v158, 0x3e0293ee, v249
    v_fmamk_f32 v175, v159, 0x3e0293ee, v249
    v_cvt_pk_bf16_f32 v162, v168, v169
    v_cvt_pk_bf16_f32 v163, v170, v171
    v_exp_f32 v172, v172
    v_exp_f32 v173, v173
    v_exp_f32 v174, v174
    v_exp_f32 v175, v175
    v_cvt_pk_bf16_f32 v166, v172, v173
    v_cvt_pk_bf16_f32 v167, v174, v175
    s_barrier
    s_waitcnt vmcnt(1)
    v_mfma_f32_16x16x32_bf16 v[208:211], v[216:219], v[160:163], v[200:203]
    v_mfma_f32_16x16x32_bf16 v[212:215], v[216:219], v[164:167], v[204:207]
    s_waitcnt lgkmcnt(3)
    v_mfma_f32_16x16x32_bf16 v[128:131], v[176:179], v[96:99], 0
    s_setprio 3
    ds_read_b128 v[192:195], v224 offset:20480
    v_mfma_f32_16x16x32_bf16 v[136:139], v[176:179], v[112:115], 0
    s_waitcnt lgkmcnt(3)
    v_mfma_f32_16x16x32_bf16 v[136:139], v[180:183], v[116:119], v[136:139]
    ds_read_b128 v[196:199], v225 offset:20480
    v_mfma_f32_16x16x32_bf16 v[128:131], v[180:183], v[100:103], v[128:131]
    s_add_u32 m0, s37, 0x2000
    s_xor_b32 s38, s36, 0x1000
    buffer_load_dwordx4 v245, s[16:19], s38 offen offset:0 nt lds
    s_waitcnt lgkmcnt(3)
    v_mfma_f32_16x16x32_bf16 v[128:131], v[184:187], v[104:107], v[128:131]
    ds_read_b128 v[176:179], v226 offset:20480
    v_mfma_f32_16x16x32_bf16 v[136:139], v[184:187], v[120:123], v[136:139]
    v_max_f32_e64 v250, v208, v212
    v_cmp_nle_f32_e64 s[42:43], v250, s40
    s_waitcnt lgkmcnt(3)
    v_mfma_f32_16x16x32_bf16 v[136:139], v[188:191], v[124:127], v[136:139]
    ds_read_b128 v[180:183], v227 offset:20480
    v_mfma_f32_16x16x32_bf16 v[128:131], v[188:191], v[108:111], v[128:131]
    s_cmp_lg_u64 s[42:43], 0
    s_cbranch_scc1 L_stublead7
L_retlead7:
    s_add_u32 m0, s37, 0x10000
    s_xor_b32 s38, s36, 0x0
    buffer_load_dwordx4 v246, s[20:23], s38 offen offset:0 nt lds
    s_waitcnt lgkmcnt(3)
    v_mfma_f32_16x16x32_bf16 v[132:135], v[192:195], v[96:99], 0
    ds_read_b64_tr_b16 v[184:185], v228 offset:8192
    v_mfma_f32_16x16x32_bf16 v[140:143], v[192:195], v[112:115], 0
    ds_read_b64_tr_b16 v[186:187], v228 offset:12288
    s_waitcnt lgkmcnt(4)
    v_mfma_f32_16x16x32_bf16 v[140:143], v[196:199], v[116:119], v[140:143]
    ds_read_b64_tr_b16 v[188:189], v229 offset:8192
    v_mfma_f32_16x16x32_bf16 v[132:135], v[196:199], v[100:103], v[132:135]
    ds_read_b64_tr_b16 v[190:191], v229 offset:12288
    s_waitcnt lgkmcnt(5)
    v_mfma_f32_16x16x32_bf16 v[132:135], v[176:179], v[104:107], v[132:135]
    ds_read_b64_tr_b16 v[192:193], v230 offset:8192
    v_mfma_f32_16x16x32_bf16 v[140:143], v[176:179], v[120:123], v[140:143]
    ds_read_b64_tr_b16 v[194:195], v230 offset:12288
    s_waitcnt lgkmcnt(6)
    v_mfma_f32_16x16x32_bf16 v[140:143], v[180:183], v[124:127], v[140:143]
    ds_read_b64_tr_b16 v[176:177], v231 offset:8192
    v_mfma_f32_16x16x32_bf16 v[132:135], v[180:183], v[108:111], v[132:135]
    ds_read_b64_tr_b16 v[178:179], v231 offset:12288
    s_waitcnt lgkmcnt(6)
    v_mfma_f32_16x16x32_bf16 v[0:3], v[184:187], v[160:163], v[0:3]
    ds_read_b64_tr_b16 v[180:181], v232 offset:8192
    v_mfma_f32_16x16x32_bf16 v[32:35], v[184:187], v[164:167], v[32:35]
    ds_read_b64_tr_b16 v[182:183], v232 offset:12288
    s_waitcnt lgkmcnt(6)
    v_mfma_f32_16x16x32_bf16 v[36:39], v[188:191], v[164:167], v[36:39]
    ds_read_b64_tr_b16 v[184:185], v233 offset:8192
    v_mfma_f32_16x16x32_bf16 v[4:7], v[188:191], v[160:163], v[4:7]
    ds_read_b64_tr_b16 v[186:187], v233 offset:12288
    s_waitcnt lgkmcnt(6)
    v_mfma_f32_16x16x32_bf16 v[8:11], v[192:195], v[160:163], v[8:11]
    ds_read_b64_tr_b16 v[196:197], v234 offset:8192
    v_mfma_f32_16x16x32_bf16 v[40:43], v[192:195], v[164:167], v[40:43]
    ds_read_b64_tr_b16 v[198:199], v234 offset:12288
    s_waitcnt lgkmcnt(6)
    v_mfma_f32_16x16x32_bf16 v[44:47], v[176:179], v[164:167], v[44:47]
    ds_read_b64_tr_b16 v[192:193], v235 offset:8192
    v_mfma_f32_16x16x32_bf16 v[12:15], v[176:179], v[160:163], v[12:15]
    ds_read_b64_tr_b16 v[194:195], v235 offset:12288
    s_waitcnt lgkmcnt(6)
    v_mfma_f32_16x16x32_bf16 v[16:19], v[180:183], v[160:163], v[16:19]
    v_mfma_f32_16x16x32_bf16 v[48:51], v[180:183], v[164:167], v[48:51]
    s_waitcnt lgkmcnt(4)
    v_mfma_f32_16x16x32_bf16 v[52:55], v[184:187], v[164:167], v[52:55]
    v_mfma_f32_16x16x32_bf16 v[20:23], v[184:187], v[160:163], v[20:23]
    s_waitcnt lgkmcnt(2)
    v_mfma_f32_16x16x32_bf16 v[24:27], v[196:199], v[160:163], v[24:27]
    ds_read_b128 v[176:179], v224 offset:24576
    v_mfma_f32_16x16x32_bf16 v[56:59], v[196:199], v[164:167], v[56:59]
    ds_read_b128 v[180:183], v225 offset:24576
    s_waitcnt lgkmcnt(2)
    v_mfma_f32_16x16x32_bf16 v[60:63], v[192:195], v[164:167], v[60:63]
    ds_read_b128 v[184:187], v226 offset:24576
    v_mfma_f32_16x16x32_bf16 v[28:31], v[192:195], v[160:163], v[28:31]
    ds_read_b128 v[188:191], v227 offset:24576
    s_setprio 0
.p2align 3
    s_nop 0
    s_barrier
    s_setprio 2
    s_nop 0
    v_fmamk_f32 v168, v128, 0x3e0293ee, v248
    v_fmamk_f32 v169, v129, 0x3e0293ee, v248
    v_permlane16_swap_b32 v72, v74
    v_permlane16_swap_b32 v73, v75
    v_fmamk_f32 v170, v130, 0x3e0293ee, v248
    v_fmamk_f32 v171, v131, 0x3e0293ee, v248
    v_exp_f32 v168, v168
    v_exp_f32 v169, v169
    v_permlane16_swap_b32 v76, v78
    v_permlane16_swap_b32 v77, v79
    v_exp_f32 v170, v170
    v_exp_f32 v171, v171
    v_fmamk_f32 v172, v136, 0x3e0293ee, v249
    v_fmamk_f32 v173, v137, 0x3e0293ee, v249
    v_cndmask_b32_dpp v64, v76, v72, vcc quad_perm:[1,0,3,2] row_mask:0xf bank_mask:0xf
    v_cndmask_b32_dpp v65, v77, v73, vcc quad_perm:[1,0,3,2] row_mask:0xf bank_mask:0xf
    v_fmamk_f32 v174, v138, 0x3e0293ee, v249
    v_fmamk_f32 v175, v139, 0x3e0293ee, v249
    v_cvt_pk_bf16_f32 v160, v168, v169
    v_cvt_pk_bf16_f32 v161, v170, v171
    v_cndmask_b32_dpp v66, v78, v74, vcc quad_perm:[1,0,3,2] row_mask:0xf bank_mask:0xf
    v_cndmask_b32_dpp v67, v79, v75, vcc quad_perm:[1,0,3,2] row_mask:0xf bank_mask:0xf
    s_not_b64 vcc, vcc
    s_nop 0
    v_exp_f32 v172, v172
    v_exp_f32 v173, v173
    v_exp_f32 v174, v174
    v_exp_f32 v175, v175
    v_cndmask_b32_dpp v76, v72, v76, vcc quad_perm:[1,0,3,2] row_mask:0xf bank_mask:0xf
    v_cndmask_b32_dpp v77, v73, v77, vcc quad_perm:[1,0,3,2] row_mask:0xf bank_mask:0xf
    v_fmamk_f32 v168, v132, 0x3e0293ee, v248
    v_fmamk_f32 v169, v133, 0x3e0293ee, v248
    v_fmamk_f32 v170, v134, 0x3e0293ee, v248
    v_fmamk_f32 v171, v135, 0x3e0293ee, v248
    v_cndmask_b32_dpp v78, v74, v78, vcc quad_perm:[1,0,3,2] row_mask:0xf bank_mask:0xf
    v_cndmask_b32_dpp v79, v75, v79, vcc quad_perm:[1,0,3,2] row_mask:0xf bank_mask:0xf
    s_not_b64 vcc, vcc
    s_nop 0
    v_cvt_pk_bf16_f32 v164, v172, v173
    v_cvt_pk_bf16_f32 v165, v174, v175
    v_exp_f32 v168, v168
    v_exp_f32 v169, v169
    buffer_store_dwordx4 v[64:67], v244, s[24:27], s34 offen offset:128 sc0 sc1
    v_exp_f32 v170, v170
    v_exp_f32 v171, v171
    v_fmamk_f32 v172, v140, 0x3e0293ee, v249
    v_fmamk_f32 v173, v141, 0x3e0293ee, v249
    v_fmamk_f32 v174, v142, 0x3e0293ee, v249
    v_fmamk_f32 v175, v143, 0x3e0293ee, v249
    v_cvt_pk_bf16_f32 v162, v168, v169
    v_cvt_pk_bf16_f32 v163, v170, v171
    v_exp_f32 v172, v172
    v_exp_f32 v173, v173
    v_exp_f32 v174, v174
    v_exp_f32 v175, v175
    v_cvt_pk_bf16_f32 v166, v172, v173
    v_cvt_pk_bf16_f32 v167, v174, v175
    s_waitcnt vmcnt(1)
    v_mfma_f32_16x16x32_bf16 v[200:203], v[216:219], v[160:163], v[208:211]
    v_mfma_f32_16x16x32_bf16 v[204:207], v[216:219], v[164:167], v[212:215]
    s_waitcnt lgkmcnt(3)
    v_mfma_f32_16x16x32_bf16 v[144:147], v[176:179], v[96:99], 0
    s_setprio 3
    ds_read_b128 v[192:195], v224 offset:28672
    v_mfma_f32_16x16x32_bf16 v[152:155], v[176:179], v[112:115], 0
    s_waitcnt lgkmcnt(3)
    v_mfma_f32_16x16x32_bf16 v[152:155], v[180:183], v[116:119], v[152:155]
    ds_read_b128 v[196:199], v225 offset:28672
    v_mfma_f32_16x16x32_bf16 v[144:147], v[180:183], v[100:103], v[144:147]
    s_add_u32 m0, s58, 0xc00
    s_nop 0
    buffer_load_dwordx4 v243, s[12:15], s30 offen offset:0 nt lds
    s_waitcnt lgkmcnt(3)
    v_mfma_f32_16x16x32_bf16 v[144:147], v[184:187], v[104:107], v[144:147]
    ds_read_b128 v[176:179], v226 offset:28672
    v_mfma_f32_16x16x32_bf16 v[152:155], v[184:187], v[120:123], v[152:155]
    v_max_f32_e64 v250, v200, v204
    v_cmp_nle_f32_e64 s[42:43], v250, s40
    s_waitcnt lgkmcnt(3)
    v_mfma_f32_16x16x32_bf16 v[152:155], v[188:191], v[124:127], v[152:155]
    ds_read_b128 v[180:183], v227 offset:28672
    v_mfma_f32_16x16x32_bf16 v[144:147], v[188:191], v[108:111], v[144:147]
    s_cmp_lg_u64 s[42:43], 0
    s_cbranch_scc1 L_stublead8
L_retlead8:
    s_add_u32 m0, s37, 0x4000
    s_xor_b32 s38, s36, 0x2000
    buffer_load_dwordx4 v245, s[16:19], s38 offen offset:0 nt lds
    s_waitcnt lgkmcnt(3)
    v_mfma_f32_16x16x32_bf16 v[148:151], v[192:195], v[96:99], 0
    ds_read_b64_tr_b16 v[184:185], v228 offset:16384
    v_mfma_f32_16x16x32_bf16 v[156:159], v[192:195], v[112:115], 0
    ds_read_b64_tr_b16 v[186:187], v228 offset:20480
    s_waitcnt lgkmcnt(4)
    v_mfma_f32_16x16x32_bf16 v[156:159], v[196:199], v[116:119], v[156:159]
    ds_read_b64_tr_b16 v[188:189], v229 offset:16384
    v_mfma_f32_16x16x32_bf16 v[148:151], v[196:199], v[100:103], v[148:151]
    ds_read_b64_tr_b16 v[190:191], v229 offset:20480
    s_waitcnt lgkmcnt(5)
    v_mfma_f32_16x16x32_bf16 v[148:151], v[176:179], v[104:107], v[148:151]
    ds_read_b64_tr_b16 v[192:193], v230 offset:16384
    v_mfma_f32_16x16x32_bf16 v[156:159], v[176:179], v[120:123], v[156:159]
    ds_read_b64_tr_b16 v[194:195], v230 offset:20480
    s_waitcnt lgkmcnt(6)
    v_mfma_f32_16x16x32_bf16 v[156:159], v[180:183], v[124:127], v[156:159]
    ds_read_b64_tr_b16 v[176:177], v231 offset:16384
    v_mfma_f32_16x16x32_bf16 v[148:151], v[180:183], v[108:111], v[148:151]
    ds_read_b64_tr_b16 v[178:179], v231 offset:20480
    s_waitcnt lgkmcnt(6)
    v_mfma_f32_16x16x32_bf16 v[0:3], v[184:187], v[160:163], v[0:3]
    ds_read_b64_tr_b16 v[180:181], v232 offset:16384
    v_mfma_f32_16x16x32_bf16 v[32:35], v[184:187], v[164:167], v[32:35]
    ds_read_b64_tr_b16 v[182:183], v232 offset:20480
    s_waitcnt lgkmcnt(6)
    v_mfma_f32_16x16x32_bf16 v[36:39], v[188:191], v[164:167], v[36:39]
    ds_read_b64_tr_b16 v[184:185], v233 offset:16384
    v_mfma_f32_16x16x32_bf16 v[4:7], v[188:191], v[160:163], v[4:7]
    ds_read_b64_tr_b16 v[186:187], v233 offset:20480
    s_waitcnt lgkmcnt(6)
    v_mfma_f32_16x16x32_bf16 v[8:11], v[192:195], v[160:163], v[8:11]
    ds_read_b64_tr_b16 v[196:197], v234 offset:16384
    v_mfma_f32_16x16x32_bf16 v[40:43], v[192:195], v[164:167], v[40:43]
    ds_read_b64_tr_b16 v[198:199], v234 offset:20480
    s_waitcnt lgkmcnt(6)
    v_mfma_f32_16x16x32_bf16 v[44:47], v[176:179], v[164:167], v[44:47]
    ds_read_b64_tr_b16 v[192:193], v235 offset:16384
    v_mfma_f32_16x16x32_bf16 v[12:15], v[176:179], v[160:163], v[12:15]
    ds_read_b64_tr_b16 v[194:195], v235 offset:20480
    s_waitcnt lgkmcnt(6)
    v_mfma_f32_16x16x32_bf16 v[16:19], v[180:183], v[160:163], v[16:19]
    v_mfma_f32_16x16x32_bf16 v[48:51], v[180:183], v[164:167], v[48:51]
    s_waitcnt lgkmcnt(4)
    v_mfma_f32_16x16x32_bf16 v[52:55], v[184:187], v[164:167], v[52:55]
    v_mfma_f32_16x16x32_bf16 v[20:23], v[184:187], v[160:163], v[20:23]
    s_waitcnt lgkmcnt(2)
    v_mfma_f32_16x16x32_bf16 v[24:27], v[196:199], v[160:163], v[24:27]
    ds_read_b128 v[176:179], v224 offset:32768
    v_mfma_f32_16x16x32_bf16 v[56:59], v[196:199], v[164:167], v[56:59]
    ds_read_b128 v[180:183], v225 offset:32768
    s_waitcnt lgkmcnt(2)
    v_mfma_f32_16x16x32_bf16 v[60:63], v[192:195], v[164:167], v[60:63]
    ds_read_b128 v[184:187], v226 offset:32768
    v_mfma_f32_16x16x32_bf16 v[28:31], v[192:195], v[160:163], v[28:31]
    ds_read_b128 v[188:191], v227 offset:32768
    s_setprio 0
.p2align 3
    s_nop 0
    s_barrier
    s_setprio 2
    s_nop 0
    v_fmamk_f32 v168, v144, 0x3e0293ee, v248
    v_fmamk_f32 v169, v145, 0x3e0293ee, v248
    buffer_store_dwordx4 v[76:79], v244, s[24:27], s34 offen offset:384 sc0 sc1
    v_fmamk_f32 v170, v146, 0x3e0293ee, v248
    v_fmamk_f32 v171, v147, 0x3e0293ee, v248
    v_exp_f32 v168, v168
    v_exp_f32 v169, v169
    v_exp_f32 v170, v170
    v_exp_f32 v171, v171
    v_fmamk_f32 v172, v152, 0x3e0293ee, v249
    v_fmamk_f32 v173, v153, 0x3e0293ee, v249
    v_fmamk_f32 v174, v154, 0x3e0293ee, v249
    v_fmamk_f32 v175, v155, 0x3e0293ee, v249
    v_cvt_pk_bf16_f32 v160, v168, v169
    v_cvt_pk_bf16_f32 v161, v170, v171
    v_exp_f32 v172, v172
    v_exp_f32 v173, v173
    v_exp_f32 v174, v174
    v_exp_f32 v175, v175
    v_fmamk_f32 v168, v148, 0x3e0293ee, v248
    v_fmamk_f32 v169, v149, 0x3e0293ee, v248
    v_fmamk_f32 v170, v150, 0x3e0293ee, v248
    v_fmamk_f32 v171, v151, 0x3e0293ee, v248
    v_cvt_pk_bf16_f32 v164, v172, v173
    v_cvt_pk_bf16_f32 v165, v174, v175
    v_exp_f32 v168, v168
    v_exp_f32 v169, v169
    v_exp_f32 v170, v170
    v_exp_f32 v171, v171
    v_fmamk_f32 v172, v156, 0x3e0293ee, v249
    v_fmamk_f32 v173, v157, 0x3e0293ee, v249
    v_fmamk_f32 v174, v158, 0x3e0293ee, v249
    v_fmamk_f32 v175, v159, 0x3e0293ee, v249
    v_cvt_pk_bf16_f32 v162, v168, v169
    v_cvt_pk_bf16_f32 v163, v170, v171
    s_waitcnt vmcnt(2)
    s_nop 0
    ds_read_b128 v[64:67], v236 offset:0
    ds_read_b128 v[68:71], v237 offset:0
    ds_read_b128 v[72:75], v238 offset:0
    ds_read_b128 v[76:79], v239 offset:0
    v_exp_f32 v172, v172
    v_exp_f32 v173, v173
    v_exp_f32 v174, v174
    v_exp_f32 v175, v175
    v_cvt_pk_bf16_f32 v166, v172, v173
    v_cvt_pk_bf16_f32 v167, v174, v175
    s_waitcnt vmcnt(1)
    v_mfma_f32_16x16x32_bf16 v[208:211], v[216:219], v[160:163], v[200:203]
    v_mfma_f32_16x16x32_bf16 v[212:215], v[216:219], v[164:167], v[204:207]
    s_waitcnt lgkmcnt(7)
    v_mfma_f32_16x16x32_bf16 v[128:131], v[176:179], v[96:99], 0
    s_setprio 3
    ds_read_b128 v[192:195], v224 offset:36864
    v_mfma_f32_16x16x32_bf16 v[136:139], v[176:179], v[112:115], 0
    s_waitcnt lgkmcnt(7)
    v_mfma_f32_16x16x32_bf16 v[136:139], v[180:183], v[116:119], v[136:139]
    ds_read_b128 v[196:199], v225 offset:36864
    v_mfma_f32_16x16x32_bf16 v[128:131], v[180:183], v[100:103], v[128:131]
    s_add_u32 m0, s37, 0x12000
    s_xor_b32 s38, s36, 0x1000
    buffer_load_dwordx4 v246, s[20:23], s38 offen offset:0 nt lds
    s_waitcnt lgkmcnt(7)
    v_mfma_f32_16x16x32_bf16 v[128:131], v[184:187], v[104:107], v[128:131]
    ds_read_b128 v[176:179], v226 offset:36864
    v_mfma_f32_16x16x32_bf16 v[136:139], v[184:187], v[120:123], v[136:139]
    v_max_f32_e64 v250, v208, v212
    v_cmp_nle_f32_e64 s[42:43], v250, s40
    s_waitcnt lgkmcnt(7)
    v_mfma_f32_16x16x32_bf16 v[136:139], v[188:191], v[124:127], v[136:139]
    ds_read_b128 v[180:183], v227 offset:36864
    v_mfma_f32_16x16x32_bf16 v[128:131], v[188:191], v[108:111], v[128:131]
    s_cmp_lg_u64 s[42:43], 0
    s_cbranch_scc1 L_stublead9
L_retlead9:
    s_waitcnt lgkmcnt(4)
    s_add_u32 m0, s58, 0x0
    s_nop 0
    buffer_load_dwordx4 v240, s[12:15], s31 offen offset:0 nt lds
    s_waitcnt lgkmcnt(3)
    v_mfma_f32_16x16x32_bf16 v[132:135], v[192:195], v[96:99], 0
    ds_read_b64_tr_b16 v[184:185], v228 offset:24576
    v_mfma_f32_16x16x32_bf16 v[140:143], v[192:195], v[112:115], 0
    ds_read_b64_tr_b16 v[186:187], v228 offset:28672
    s_waitcnt lgkmcnt(4)
    v_mfma_f32_16x16x32_bf16 v[140:143], v[196:199], v[116:119], v[140:143]
    ds_read_b64_tr_b16 v[188:189], v229 offset:24576
    v_mfma_f32_16x16x32_bf16 v[132:135], v[196:199], v[100:103], v[132:135]
    ds_read_b64_tr_b16 v[190:191], v229 offset:28672
    s_waitcnt lgkmcnt(5)
    v_mfma_f32_16x16x32_bf16 v[132:135], v[176:179], v[104:107], v[132:135]
    ds_read_b64_tr_b16 v[192:193], v230 offset:24576
    v_mfma_f32_16x16x32_bf16 v[140:143], v[176:179], v[120:123], v[140:143]
    ds_read_b64_tr_b16 v[194:195], v230 offset:28672
    s_waitcnt lgkmcnt(6)
    v_mfma_f32_16x16x32_bf16 v[140:143], v[180:183], v[124:127], v[140:143]
    ds_read_b64_tr_b16 v[176:177], v231 offset:24576
    v_mfma_f32_16x16x32_bf16 v[132:135], v[180:183], v[108:111], v[132:135]
    ds_read_b64_tr_b16 v[178:179], v231 offset:28672
    s_waitcnt lgkmcnt(6)
    v_mfma_f32_16x16x32_bf16 v[0:3], v[184:187], v[160:163], v[0:3]
    ds_read_b64_tr_b16 v[180:181], v232 offset:24576
    v_mfma_f32_16x16x32_bf16 v[32:35], v[184:187], v[164:167], v[32:35]
    ds_read_b64_tr_b16 v[182:183], v232 offset:28672
    s_waitcnt lgkmcnt(6)
    v_mfma_f32_16x16x32_bf16 v[36:39], v[188:191], v[164:167], v[36:39]
    ds_read_b64_tr_b16 v[184:185], v233 offset:24576
    v_mfma_f32_16x16x32_bf16 v[4:7], v[188:191], v[160:163], v[4:7]
    ds_read_b64_tr_b16 v[186:187], v233 offset:28672
    s_waitcnt lgkmcnt(6)
    v_mfma_f32_16x16x32_bf16 v[8:11], v[192:195], v[160:163], v[8:11]
    ds_read_b64_tr_b16 v[196:197], v234 offset:24576
    v_mfma_f32_16x16x32_bf16 v[40:43], v[192:195], v[164:167], v[40:43]
    ds_read_b64_tr_b16 v[198:199], v234 offset:28672
    s_waitcnt lgkmcnt(6)
    v_mfma_f32_16x16x32_bf16 v[44:47], v[176:179], v[164:167], v[44:47]
    ds_read_b64_tr_b16 v[192:193], v235 offset:24576
    v_mfma_f32_16x16x32_bf16 v[12:15], v[176:179], v[160:163], v[12:15]
    ds_read_b64_tr_b16 v[194:195], v235 offset:28672
    s_waitcnt lgkmcnt(6)
    v_mfma_f32_16x16x32_bf16 v[16:19], v[180:183], v[160:163], v[16:19]
    v_mfma_f32_16x16x32_bf16 v[48:51], v[180:183], v[164:167], v[48:51]
    s_waitcnt lgkmcnt(4)
    v_mfma_f32_16x16x32_bf16 v[52:55], v[184:187], v[164:167], v[52:55]
    v_mfma_f32_16x16x32_bf16 v[20:23], v[184:187], v[160:163], v[20:23]
    s_waitcnt lgkmcnt(2)
    v_mfma_f32_16x16x32_bf16 v[24:27], v[196:199], v[160:163], v[24:27]
    ds_read_b128 v[176:179], v224 offset:40960
    v_mfma_f32_16x16x32_bf16 v[56:59], v[196:199], v[164:167], v[56:59]
    ds_read_b128 v[180:183], v225 offset:40960
    s_waitcnt lgkmcnt(2)
    v_mfma_f32_16x16x32_bf16 v[60:63], v[192:195], v[164:167], v[60:63]
    ds_read_b128 v[184:187], v226 offset:40960
    v_mfma_f32_16x16x32_bf16 v[28:31], v[192:195], v[160:163], v[28:31]
    ds_read_b128 v[188:191], v227 offset:40960
    s_setprio 0
.p2align 3
    s_nop 0
    s_barrier
    s_setprio 2
    s_nop 0
    v_fmamk_f32 v168, v128, 0x3e0293ee, v248
    v_fmamk_f32 v169, v129, 0x3e0293ee, v248
    buffer_store_dwordx4 v[220:223], v244, s[24:27], s34 offen offset:0 sc0 sc1
    v_fmamk_f32 v170, v130, 0x3e0293ee, v248
    v_fmamk_f32 v171, v131, 0x3e0293ee, v248
    v_exp_f32 v168, v168
    v_exp_f32 v169, v169
    v_exp_f32 v170, v170
    v_exp_f32 v171, v171
    v_fmamk_f32 v172, v136, 0x3e0293ee, v249
    v_fmamk_f32 v173, v137, 0x3e0293ee, v249
    v_fmamk_f32 v174, v138, 0x3e0293ee, v249
    v_fmamk_f32 v175, v139, 0x3e0293ee, v249
    v_cvt_pk_bf16_f32 v160, v168, v169
    v_cvt_pk_bf16_f32 v161, v170, v171
    v_exp_f32 v172, v172
    v_exp_f32 v173, v173
    v_exp_f32 v174, v174
    v_exp_f32 v175, v175
    v_fmamk_f32 v168, v132, 0x3e0293ee, v248
    v_fmamk_f32 v169, v133, 0x3e0293ee, v248
    v_fmamk_f32 v170, v134, 0x3e0293ee, v248
    v_fmamk_f32 v171, v135, 0x3e0293ee, v248
    v_cvt_pk_bf16_f32 v164, v172, v173
    v_cvt_pk_bf16_f32 v165, v174, v175
    v_exp_f32 v168, v168
    v_exp_f32 v169, v169
    v_exp_f32 v170, v170
    v_exp_f32 v171, v171
    v_fmamk_f32 v172, v140, 0x3e0293ee, v249
    v_fmamk_f32 v173, v141, 0x3e0293ee, v249
    v_fmamk_f32 v174, v142, 0x3e0293ee, v249
    v_fmamk_f32 v175, v143, 0x3e0293ee, v249
    v_cvt_pk_bf16_f32 v162, v168, v169
    v_cvt_pk_bf16_f32 v163, v170, v171
    v_exp_f32 v172, v172
    v_exp_f32 v173, v173
    v_exp_f32 v174, v174
    v_exp_f32 v175, v175
    v_cvt_pk_bf16_f32 v166, v172, v173
    v_cvt_pk_bf16_f32 v167, v174, v175
    s_waitcnt vmcnt(1)
    v_mfma_f32_16x16x32_bf16 v[200:203], v[216:219], v[160:163], v[208:211]
    v_mfma_f32_16x16x32_bf16 v[204:207], v[216:219], v[164:167], v[212:215]
    s_waitcnt lgkmcnt(3)
    v_mfma_f32_16x16x32_bf16 v[144:147], v[176:179], v[96:99], 0
    s_setprio 3
    ds_read_b128 v[192:195], v224 offset:45056
    v_mfma_f32_16x16x32_bf16 v[152:155], v[176:179], v[112:115], 0
    s_waitcnt lgkmcnt(3)
    v_mfma_f32_16x16x32_bf16 v[152:155], v[180:183], v[116:119], v[152:155]
    ds_read_b128 v[196:199], v225 offset:45056
    v_mfma_f32_16x16x32_bf16 v[144:147], v[180:183], v[100:103], v[144:147]
    s_add_u32 m0, s58, 0x400
    s_nop 0
    buffer_load_dwordx4 v241, s[12:15], s31 offen offset:0 nt lds
    s_waitcnt lgkmcnt(3)
    v_mfma_f32_16x16x32_bf16 v[144:147], v[184:187], v[104:107], v[144:147]
    ds_read_b128 v[176:179], v226 offset:45056
    v_mfma_f32_16x16x32_bf16 v[152:155], v[184:187], v[120:123], v[152:155]
    v_max_f32_e64 v250, v200, v204
    v_cmp_nle_f32_e64 s[42:43], v250, s40
    s_waitcnt lgkmcnt(3)
    v_mfma_f32_16x16x32_bf16 v[152:155], v[188:191], v[124:127], v[152:155]
    ds_read_b128 v[180:183], v227 offset:45056
    v_mfma_f32_16x16x32_bf16 v[144:147], v[188:191], v[108:111], v[144:147]
    s_cmp_lg_u64 s[42:43], 0
    s_cbranch_scc1 L_stublead10
L_retlead10:
    s_add_u32 m0, s37, 0x6000
    s_xor_b32 s38, s36, 0x3000
    buffer_load_dwordx4 v245, s[16:19], s38 offen offset:0 nt lds
    s_waitcnt lgkmcnt(3)
    v_mfma_f32_16x16x32_bf16 v[148:151], v[192:195], v[96:99], 0
    ds_read_b64_tr_b16 v[184:185], v228 offset:32768
    v_mfma_f32_16x16x32_bf16 v[156:159], v[192:195], v[112:115], 0
    ds_read_b64_tr_b16 v[186:187], v228 offset:36864
    s_waitcnt lgkmcnt(4)
    v_mfma_f32_16x16x32_bf16 v[156:159], v[196:199], v[116:119], v[156:159]
    ds_read_b64_tr_b16 v[188:189], v229 offset:32768
    v_mfma_f32_16x16x32_bf16 v[148:151], v[196:199], v[100:103], v[148:151]
    ds_read_b64_tr_b16 v[190:191], v229 offset:36864
    s_waitcnt lgkmcnt(5)
    v_mfma_f32_16x16x32_bf16 v[148:151], v[176:179], v[104:107], v[148:151]
    ds_read_b64_tr_b16 v[192:193], v230 offset:32768
    v_mfma_f32_16x16x32_bf16 v[156:159], v[176:179], v[120:123], v[156:159]
    ds_read_b64_tr_b16 v[194:195], v230 offset:36864
    s_waitcnt lgkmcnt(6)
    v_mfma_f32_16x16x32_bf16 v[156:159], v[180:183], v[124:127], v[156:159]
    ds_read_b64_tr_b16 v[176:177], v231 offset:32768
    v_mfma_f32_16x16x32_bf16 v[148:151], v[180:183], v[108:111], v[148:151]
    ds_read_b64_tr_b16 v[178:179], v231 offset:36864
    s_waitcnt lgkmcnt(6)
    v_mfma_f32_16x16x32_bf16 v[0:3], v[184:187], v[160:163], v[0:3]
    ds_read_b64_tr_b16 v[180:181], v232 offset:32768
    v_mfma_f32_16x16x32_bf16 v[32:35], v[184:187], v[164:167], v[32:35]
    ds_read_b64_tr_b16 v[182:183], v232 offset:36864
    s_waitcnt lgkmcnt(6)
    v_mfma_f32_16x16x32_bf16 v[36:39], v[188:191], v[164:167], v[36:39]
    ds_read_b64_tr_b16 v[184:185], v233 offset:32768
    v_mfma_f32_16x16x32_bf16 v[4:7], v[188:191], v[160:163], v[4:7]
    ds_read_b64_tr_b16 v[186:187], v233 offset:36864
    s_waitcnt lgkmcnt(6)
    v_mfma_f32_16x16x32_bf16 v[8:11], v[192:195], v[160:163], v[8:11]
    ds_read_b64_tr_b16 v[196:197], v234 offset:32768
    v_mfma_f32_16x16x32_bf16 v[40:43], v[192:195], v[164:167], v[40:43]
    ds_read_b64_tr_b16 v[198:199], v234 offset:36864
    s_waitcnt lgkmcnt(6)
    v_mfma_f32_16x16x32_bf16 v[44:47], v[176:179], v[164:167], v[44:47]
    ds_read_b64_tr_b16 v[192:193], v235 offset:32768
    v_mfma_f32_16x16x32_bf16 v[12:15], v[176:179], v[160:163], v[12:15]
    ds_read_b64_tr_b16 v[194:195], v235 offset:36864
    s_waitcnt lgkmcnt(6)
    v_mfma_f32_16x16x32_bf16 v[16:19], v[180:183], v[160:163], v[16:19]
    v_mfma_f32_16x16x32_bf16 v[48:51], v[180:183], v[164:167], v[48:51]
    s_waitcnt lgkmcnt(4)
    v_mfma_f32_16x16x32_bf16 v[52:55], v[184:187], v[164:167], v[52:55]
    v_mfma_f32_16x16x32_bf16 v[20:23], v[184:187], v[160:163], v[20:23]
    s_waitcnt lgkmcnt(2)
    v_mfma_f32_16x16x32_bf16 v[24:27], v[196:199], v[160:163], v[24:27]
    ds_read_b128 v[176:179], v224 offset:49152
    v_mfma_f32_16x16x32_bf16 v[56:59], v[196:199], v[164:167], v[56:59]
    ds_read_b128 v[180:183], v225 offset:49152
    s_waitcnt lgkmcnt(2)
    v_mfma_f32_16x16x32_bf16 v[60:63], v[192:195], v[164:167], v[60:63]
    ds_read_b128 v[184:187], v226 offset:49152
    v_mfma_f32_16x16x32_bf16 v[28:31], v[192:195], v[160:163], v[28:31]
    ds_read_b128 v[188:191], v227 offset:49152
    s_setprio 0
.p2align 3
    s_nop 0
    s_barrier
    s_setprio 2
    s_nop 0
    v_fmamk_f32 v168, v144, 0x3e0293ee, v248
    v_fmamk_f32 v169, v145, 0x3e0293ee, v248
    v_permlane16_swap_b32 v80, v82
    v_permlane16_swap_b32 v81, v83
    v_fmamk_f32 v170, v146, 0x3e0293ee, v248
    v_fmamk_f32 v171, v147, 0x3e0293ee, v248
    v_exp_f32 v168, v168
    v_exp_f32 v169, v169
    v_permlane16_swap_b32 v84, v86
    v_permlane16_swap_b32 v85, v87
    v_exp_f32 v170, v170
    v_exp_f32 v171, v171
    v_fmamk_f32 v172, v152, 0x3e0293ee, v249
    v_fmamk_f32 v173, v153, 0x3e0293ee, v249
    v_cndmask_b32_dpp v220, v84, v80, vcc quad_perm:[1,0,3,2] row_mask:0xf bank_mask:0xf
    v_cndmask_b32_dpp v221, v85, v81, vcc quad_perm:[1,0,3,2] row_mask:0xf bank_mask:0xf
    v_fmamk_f32 v174, v154, 0x3e0293ee, v249
    v_fmamk_f32 v175, v155, 0x3e0293ee, v249
    v_cvt_pk_bf16_f32 v160, v168, v169
    v_cvt_pk_bf16_f32 v161, v170, v171
    v_cndmask_b32_dpp v222, v86, v82, vcc quad_perm:[1,0,3,2] row_mask:0xf bank_mask:0xf
    v_cndmask_b32_dpp v223, v87, v83, vcc quad_perm:[1,0,3,2] row_mask:0xf bank_mask:0xf
    s_not_b64 vcc, vcc
    s_nop 0
    v_exp_f32 v172, v172
    v_exp_f32 v173, v173
    v_exp_f32 v174, v174
    v_exp_f32 v175, v175
    v_cndmask_b32_dpp v84, v80, v84, vcc quad_perm:[1,0,3,2] row_mask:0xf bank_mask:0xf
    v_cndmask_b32_dpp v85, v81, v85, vcc quad_perm:[1,0,3,2] row_mask:0xf bank_mask:0xf
    v_fmamk_f32 v168, v148, 0x3e0293ee, v248
    v_fmamk_f32 v169, v149, 0x3e0293ee, v248
    v_fmamk_f32 v170, v150, 0x3e0293ee, v248
    v_fmamk_f32 v171, v151, 0x3e0293ee, v248
    v_cndmask_b32_dpp v86, v82, v86, vcc quad_perm:[1,0,3,2] row_mask:0xf bank_mask:0xf
    v_cndmask_b32_dpp v87, v83, v87, vcc quad_perm:[1,0,3,2] row_mask:0xf bank_mask:0xf
    s_not_b64 vcc, vcc
    s_nop 0
    v_cvt_pk_bf16_f32 v164, v172, v173
    v_cvt_pk_bf16_f32 v165, v174, v175
    v_exp_f32 v168, v168
    v_exp_f32 v169, v169
    buffer_store_dwordx4 v[84:87], v244, s[24:27], s35 offen offset:256 sc0 sc1
    v_exp_f32 v170, v170
    v_exp_f32 v171, v171
    v_fmamk_f32 v172, v156, 0x3e0293ee, v249
    v_fmamk_f32 v173, v157, 0x3e0293ee, v249
    v_fmamk_f32 v174, v158, 0x3e0293ee, v249
    v_fmamk_f32 v175, v159, 0x3e0293ee, v249
    v_cvt_pk_bf16_f32 v162, v168, v169
    v_cvt_pk_bf16_f32 v163, v170, v171
    v_exp_f32 v172, v172
    v_exp_f32 v173, v173
    v_exp_f32 v174, v174
    v_exp_f32 v175, v175
    v_cvt_pk_bf16_f32 v166, v172, v173
    v_cvt_pk_bf16_f32 v167, v174, v175
    s_waitcnt vmcnt(1)
    v_mfma_f32_16x16x32_bf16 v[208:211], v[216:219], v[160:163], v[200:203]
    v_mfma_f32_16x16x32_bf16 v[212:215], v[216:219], v[164:167], v[204:207]
    s_waitcnt lgkmcnt(3)
    v_mfma_f32_16x16x32_bf16 v[128:131], v[176:179], v[96:99], 0
    s_setprio 3
    ds_read_b128 v[192:195], v224 offset:53248
    v_mfma_f32_16x16x32_bf16 v[136:139], v[176:179], v[112:115], 0
    s_waitcnt lgkmcnt(3)
    v_mfma_f32_16x16x32_bf16 v[136:139], v[180:183], v[116:119], v[136:139]
    ds_read_b128 v[196:199], v225 offset:53248
    v_mfma_f32_16x16x32_bf16 v[128:131], v[180:183], v[100:103], v[128:131]
    s_add_u32 m0, s58, 0x800
    s_nop 0
    buffer_load_dwordx4 v242, s[12:15], s31 offen offset:0 nt lds
    s_waitcnt lgkmcnt(3)
    v_mfma_f32_16x16x32_bf16 v[128:131], v[184:187], v[104:107], v[128:131]
    ds_read_b128 v[176:179], v226 offset:53248
    v_mfma_f32_16x16x32_bf16 v[136:139], v[184:187], v[120:123], v[136:139]
    v_max_f32_e64 v250, v208, v212
    v_cmp_nle_f32_e64 s[42:43], v250, s40
    s_waitcnt lgkmcnt(3)
    v_mfma_f32_16x16x32_bf16 v[136:139], v[188:191], v[124:127], v[136:139]
    ds_read_b128 v[180:183], v227 offset:53248
    v_mfma_f32_16x16x32_bf16 v[128:131], v[188:191], v[108:111], v[128:131]
    s_cmp_lg_u64 s[42:43], 0
    s_cbranch_scc1 L_stublead11
L_retlead11:
    s_add_u32 m0, s37, 0x14000
    s_xor_b32 s38, s36, 0x2000
    buffer_load_dwordx4 v246, s[20:23], s38 offen offset:0 nt lds
    s_waitcnt lgkmcnt(3)
    v_mfma_f32_16x16x32_bf16 v[132:135], v[192:195], v[96:99], 0
    ds_read_b64_tr_b16 v[184:185], v228 offset:40960
    v_mfma_f32_16x16x32_bf16 v[140:143], v[192:195], v[112:115], 0
    ds_read_b64_tr_b16 v[186:187], v228 offset:45056
    s_waitcnt lgkmcnt(4)
    v_mfma_f32_16x16x32_bf16 v[140:143], v[196:199], v[116:119], v[140:143]
    ds_read_b64_tr_b16 v[188:189], v229 offset:40960
    v_mfma_f32_16x16x32_bf16 v[132:135], v[196:199], v[100:103], v[132:135]
    ds_read_b64_tr_b16 v[190:191], v229 offset:45056
    s_waitcnt lgkmcnt(5)
    v_mfma_f32_16x16x32_bf16 v[132:135], v[176:179], v[104:107], v[132:135]
    ds_read_b64_tr_b16 v[192:193], v230 offset:40960
    v_mfma_f32_16x16x32_bf16 v[140:143], v[176:179], v[120:123], v[140:143]
    ds_read_b64_tr_b16 v[194:195], v230 offset:45056
    s_waitcnt lgkmcnt(6)
    v_mfma_f32_16x16x32_bf16 v[140:143], v[180:183], v[124:127], v[140:143]
    ds_read_b64_tr_b16 v[176:177], v231 offset:40960
    v_mfma_f32_16x16x32_bf16 v[132:135], v[180:183], v[108:111], v[132:135]
    ds_read_b64_tr_b16 v[178:179], v231 offset:45056
    s_waitcnt lgkmcnt(6)
    v_mfma_f32_16x16x32_bf16 v[0:3], v[184:187], v[160:163], v[0:3]
    ds_read_b64_tr_b16 v[180:181], v232 offset:40960
    v_mfma_f32_16x16x32_bf16 v[32:35], v[184:187], v[164:167], v[32:35]
    ds_read_b64_tr_b16 v[182:183], v232 offset:45056
    s_waitcnt lgkmcnt(6)
    v_mfma_f32_16x16x32_bf16 v[36:39], v[188:191], v[164:167], v[36:39]
    ds_read_b64_tr_b16 v[184:185], v233 offset:40960
    v_mfma_f32_16x16x32_bf16 v[4:7], v[188:191], v[160:163], v[4:7]
    ds_read_b64_tr_b16 v[186:187], v233 offset:45056
    s_waitcnt lgkmcnt(6)
    v_mfma_f32_16x16x32_bf16 v[8:11], v[192:195], v[160:163], v[8:11]
    ds_read_b64_tr_b16 v[196:197], v234 offset:40960
    v_mfma_f32_16x16x32_bf16 v[40:43], v[192:195], v[164:167], v[40:43]
    ds_read_b64_tr_b16 v[198:199], v234 offset:45056
    s_waitcnt lgkmcnt(6)
    v_mfma_f32_16x16x32_bf16 v[44:47], v[176:179], v[164:167], v[44:47]
    ds_read_b64_tr_b16 v[192:193], v235 offset:40960
    v_mfma_f32_16x16x32_bf16 v[12:15], v[176:179], v[160:163], v[12:15]
    ds_read_b64_tr_b16 v[194:195], v235 offset:45056
    s_waitcnt lgkmcnt(6)
    v_mfma_f32_16x16x32_bf16 v[16:19], v[180:183], v[160:163], v[16:19]
    v_mfma_f32_16x16x32_bf16 v[48:51], v[180:183], v[164:167], v[48:51]
    s_waitcnt lgkmcnt(4)
    v_mfma_f32_16x16x32_bf16 v[52:55], v[184:187], v[164:167], v[52:55]
    v_mfma_f32_16x16x32_bf16 v[20:23], v[184:187], v[160:163], v[20:23]
    s_waitcnt lgkmcnt(2)
    v_mfma_f32_16x16x32_bf16 v[24:27], v[196:199], v[160:163], v[24:27]
    ds_read_b128 v[176:179], v224 offset:57344
    v_mfma_f32_16x16x32_bf16 v[56:59], v[196:199], v[164:167], v[56:59]
    ds_read_b128 v[180:183], v225 offset:57344
    s_waitcnt lgkmcnt(2)
    v_mfma_f32_16x16x32_bf16 v[60:63], v[192:195], v[164:167], v[60:63]
    ds_read_b128 v[184:187], v226 offset:57344
    v_mfma_f32_16x16x32_bf16 v[28:31], v[192:195], v[160:163], v[28:31]
    ds_read_b128 v[188:191], v227 offset:57344
    s_setprio 0
.p2align 3
    s_waitcnt vmcnt(15)
    s_barrier
    s_setprio 2
    s_nop 0
    v_fmamk_f32 v168, v128, 0x3e0293ee, v248
    v_fmamk_f32 v169, v129, 0x3e0293ee, v248
    v_permlane16_swap_b32 v88, v90
    v_permlane16_swap_b32 v89, v91
    v_fmamk_f32 v170, v130, 0x3e0293ee, v248
    v_fmamk_f32 v171, v131, 0x3e0293ee, v248
    v_exp_f32 v168, v168
    v_exp_f32 v169, v169
    v_permlane16_swap_b32 v92, v94
    v_permlane16_swap_b32 v93, v95
    v_exp_f32 v170, v170
    v_exp_f32 v171, v171
    v_fmamk_f32 v172, v136, 0x3e0293ee, v249
    v_fmamk_f32 v173, v137, 0x3e0293ee, v249
    v_cndmask_b32_dpp v80, v92, v88, vcc quad_perm:[1,0,3,2] row_mask:0xf bank_mask:0xf
    v_cndmask_b32_dpp v81, v93, v89, vcc quad_perm:[1,0,3,2] row_mask:0xf bank_mask:0xf
    v_fmamk_f32 v174, v138, 0x3e0293ee, v249
    v_fmamk_f32 v175, v139, 0x3e0293ee, v249
    v_cvt_pk_bf16_f32 v160, v168, v169
    v_cvt_pk_bf16_f32 v161, v170, v171
    v_cndmask_b32_dpp v82, v94, v90, vcc quad_perm:[1,0,3,2] row_mask:0xf bank_mask:0xf
    v_cndmask_b32_dpp v83, v95, v91, vcc quad_perm:[1,0,3,2] row_mask:0xf bank_mask:0xf
    s_not_b64 vcc, vcc
    s_nop 0
    v_exp_f32 v172, v172
    v_exp_f32 v173, v173
    v_exp_f32 v174, v174
    v_exp_f32 v175, v175
    v_cndmask_b32_dpp v92, v88, v92, vcc quad_perm:[1,0,3,2] row_mask:0xf bank_mask:0xf
    v_cndmask_b32_dpp v93, v89, v93, vcc quad_perm:[1,0,3,2] row_mask:0xf bank_mask:0xf
    v_fmamk_f32 v168, v132, 0x3e0293ee, v248
    v_fmamk_f32 v169, v133, 0x3e0293ee, v248
    v_fmamk_f32 v170, v134, 0x3e0293ee, v248
    v_fmamk_f32 v171, v135, 0x3e0293ee, v248
    v_cndmask_b32_dpp v94, v90, v94, vcc quad_perm:[1,0,3,2] row_mask:0xf bank_mask:0xf
    v_cndmask_b32_dpp v95, v91, v95, vcc quad_perm:[1,0,3,2] row_mask:0xf bank_mask:0xf
    s_not_b64 vcc, vcc
    s_nop 0
    v_cvt_pk_bf16_f32 v164, v172, v173
    v_cvt_pk_bf16_f32 v165, v174, v175
    v_exp_f32 v168, v168
    v_exp_f32 v169, v169
    buffer_store_dwordx4 v[80:83], v244, s[24:27], s35 offen offset:128 sc0 sc1
    v_exp_f32 v170, v170
    v_exp_f32 v171, v171
    v_fmamk_f32 v172, v140, 0x3e0293ee, v249
    v_fmamk_f32 v173, v141, 0x3e0293ee, v249
    v_fmamk_f32 v174, v142, 0x3e0293ee, v249
    v_fmamk_f32 v175, v143, 0x3e0293ee, v249
    v_cvt_pk_bf16_f32 v162, v168, v169
    v_cvt_pk_bf16_f32 v163, v170, v171
    v_exp_f32 v172, v172
    v_exp_f32 v173, v173
    v_exp_f32 v174, v174
    v_exp_f32 v175, v175
    v_cvt_pk_bf16_f32 v166, v172, v173
    v_cvt_pk_bf16_f32 v167, v174, v175
    s_waitcnt vmcnt(1)
    v_mfma_f32_16x16x32_bf16 v[200:203], v[216:219], v[160:163], v[208:211]
    v_mfma_f32_16x16x32_bf16 v[204:207], v[216:219], v[164:167], v[212:215]
    s_waitcnt lgkmcnt(3)
    v_mfma_f32_16x16x32_bf16 v[144:147], v[176:179], v[96:99], 0
    s_setprio 3
    ds_read_b128 v[192:195], v224 offset:61440
    v_mfma_f32_16x16x32_bf16 v[152:155], v[176:179], v[112:115], 0
    s_waitcnt lgkmcnt(3)
    v_mfma_f32_16x16x32_bf16 v[152:155], v[180:183], v[116:119], v[152:155]
    ds_read_b128 v[196:199], v225 offset:61440
    v_mfma_f32_16x16x32_bf16 v[144:147], v[180:183], v[100:103], v[144:147]
    s_add_u32 m0, s58, 0xc00
    s_nop 0
    buffer_load_dwordx4 v243, s[12:15], s31 offen offset:0 nt lds
    s_waitcnt lgkmcnt(3)
    v_mfma_f32_16x16x32_bf16 v[144:147], v[184:187], v[104:107], v[144:147]
    ds_read_b128 v[176:179], v226 offset:61440
    v_mfma_f32_16x16x32_bf16 v[152:155], v[184:187], v[120:123], v[152:155]
    v_max_f32_e64 v250, v200, v204
    v_cmp_nle_f32_e64 s[42:43], v250, s40
    s_waitcnt lgkmcnt(3)
    v_mfma_f32_16x16x32_bf16 v[152:155], v[188:191], v[124:127], v[152:155]
    ds_read_b128 v[180:183], v227 offset:61440
    v_mfma_f32_16x16x32_bf16 v[144:147], v[188:191], v[108:111], v[144:147]
    s_cmp_lg_u64 s[42:43], 0
    s_cbranch_scc1 L_stublead12
L_retlead12:
    s_add_u32 m0, s37, 0x8000
    s_xor_b32 s38, s36, 0x4000
    buffer_load_dwordx4 v245, s[16:19], s38 offen offset:0 nt lds
    s_waitcnt lgkmcnt(3)
    v_mfma_f32_16x16x32_bf16 v[148:151], v[192:195], v[96:99], 0
    ds_read_b64_tr_b16 v[184:185], v228 offset:49152
    v_mfma_f32_16x16x32_bf16 v[156:159], v[192:195], v[112:115], 0
    ds_read_b64_tr_b16 v[186:187], v228 offset:53248
    s_waitcnt lgkmcnt(4)
    v_mfma_f32_16x16x32_bf16 v[156:159], v[196:199], v[116:119], v[156:159]
    ds_read_b64_tr_b16 v[188:189], v229 offset:49152
    v_mfma_f32_16x16x32_bf16 v[148:151], v[196:199], v[100:103], v[148:151]
    ds_read_b64_tr_b16 v[190:191], v229 offset:53248
    s_waitcnt lgkmcnt(5)
    v_mfma_f32_16x16x32_bf16 v[148:151], v[176:179], v[104:107], v[148:151]
    ds_read_b64_tr_b16 v[192:193], v230 offset:49152
    v_mfma_f32_16x16x32_bf16 v[156:159], v[176:179], v[120:123], v[156:159]
    ds_read_b64_tr_b16 v[194:195], v230 offset:53248
    s_waitcnt lgkmcnt(6)
    v_mfma_f32_16x16x32_bf16 v[156:159], v[180:183], v[124:127], v[156:159]
    ds_read_b64_tr_b16 v[176:177], v231 offset:49152
    v_mfma_f32_16x16x32_bf16 v[148:151], v[180:183], v[108:111], v[148:151]
    ds_read_b64_tr_b16 v[178:179], v231 offset:53248
    s_waitcnt lgkmcnt(6)
    v_mfma_f32_16x16x32_bf16 v[0:3], v[184:187], v[160:163], v[0:3]
    ds_read_b64_tr_b16 v[180:181], v232 offset:49152
    v_mfma_f32_16x16x32_bf16 v[32:35], v[184:187], v[164:167], v[32:35]
    ds_read_b64_tr_b16 v[182:183], v232 offset:53248
    s_waitcnt lgkmcnt(6)
    v_mfma_f32_16x16x32_bf16 v[36:39], v[188:191], v[164:167], v[36:39]
    ds_read_b64_tr_b16 v[184:185], v233 offset:49152
    v_mfma_f32_16x16x32_bf16 v[4:7], v[188:191], v[160:163], v[4:7]
    ds_read_b64_tr_b16 v[186:187], v233 offset:53248
    s_waitcnt lgkmcnt(6)
    v_mfma_f32_16x16x32_bf16 v[8:11], v[192:195], v[160:163], v[8:11]
    ds_read_b64_tr_b16 v[196:197], v234 offset:49152
    v_mfma_f32_16x16x32_bf16 v[40:43], v[192:195], v[164:167], v[40:43]
    ds_read_b64_tr_b16 v[198:199], v234 offset:53248
    s_waitcnt lgkmcnt(6)
    v_mfma_f32_16x16x32_bf16 v[44:47], v[176:179], v[164:167], v[44:47]
    ds_read_b64_tr_b16 v[192:193], v235 offset:49152
    v_mfma_f32_16x16x32_bf16 v[12:15], v[176:179], v[160:163], v[12:15]
    ds_read_b64_tr_b16 v[194:195], v235 offset:53248
    s_waitcnt lgkmcnt(6)
    v_mfma_f32_16x16x32_bf16 v[16:19], v[180:183], v[160:163], v[16:19]
    v_mfma_f32_16x16x32_bf16 v[48:51], v[180:183], v[164:167], v[48:51]
    s_waitcnt lgkmcnt(4)
    v_mfma_f32_16x16x32_bf16 v[52:55], v[184:187], v[164:167], v[52:55]
    v_mfma_f32_16x16x32_bf16 v[20:23], v[184:187], v[160:163], v[20:23]
    s_waitcnt lgkmcnt(2)
    v_mfma_f32_16x16x32_bf16 v[24:27], v[196:199], v[160:163], v[24:27]
    ds_read_b128 v[176:179], v224 offset:0
    v_mfma_f32_16x16x32_bf16 v[56:59], v[196:199], v[164:167], v[56:59]
    ds_read_b128 v[180:183], v225 offset:0
    s_waitcnt lgkmcnt(2)
    v_mfma_f32_16x16x32_bf16 v[60:63], v[192:195], v[164:167], v[60:63]
    ds_read_b128 v[184:187], v226 offset:0
    v_mfma_f32_16x16x32_bf16 v[28:31], v[192:195], v[160:163], v[28:31]
    ds_read_b128 v[188:191], v227 offset:0
    s_setprio 0
.p2align 3
    s_waitcnt vmcnt(16)
    s_barrier
    s_setprio 2
    s_nop 0
    v_fmamk_f32 v168, v144, 0x3e0293ee, v248
    v_fmamk_f32 v169, v145, 0x3e0293ee, v248
    buffer_store_dwordx4 v[92:95], v244, s[24:27], s35 offen offset:384 sc0 sc1
    v_fmamk_f32 v170, v146, 0x3e0293ee, v248
    v_fmamk_f32 v171, v147, 0x3e0293ee, v248
    v_exp_f32 v168, v168
    v_exp_f32 v169, v169
    v_exp_f32 v170, v170
    v_exp_f32 v171, v171
    v_fmamk_f32 v172, v152, 0x3e0293ee, v249
    v_fmamk_f32 v173, v153, 0x3e0293ee, v249
    v_fmamk_f32 v174, v154, 0x3e0293ee, v249
    v_fmamk_f32 v175, v155, 0x3e0293ee, v249
    v_cvt_pk_bf16_f32 v160, v168, v169
    v_cvt_pk_bf16_f32 v161, v170, v171
    v_exp_f32 v172, v172
    v_exp_f32 v173, v173
    v_exp_f32 v174, v174
    v_exp_f32 v175, v175
    v_fmamk_f32 v168, v148, 0x3e0293ee, v248
    v_fmamk_f32 v169, v149, 0x3e0293ee, v248
    v_fmamk_f32 v170, v150, 0x3e0293ee, v248
    v_fmamk_f32 v171, v151, 0x3e0293ee, v248
    v_cvt_pk_bf16_f32 v164, v172, v173
    v_cvt_pk_bf16_f32 v165, v174, v175
    v_exp_f32 v168, v168
    v_exp_f32 v169, v169
    v_exp_f32 v170, v170
    v_exp_f32 v171, v171
    v_fmamk_f32 v172, v156, 0x3e0293ee, v249
    v_fmamk_f32 v173, v157, 0x3e0293ee, v249
    v_fmamk_f32 v174, v158, 0x3e0293ee, v249
    v_fmamk_f32 v175, v159, 0x3e0293ee, v249
    v_cvt_pk_bf16_f32 v162, v168, v169
    v_cvt_pk_bf16_f32 v163, v170, v171
    s_waitcnt vmcnt(2)
    s_nop 0
    ds_read_b128 v[80:83], v236 offset:0
    ds_read_b128 v[84:87], v237 offset:0
    ds_read_b128 v[88:91], v238 offset:0
    ds_read_b128 v[92:95], v239 offset:0
    v_exp_f32 v172, v172
    v_exp_f32 v173, v173
    v_exp_f32 v174, v174
    v_exp_f32 v175, v175
    v_cvt_pk_bf16_f32 v166, v172, v173
    v_cvt_pk_bf16_f32 v167, v174, v175
    s_waitcnt vmcnt(1)
    v_mfma_f32_16x16x32_bf16 v[208:211], v[216:219], v[160:163], v[200:203]
    v_mfma_f32_16x16x32_bf16 v[212:215], v[216:219], v[164:167], v[204:207]
    s_waitcnt lgkmcnt(7)
    v_mfma_f32_16x16x32_bf16 v[128:131], v[176:179], v[64:67], 0
    s_setprio 3
    ds_read_b128 v[192:195], v224 offset:4096
    s_waitcnt lgkmcnt(4)
    v_mfma_f32_16x16x32_bf16 v[136:139], v[176:179], v[80:83], 0
    s_waitcnt lgkmcnt(3)
    v_mfma_f32_16x16x32_bf16 v[136:139], v[180:183], v[84:87], v[136:139]
    ds_read_b128 v[196:199], v225 offset:4096
    v_mfma_f32_16x16x32_bf16 v[128:131], v[180:183], v[68:71], v[128:131]
    s_add_u32 m0, s37, 0xa000
    s_xor_b32 s38, s36, 0x5000
    buffer_load_dwordx4 v245, s[16:19], s38 offen offset:0 nt lds
    v_mfma_f32_16x16x32_bf16 v[128:131], v[184:187], v[72:75], v[128:131]
    ds_read_b128 v[176:179], v226 offset:4096
    s_waitcnt lgkmcnt(4)
    v_mfma_f32_16x16x32_bf16 v[136:139], v[184:187], v[88:91], v[136:139]
    v_max_f32_e64 v250, v208, v212
    v_cmp_nle_f32_e64 s[42:43], v250, s40
    s_waitcnt lgkmcnt(3)
    v_mfma_f32_16x16x32_bf16 v[136:139], v[188:191], v[92:95], v[136:139]
    ds_read_b128 v[180:183], v227 offset:4096
    v_mfma_f32_16x16x32_bf16 v[128:131], v[188:191], v[76:79], v[128:131]
    s_cmp_lg_u64 s[42:43], 0
    s_cbranch_scc1 L_stublead13
L_retlead13:
    s_add_u32 m0, s58, 0x0
    s_add_u32 s38, s32, 0x2000000
    buffer_load_dwordx4 v240, s[12:15], s38 offen offset:0 nt lds
    s_waitcnt lgkmcnt(3)
    v_mfma_f32_16x16x32_bf16 v[132:135], v[192:195], v[64:67], 0
    ds_read_b64_tr_b16 v[184:185], v228 offset:57344
    v_mfma_f32_16x16x32_bf16 v[140:143], v[192:195], v[80:83], 0
    ds_read_b64_tr_b16 v[186:187], v228 offset:61440
    s_waitcnt lgkmcnt(4)
    v_mfma_f32_16x16x32_bf16 v[140:143], v[196:199], v[84:87], v[140:143]
    ds_read_b64_tr_b16 v[188:189], v229 offset:57344
    v_mfma_f32_16x16x32_bf16 v[132:135], v[196:199], v[68:71], v[132:135]
    ds_read_b64_tr_b16 v[190:191], v229 offset:61440
    s_waitcnt lgkmcnt(5)
    v_mfma_f32_16x16x32_bf16 v[132:135], v[176:179], v[72:75], v[132:135]
    ds_read_b64_tr_b16 v[192:193], v230 offset:57344
    v_mfma_f32_16x16x32_bf16 v[140:143], v[176:179], v[88:91], v[140:143]
    ds_read_b64_tr_b16 v[194:195], v230 offset:61440
    s_waitcnt lgkmcnt(6)
    v_mfma_f32_16x16x32_bf16 v[140:143], v[180:183], v[92:95], v[140:143]
    ds_read_b64_tr_b16 v[176:177], v231 offset:57344
    v_mfma_f32_16x16x32_bf16 v[132:135], v[180:183], v[76:79], v[132:135]
    ds_read_b64_tr_b16 v[178:179], v231 offset:61440
    s_waitcnt lgkmcnt(6)
    v_mfma_f32_16x16x32_bf16 v[0:3], v[184:187], v[160:163], v[0:3]
    ds_read_b64_tr_b16 v[180:181], v232 offset:57344
    v_mfma_f32_16x16x32_bf16 v[32:35], v[184:187], v[164:167], v[32:35]
    ds_read_b64_tr_b16 v[182:183], v232 offset:61440
    s_waitcnt lgkmcnt(6)
    v_mfma_f32_16x16x32_bf16 v[36:39], v[188:191], v[164:167], v[36:39]
    ds_read_b64_tr_b16 v[184:185], v233 offset:57344
    v_mfma_f32_16x16x32_bf16 v[4:7], v[188:191], v[160:163], v[4:7]
    ds_read_b64_tr_b16 v[186:187], v233 offset:61440
    s_waitcnt lgkmcnt(6)
    v_mfma_f32_16x16x32_bf16 v[8:11], v[192:195], v[160:163], v[8:11]
    ds_read_b64_tr_b16 v[196:197], v234 offset:57344
    v_mfma_f32_16x16x32_bf16 v[40:43], v[192:195], v[164:167], v[40:43]
    ds_read_b64_tr_b16 v[198:199], v234 offset:61440
    s_waitcnt lgkmcnt(6)
    v_mfma_f32_16x16x32_bf16 v[44:47], v[176:179], v[164:167], v[44:47]
    ds_read_b64_tr_b16 v[192:193], v235 offset:57344
    v_mfma_f32_16x16x32_bf16 v[12:15], v[176:179], v[160:163], v[12:15]
    ds_read_b64_tr_b16 v[194:195], v235 offset:61440
    s_waitcnt lgkmcnt(6)
    v_mfma_f32_16x16x32_bf16 v[16:19], v[180:183], v[160:163], v[16:19]
    v_mfma_f32_16x16x32_bf16 v[48:51], v[180:183], v[164:167], v[48:51]
    s_waitcnt lgkmcnt(4)
    v_mfma_f32_16x16x32_bf16 v[52:55], v[184:187], v[164:167], v[52:55]
    v_mfma_f32_16x16x32_bf16 v[20:23], v[184:187], v[160:163], v[20:23]
    s_waitcnt lgkmcnt(2)
    v_mfma_f32_16x16x32_bf16 v[24:27], v[196:199], v[160:163], v[24:27]
    ds_read_b128 v[176:179], v224 offset:8192
    v_mfma_f32_16x16x32_bf16 v[56:59], v[196:199], v[164:167], v[56:59]
    ds_read_b128 v[180:183], v225 offset:8192
    s_waitcnt lgkmcnt(2)
    v_mfma_f32_16x16x32_bf16 v[60:63], v[192:195], v[164:167], v[60:63]
    ds_read_b128 v[184:187], v226 offset:8192
    v_mfma_f32_16x16x32_bf16 v[28:31], v[192:195], v[160:163], v[28:31]
    ds_read_b128 v[188:191], v227 offset:8192
    s_add_u32 s29, s29, 1
    s_mov_b32 s50, s35
    s_mov_b32 s54, s26
    s_mov_b32 s34, s32
    s_mov_b32 s32, s30
    s_xor_b32 s30, s30, 0x4000
    s_mov_b32 s35, s33
    s_mov_b32 s33, s31
    s_xor_b32 s31, s31, 0x4000
    s_setprio 0
.p2align 3
    v_rcp_f32 v208, v208
    v_rcp_f32 v212, v212
    buffer_store_dwordx4 v[220:223], v244, s[52:55], s50 offen offset:0 sc0 sc1
    v_max_f32_e64 v248, v128, v129
    v_max_f32_e64 v249, v136, v137
    v_max3_f32 v248, v248, v130, v131
    v_max3_f32 v249, v249, v138, v139
    v_max3_f32 v248, v248, v132, v133
    v_max3_f32 v249, v249, v140, v141
    v_max3_f32 v248, v248, v134, v135
    v_max3_f32 v249, v249, v142, v143
    s_nop 1
    v_permlane32_swap_b32 v248, v249
    v_max_f32 v248, v248, v249
    v_mov_b32 v249, v248
    s_nop 1
    v_permlane16_swap_b32 v248, v249
    v_max_f32 v248, v248, v249
    v_mul_f32 v248, 0xbe0293ee, v248
    v_mov_b32 v249, v248
    s_nop 1
    v_permlane32_swap_b32 v248, v249
.p2align 3
    v_fmamk_f32 v168, v128, 0x3e0293ee, v248
    v_fmamk_f32 v169, v129, 0x3e0293ee, v248
    v_fmamk_f32 v170, v130, 0x3e0293ee, v248
    v_fmamk_f32 v171, v131, 0x3e0293ee, v248
    v_exp_f32 v168, v168
    v_exp_f32 v169, v169
    v_exp_f32 v170, v170
    v_exp_f32 v171, v171
    v_fmamk_f32 v172, v136, 0x3e0293ee, v249
    v_fmamk_f32 v173, v137, 0x3e0293ee, v249
    v_fmamk_f32 v174, v138, 0x3e0293ee, v249
    v_fmamk_f32 v175, v139, 0x3e0293ee, v249
    s_setprio 2
    s_nop 0
    v_cvt_pk_bf16_f32 v160, v168, v169
    v_cvt_pk_bf16_f32 v161, v170, v171
    v_exp_f32 v172, v172
    v_exp_f32 v173, v173
    v_exp_f32 v174, v174
    v_exp_f32 v175, v175
    v_fmamk_f32 v168, v132, 0x3e0293ee, v248
    v_fmamk_f32 v169, v133, 0x3e0293ee, v248
    v_fmamk_f32 v170, v134, 0x3e0293ee, v248
    v_fmamk_f32 v171, v135, 0x3e0293ee, v248
    v_cvt_pk_bf16_f32 v164, v172, v173
    v_cvt_pk_bf16_f32 v165, v174, v175
    v_exp_f32 v168, v168
    v_exp_f32 v169, v169
    v_exp_f32 v170, v170
    v_exp_f32 v171, v171
    v_fmamk_f32 v172, v140, 0x3e0293ee, v249
    v_fmamk_f32 v173, v141, 0x3e0293ee, v249
    v_fmamk_f32 v174, v142, 0x3e0293ee, v249
    v_fmamk_f32 v175, v143, 0x3e0293ee, v249
    v_cvt_pk_bf16_f32 v162, v168, v169
    v_cvt_pk_bf16_f32 v163, v170, v171
    v_exp_f32 v172, v172
    v_exp_f32 v173, v173
    v_exp_f32 v174, v174
    v_exp_f32 v175, v175
    v_cvt_pk_bf16_f32 v166, v172, v173
    v_cvt_pk_bf16_f32 v167, v174, v175
    v_pk_mul_f32 v[0:1], v[0:1], v[208:209] op_sel_hi:[1,0]
    v_pk_mul_f32 v[2:3], v[2:3], v[208:209] op_sel_hi:[1,0]
    v_pk_mul_f32 v[4:5], v[4:5], v[208:209] op_sel_hi:[1,0]
    v_pk_mul_f32 v[6:7], v[6:7], v[208:209] op_sel_hi:[1,0]
    v_cvt_pk_bf16_f32 v96, v0, v1
    v_cvt_pk_bf16_f32 v97, v2, v3
    v_cvt_pk_bf16_f32 v98, v4, v5
    v_cvt_pk_bf16_f32 v99, v6, v7
    v_pk_mul_f32 v[8:9], v[8:9], v[208:209] op_sel_hi:[1,0]
    v_pk_mul_f32 v[10:11], v[10:11], v[208:209] op_sel_hi:[1,0]
    v_pk_mul_f32 v[12:13], v[12:13], v[208:209] op_sel_hi:[1,0]
    v_pk_mul_f32 v[14:15], v[14:15], v[208:209] op_sel_hi:[1,0]
    v_cvt_pk_bf16_f32 v100, v8, v9
    v_cvt_pk_bf16_f32 v101, v10, v11
    v_cvt_pk_bf16_f32 v102, v12, v13
    v_cvt_pk_bf16_f32 v103, v14, v15
    v_pk_mul_f32 v[16:17], v[16:17], v[208:209] op_sel_hi:[1,0]
    v_pk_mul_f32 v[18:19], v[18:19], v[208:209] op_sel_hi:[1,0]
    v_pk_mul_f32 v[20:21], v[20:21], v[208:209] op_sel_hi:[1,0]
    v_pk_mul_f32 v[22:23], v[22:23], v[208:209] op_sel_hi:[1,0]
    v_cvt_pk_bf16_f32 v104, v16, v17
    v_cvt_pk_bf16_f32 v105, v18, v19
    v_cvt_pk_bf16_f32 v106, v20, v21
    v_cvt_pk_bf16_f32 v107, v22, v23
    v_pk_mul_f32 v[24:25], v[24:25], v[208:209] op_sel_hi:[1,0]
    v_pk_mul_f32 v[26:27], v[26:27], v[208:209] op_sel_hi:[1,0]
    v_pk_mul_f32 v[28:29], v[28:29], v[208:209] op_sel_hi:[1,0]
    v_pk_mul_f32 v[30:31], v[30:31], v[208:209] op_sel_hi:[1,0]
    v_cvt_pk_bf16_f32 v108, v24, v25
    v_cvt_pk_bf16_f32 v109, v26, v27
    v_cvt_pk_bf16_f32 v110, v28, v29
    v_cvt_pk_bf16_f32 v111, v30, v31
    v_pk_mul_f32 v[32:33], v[32:33], v[212:213] op_sel_hi:[1,0]
    v_pk_mul_f32 v[34:35], v[34:35], v[212:213] op_sel_hi:[1,0]
    v_pk_mul_f32 v[36:37], v[36:37], v[212:213] op_sel_hi:[1,0]
    v_pk_mul_f32 v[38:39], v[38:39], v[212:213] op_sel_hi:[1,0]
    v_cvt_pk_bf16_f32 v112, v32, v33
    v_cvt_pk_bf16_f32 v113, v34, v35
    v_cvt_pk_bf16_f32 v114, v36, v37
    v_cvt_pk_bf16_f32 v115, v38, v39
    v_pk_mul_f32 v[40:41], v[40:41], v[212:213] op_sel_hi:[1,0]
    v_pk_mul_f32 v[42:43], v[42:43], v[212:213] op_sel_hi:[1,0]
    v_pk_mul_f32 v[44:45], v[44:45], v[212:213] op_sel_hi:[1,0]
    v_pk_mul_f32 v[46:47], v[46:47], v[212:213] op_sel_hi:[1,0]
    v_cvt_pk_bf16_f32 v116, v40, v41
    v_cvt_pk_bf16_f32 v117, v42, v43
    v_cvt_pk_bf16_f32 v118, v44, v45
    v_cvt_pk_bf16_f32 v119, v46, v47
    v_pk_mul_f32 v[48:49], v[48:49], v[212:213] op_sel_hi:[1,0]
    v_pk_mul_f32 v[50:51], v[50:51], v[212:213] op_sel_hi:[1,0]
    v_pk_mul_f32 v[52:53], v[52:53], v[212:213] op_sel_hi:[1,0]
    v_pk_mul_f32 v[54:55], v[54:55], v[212:213] op_sel_hi:[1,0]
    v_cvt_pk_bf16_f32 v120, v48, v49
    v_cvt_pk_bf16_f32 v121, v50, v51
    v_cvt_pk_bf16_f32 v122, v52, v53
    v_cvt_pk_bf16_f32 v123, v54, v55
    v_pk_mul_f32 v[56:57], v[56:57], v[212:213] op_sel_hi:[1,0]
    v_pk_mul_f32 v[58:59], v[58:59], v[212:213] op_sel_hi:[1,0]
    v_pk_mul_f32 v[60:61], v[60:61], v[212:213] op_sel_hi:[1,0]
    v_pk_mul_f32 v[62:63], v[62:63], v[212:213] op_sel_hi:[1,0]
    v_cvt_pk_bf16_f32 v124, v56, v57
    v_cvt_pk_bf16_f32 v125, v58, v59
    v_cvt_pk_bf16_f32 v126, v60, v61
    v_cvt_pk_bf16_f32 v127, v62, v63
    s_waitcnt vmcnt(16)
    s_barrier
    s_waitcnt vmcnt(1)
    v_mfma_f32_16x16x32_bf16 v[200:203], v[216:219], v[160:163], 0
    v_mfma_f32_16x16x32_bf16 v[204:207], v[216:219], v[164:167], 0
    s_waitcnt lgkmcnt(3)
    v_mfma_f32_16x16x32_bf16 v[144:147], v[176:179], v[64:67], 0
    s_setprio 3
    ds_read_b128 v[192:195], v224 offset:12288
    v_mfma_f32_16x16x32_bf16 v[152:155], v[176:179], v[80:83], 0
    s_waitcnt lgkmcnt(3)
    v_mfma_f32_16x16x32_bf16 v[152:155], v[180:183], v[84:87], v[152:155]
    ds_read_b128 v[196:199], v225 offset:12288
    v_mfma_f32_16x16x32_bf16 v[144:147], v[180:183], v[68:71], v[144:147]
    s_add_u32 m0, s58, 0x400
    s_nop 0
    buffer_load_dwordx4 v241, s[12:15], s30 offen offset:0 nt lds
    s_waitcnt lgkmcnt(3)
    v_mfma_f32_16x16x32_bf16 v[144:147], v[184:187], v[72:75], v[144:147]
    ds_read_b128 v[176:179], v226 offset:12288
    v_mfma_f32_16x16x32_bf16 v[152:155], v[184:187], v[88:91], v[152:155]
    s_waitcnt lgkmcnt(3)
    v_mfma_f32_16x16x32_bf16 v[152:155], v[188:191], v[92:95], v[152:155]
    ds_read_b128 v[180:183], v227 offset:12288
    v_mfma_f32_16x16x32_bf16 v[144:147], v[188:191], v[76:79], v[144:147]
    s_add_u32 m0, s37, 0x16000
    s_xor_b32 s38, s36, 0x3000
    buffer_load_dwordx4 v246, s[20:23], s38 offen offset:0 nt lds
    s_waitcnt lgkmcnt(3)
    v_mfma_f32_16x16x32_bf16 v[148:151], v[192:195], v[64:67], 0
    ds_read_b64_tr_b16 v[184:185], v228 offset:0
    v_mfma_f32_16x16x32_bf16 v[156:159], v[192:195], v[80:83], 0
    ds_read_b64_tr_b16 v[186:187], v228 offset:4096
    s_waitcnt lgkmcnt(4)
    v_mfma_f32_16x16x32_bf16 v[156:159], v[196:199], v[84:87], v[156:159]
    ds_read_b64_tr_b16 v[188:189], v229 offset:0
    v_mfma_f32_16x16x32_bf16 v[148:151], v[196:199], v[68:71], v[148:151]
    ds_read_b64_tr_b16 v[190:191], v229 offset:4096
    s_waitcnt lgkmcnt(5)
    v_mfma_f32_16x16x32_bf16 v[148:151], v[176:179], v[72:75], v[148:151]
    ds_read_b64_tr_b16 v[192:193], v230 offset:0
    v_mfma_f32_16x16x32_bf16 v[156:159], v[176:179], v[88:91], v[156:159]
    ds_read_b64_tr_b16 v[194:195], v230 offset:4096
    s_waitcnt lgkmcnt(6)
    v_mfma_f32_16x16x32_bf16 v[156:159], v[180:183], v[92:95], v[156:159]
    ds_read_b64_tr_b16 v[176:177], v231 offset:0
    v_mfma_f32_16x16x32_bf16 v[148:151], v[180:183], v[76:79], v[148:151]
    ds_read_b64_tr_b16 v[178:179], v231 offset:4096
    s_waitcnt lgkmcnt(6)
    v_mfma_f32_16x16x32_bf16 v[0:3], v[184:187], v[160:163], 0
    ds_read_b64_tr_b16 v[180:181], v232 offset:0
    v_mfma_f32_16x16x32_bf16 v[32:35], v[184:187], v[164:167], 0
    ds_read_b64_tr_b16 v[182:183], v232 offset:4096
    s_waitcnt lgkmcnt(6)
    v_mfma_f32_16x16x32_bf16 v[36:39], v[188:191], v[164:167], 0
    ds_read_b64_tr_b16 v[184:185], v233 offset:0
    v_mfma_f32_16x16x32_bf16 v[4:7], v[188:191], v[160:163], 0
    ds_read_b64_tr_b16 v[186:187], v233 offset:4096
    s_waitcnt lgkmcnt(6)
    v_mfma_f32_16x16x32_bf16 v[8:11], v[192:195], v[160:163], 0
    ds_read_b64_tr_b16 v[196:197], v234 offset:0
    v_mfma_f32_16x16x32_bf16 v[40:43], v[192:195], v[164:167], 0
    ds_read_b64_tr_b16 v[198:199], v234 offset:4096
    s_waitcnt lgkmcnt(6)
    v_mfma_f32_16x16x32_bf16 v[44:47], v[176:179], v[164:167], 0
    ds_read_b64_tr_b16 v[192:193], v235 offset:0
    v_mfma_f32_16x16x32_bf16 v[12:15], v[176:179], v[160:163], 0
    ds_read_b64_tr_b16 v[194:195], v235 offset:4096
    s_waitcnt lgkmcnt(6)
    v_mfma_f32_16x16x32_bf16 v[16:19], v[180:183], v[160:163], 0
    v_mfma_f32_16x16x32_bf16 v[48:51], v[180:183], v[164:167], 0
    s_waitcnt lgkmcnt(4)
    v_mfma_f32_16x16x32_bf16 v[52:55], v[184:187], v[164:167], 0
    v_mfma_f32_16x16x32_bf16 v[20:23], v[184:187], v[160:163], 0
    s_waitcnt lgkmcnt(2)
    v_mfma_f32_16x16x32_bf16 v[24:27], v[196:199], v[160:163], 0
    ds_read_b128 v[176:179], v224 offset:16384
    v_mfma_f32_16x16x32_bf16 v[56:59], v[196:199], v[164:167], 0
    ds_read_b128 v[180:183], v225 offset:16384
    s_waitcnt lgkmcnt(2)
    v_mfma_f32_16x16x32_bf16 v[60:63], v[192:195], v[164:167], 0
    ds_read_b128 v[184:187], v226 offset:16384
    v_mfma_f32_16x16x32_bf16 v[28:31], v[192:195], v[160:163], 0
    ds_read_b128 v[188:191], v227 offset:16384
    s_setprio 0
.p2align 3
    v_fmamk_f32 v168, v144, 0x3e0293ee, v248
    v_fmamk_f32 v169, v145, 0x3e0293ee, v248
    v_permlane16_swap_b32 v96, v98
    v_permlane16_swap_b32 v97, v99
    v_fmamk_f32 v170, v146, 0x3e0293ee, v248
    v_fmamk_f32 v171, v147, 0x3e0293ee, v248
    v_exp_f32 v168, v168
    v_exp_f32 v169, v169
    v_permlane16_swap_b32 v100, v102
    v_permlane16_swap_b32 v101, v103
    v_exp_f32 v170, v170
    v_exp_f32 v171, v171
    v_fmamk_f32 v172, v152, 0x3e0293ee, v249
    v_fmamk_f32 v173, v153, 0x3e0293ee, v249
    v_cndmask_b32_dpp v220, v100, v96, vcc quad_perm:[1,0,3,2] row_mask:0xf bank_mask:0xf
    v_cndmask_b32_dpp v221, v101, v97, vcc quad_perm:[1,0,3,2] row_mask:0xf bank_mask:0xf
    v_fmamk_f32 v174, v154, 0x3e0293ee, v249
    v_fmamk_f32 v175, v155, 0x3e0293ee, v249
    v_cvt_pk_bf16_f32 v160, v168, v169
    v_cvt_pk_bf16_f32 v161, v170, v171
    v_cndmask_b32_dpp v222, v102, v98, vcc quad_perm:[1,0,3,2] row_mask:0xf bank_mask:0xf
    v_cndmask_b32_dpp v223, v103, v99, vcc quad_perm:[1,0,3,2] row_mask:0xf bank_mask:0xf
    s_not_b64 vcc, vcc
    s_nop 0
    v_exp_f32 v172, v172
    v_exp_f32 v173, v173
    v_exp_f32 v174, v174
    v_exp_f32 v175, v175
    v_cndmask_b32_dpp v100, v96, v100, vcc quad_perm:[1,0,3,2] row_mask:0xf bank_mask:0xf
    v_cndmask_b32_dpp v101, v97, v101, vcc quad_perm:[1,0,3,2] row_mask:0xf bank_mask:0xf
    v_fmamk_f32 v168, v148, 0x3e0293ee, v248
    v_fmamk_f32 v169, v149, 0x3e0293ee, v248
    v_fmamk_f32 v170, v150, 0x3e0293ee, v248
    v_fmamk_f32 v171, v151, 0x3e0293ee, v248
    s_setprio 1
    s_nop 0
    v_cndmask_b32_dpp v102, v98, v102, vcc quad_perm:[1,0,3,2] row_mask:0xf bank_mask:0xf
    v_cndmask_b32_dpp v103, v99, v103, vcc quad_perm:[1,0,3,2] row_mask:0xf bank_mask:0xf
    s_not_b64 vcc, vcc
    s_nop 0
    v_cvt_pk_bf16_f32 v164, v172, v173
    v_cvt_pk_bf16_f32 v165, v174, v175
    v_exp_f32 v168, v168
    v_exp_f32 v169, v169
    buffer_store_dwordx4 v[100:103], v244, s[24:27], s34 offen offset:256 sc0 sc1
    v_exp_f32 v170, v170
    v_exp_f32 v171, v171
    v_fmamk_f32 v172, v156, 0x3e0293ee, v249
    v_fmamk_f32 v173, v157, 0x3e0293ee, v249
    v_fmamk_f32 v174, v158, 0x3e0293ee, v249
    v_fmamk_f32 v175, v159, 0x3e0293ee, v249
    v_cvt_pk_bf16_f32 v162, v168, v169
    v_cvt_pk_bf16_f32 v163, v170, v171
    v_exp_f32 v172, v172
    v_exp_f32 v173, v173
    v_exp_f32 v174, v174
    v_exp_f32 v175, v175
    v_cvt_pk_bf16_f32 v166, v172, v173
    v_cvt_pk_bf16_f32 v167, v174, v175
    s_waitcnt vmcnt(13)
    s_barrier
    s_waitcnt vmcnt(1)
    v_mfma_f32_16x16x32_bf16 v[208:211], v[216:219], v[160:163], v[200:203]
    v_mfma_f32_16x16x32_bf16 v[212:215], v[216:219], v[164:167], v[204:207]
    s_waitcnt lgkmcnt(3)
    v_mfma_f32_16x16x32_bf16 v[128:131], v[176:179], v[64:67], 0
    s_setprio 3
    ds_read_b128 v[192:195], v224 offset:20480
    v_mfma_f32_16x16x32_bf16 v[136:139], v[176:179], v[80:83], 0
    s_waitcnt lgkmcnt(3)
    v_mfma_f32_16x16x32_bf16 v[136:139], v[180:183], v[84:87], v[136:139]
    ds_read_b128 v[196:199], v225 offset:20480
    v_mfma_f32_16x16x32_bf16 v[128:131], v[180:183], v[68:71], v[128:131]
    s_add_u32 m0, s58, 0x800
    s_nop 0
    buffer_load_dwordx4 v242, s[12:15], s30 offen offset:0 nt lds
    s_waitcnt lgkmcnt(3)
    v_mfma_f32_16x16x32_bf16 v[128:131], v[184:187], v[72:75], v[128:131]
    ds_read_b128 v[176:179], v226 offset:20480
    v_mfma_f32_16x16x32_bf16 v[136:139], v[184:187], v[88:91], v[136:139]
    v_max_f32_e64 v250, v208, v212
    v_cmp_nle_f32_e64 s[42:43], v250, s40
    s_waitcnt lgkmcnt(3)
    v_mfma_f32_16x16x32_bf16 v[136:139], v[188:191], v[92:95], v[136:139]
    ds_read_b128 v[180:183], v227 offset:20480
    v_mfma_f32_16x16x32_bf16 v[128:131], v[188:191], v[76:79], v[128:131]
    s_cmp_lg_u64 s[42:43], 0
    s_cbranch_scc1 L_stublead14
L_retlead14:
    s_add_u32 m0, s37, 0xc000
    s_xor_b32 s38, s36, 0x6000
    buffer_load_dwordx4 v245, s[16:19], s38 offen offset:0 nt lds
    s_waitcnt lgkmcnt(3)
    v_mfma_f32_16x16x32_bf16 v[132:135], v[192:195], v[64:67], 0
    ds_read_b64_tr_b16 v[184:185], v228 offset:8192
    v_mfma_f32_16x16x32_bf16 v[140:143], v[192:195], v[80:83], 0
    ds_read_b64_tr_b16 v[186:187], v228 offset:12288
    s_waitcnt lgkmcnt(4)
    v_mfma_f32_16x16x32_bf16 v[140:143], v[196:199], v[84:87], v[140:143]
    ds_read_b64_tr_b16 v[188:189], v229 offset:8192
    v_mfma_f32_16x16x32_bf16 v[132:135], v[196:199], v[68:71], v[132:135]
    ds_read_b64_tr_b16 v[190:191], v229 offset:12288
    s_waitcnt lgkmcnt(5)
    v_mfma_f32_16x16x32_bf16 v[132:135], v[176:179], v[72:75], v[132:135]
    ds_read_b64_tr_b16 v[192:193], v230 offset:8192
    v_mfma_f32_16x16x32_bf16 v[140:143], v[176:179], v[88:91], v[140:143]
    ds_read_b64_tr_b16 v[194:195], v230 offset:12288
    s_waitcnt lgkmcnt(6)
    v_mfma_f32_16x16x32_bf16 v[140:143], v[180:183], v[92:95], v[140:143]
    ds_read_b64_tr_b16 v[176:177], v231 offset:8192
    v_mfma_f32_16x16x32_bf16 v[132:135], v[180:183], v[76:79], v[132:135]
    ds_read_b64_tr_b16 v[178:179], v231 offset:12288
    s_waitcnt lgkmcnt(6)
    v_mfma_f32_16x16x32_bf16 v[0:3], v[184:187], v[160:163], v[0:3]
    ds_read_b64_tr_b16 v[180:181], v232 offset:8192
    v_mfma_f32_16x16x32_bf16 v[32:35], v[184:187], v[164:167], v[32:35]
    ds_read_b64_tr_b16 v[182:183], v232 offset:12288
    s_waitcnt lgkmcnt(6)
    v_mfma_f32_16x16x32_bf16 v[36:39], v[188:191], v[164:167], v[36:39]
    ds_read_b64_tr_b16 v[184:185], v233 offset:8192
    v_mfma_f32_16x16x32_bf16 v[4:7], v[188:191], v[160:163], v[4:7]
    ds_read_b64_tr_b16 v[186:187], v233 offset:12288
    s_waitcnt lgkmcnt(6)
    v_mfma_f32_16x16x32_bf16 v[8:11], v[192:195], v[160:163], v[8:11]
    ds_read_b64_tr_b16 v[196:197], v234 offset:8192
    v_mfma_f32_16x16x32_bf16 v[40:43], v[192:195], v[164:167], v[40:43]
    ds_read_b64_tr_b16 v[198:199], v234 offset:12288
    s_waitcnt lgkmcnt(6)
    v_mfma_f32_16x16x32_bf16 v[44:47], v[176:179], v[164:167], v[44:47]
    ds_read_b64_tr_b16 v[192:193], v235 offset:8192
    v_mfma_f32_16x16x32_bf16 v[12:15], v[176:179], v[160:163], v[12:15]
    ds_read_b64_tr_b16 v[194:195], v235 offset:12288
    s_waitcnt lgkmcnt(6)
    v_mfma_f32_16x16x32_bf16 v[16:19], v[180:183], v[160:163], v[16:19]
    v_mfma_f32_16x16x32_bf16 v[48:51], v[180:183], v[164:167], v[48:51]
    s_waitcnt lgkmcnt(4)
    v_mfma_f32_16x16x32_bf16 v[52:55], v[184:187], v[164:167], v[52:55]
    v_mfma_f32_16x16x32_bf16 v[20:23], v[184:187], v[160:163], v[20:23]
    s_waitcnt lgkmcnt(2)
    v_mfma_f32_16x16x32_bf16 v[24:27], v[196:199], v[160:163], v[24:27]
    ds_read_b128 v[176:179], v224 offset:24576
    v_mfma_f32_16x16x32_bf16 v[56:59], v[196:199], v[164:167], v[56:59]
    ds_read_b128 v[180:183], v225 offset:24576
    s_waitcnt lgkmcnt(2)
    v_mfma_f32_16x16x32_bf16 v[60:63], v[192:195], v[164:167], v[60:63]
    ds_read_b128 v[184:187], v226 offset:24576
    v_mfma_f32_16x16x32_bf16 v[28:31], v[192:195], v[160:163], v[28:31]
    ds_read_b128 v[188:191], v227 offset:24576
    s_setprio 0
.p2align 3
    s_waitcnt vmcnt(9)
    s_barrier
    s_setprio 2
    s_nop 0
    v_fmamk_f32 v168, v128, 0x3e0293ee, v248
    v_fmamk_f32 v169, v129, 0x3e0293ee, v248
    v_permlane16_swap_b32 v104, v106
    v_permlane16_swap_b32 v105, v107
    v_fmamk_f32 v170, v130, 0x3e0293ee, v248
    v_fmamk_f32 v171, v131, 0x3e0293ee, v248
    v_exp_f32 v168, v168
    v_exp_f32 v169, v169
    v_permlane16_swap_b32 v108, v110
    v_permlane16_swap_b32 v109, v111
    v_exp_f32 v170, v170
    v_exp_f32 v171, v171
    v_fmamk_f32 v172, v136, 0x3e0293ee, v249
    v_fmamk_f32 v173, v137, 0x3e0293ee, v249
    v_cndmask_b32_dpp v96, v108, v104, vcc quad_perm:[1,0,3,2] row_mask:0xf bank_mask:0xf
    v_cndmask_b32_dpp v97, v109, v105, vcc quad_perm:[1,0,3,2] row_mask:0xf bank_mask:0xf
    v_fmamk_f32 v174, v138, 0x3e0293ee, v249
    v_fmamk_f32 v175, v139, 0x3e0293ee, v249
    v_cvt_pk_bf16_f32 v160, v168, v169
    v_cvt_pk_bf16_f32 v161, v170, v171
    v_cndmask_b32_dpp v98, v110, v106, vcc quad_perm:[1,0,3,2] row_mask:0xf bank_mask:0xf
    v_cndmask_b32_dpp v99, v111, v107, vcc quad_perm:[1,0,3,2] row_mask:0xf bank_mask:0xf
    s_not_b64 vcc, vcc
    s_nop 0
    v_exp_f32 v172, v172
    v_exp_f32 v173, v173
    v_exp_f32 v174, v174
    v_exp_f32 v175, v175
    v_cndmask_b32_dpp v108, v104, v108, vcc quad_perm:[1,0,3,2] row_mask:0xf bank_mask:0xf
    v_cndmask_b32_dpp v109, v105, v109, vcc quad_perm:[1,0,3,2] row_mask:0xf bank_mask:0xf
    v_fmamk_f32 v168, v132, 0x3e0293ee, v248
    v_fmamk_f32 v169, v133, 0x3e0293ee, v248
    v_fmamk_f32 v170, v134, 0x3e0293ee, v248
    v_fmamk_f32 v171, v135, 0x3e0293ee, v248
    v_cndmask_b32_dpp v110, v106, v110, vcc quad_perm:[1,0,3,2] row_mask:0xf bank_mask:0xf
    v_cndmask_b32_dpp v111, v107, v111, vcc quad_perm:[1,0,3,2] row_mask:0xf bank_mask:0xf
    s_not_b64 vcc, vcc
    s_nop 0
    v_cvt_pk_bf16_f32 v164, v172, v173
    v_cvt_pk_bf16_f32 v165, v174, v175
    v_exp_f32 v168, v168
    v_exp_f32 v169, v169
    buffer_store_dwordx4 v[96:99], v244, s[24:27], s34 offen offset:128 sc0 sc1
    v_exp_f32 v170, v170
    v_exp_f32 v171, v171
    v_fmamk_f32 v172, v140, 0x3e0293ee, v249
    v_fmamk_f32 v173, v141, 0x3e0293ee, v249
    v_fmamk_f32 v174, v142, 0x3e0293ee, v249
    v_fmamk_f32 v175, v143, 0x3e0293ee, v249
    v_cvt_pk_bf16_f32 v162, v168, v169
    v_cvt_pk_bf16_f32 v163, v170, v171
    v_exp_f32 v172, v172
    v_exp_f32 v173, v173
    v_exp_f32 v174, v174
    v_exp_f32 v175, v175
    v_cvt_pk_bf16_f32 v166, v172, v173
    v_cvt_pk_bf16_f32 v167, v174, v175
    s_waitcnt vmcnt(1)
    v_mfma_f32_16x16x32_bf16 v[200:203], v[216:219], v[160:163], v[208:211]
    v_mfma_f32_16x16x32_bf16 v[204:207], v[216:219], v[164:167], v[212:215]
    s_waitcnt lgkmcnt(3)
    v_mfma_f32_16x16x32_bf16 v[144:147], v[176:179], v[64:67], 0
    s_setprio 3
    ds_read_b128 v[192:195], v224 offset:28672
    v_mfma_f32_16x16x32_bf16 v[152:155], v[176:179], v[80:83], 0
    s_waitcnt lgkmcnt(3)
    v_mfma_f32_16x16x32_bf16 v[152:155], v[180:183], v[84:87], v[152:155]
    ds_read_b128 v[196:199], v225 offset:28672
    v_mfma_f32_16x16x32_bf16 v[144:147], v[180:183], v[68:71], v[144:147]
    s_add_u32 m0, s58, 0xc00
    s_nop 0
    buffer_load_dwordx4 v243, s[12:15], s30 offen offset:0 nt lds
    s_waitcnt lgkmcnt(3)
    v_mfma_f32_16x16x32_bf16 v[144:147], v[184:187], v[72:75], v[144:147]
    ds_read_b128 v[176:179], v226 offset:28672
    v_mfma_f32_16x16x32_bf16 v[152:155], v[184:187], v[88:91], v[152:155]
    v_max_f32_e64 v250, v200, v204
    v_cmp_nle_f32_e64 s[42:43], v250, s40
    s_waitcnt lgkmcnt(3)
    v_mfma_f32_16x16x32_bf16 v[152:155], v[188:191], v[92:95], v[152:155]
    ds_read_b128 v[180:183], v227 offset:28672
    v_mfma_f32_16x16x32_bf16 v[144:147], v[188:191], v[76:79], v[144:147]
    s_cmp_lg_u64 s[42:43], 0
    s_cbranch_scc1 L_stublead15
L_retlead15:
    s_add_u32 m0, s37, 0x18000
    s_xor_b32 s38, s36, 0x4000
    buffer_load_dwordx4 v246, s[20:23], s38 offen offset:0 nt lds
    s_waitcnt lgkmcnt(3)
    v_mfma_f32_16x16x32_bf16 v[148:151], v[192:195], v[64:67], 0
    ds_read_b64_tr_b16 v[184:185], v228 offset:16384
    v_mfma_f32_16x16x32_bf16 v[156:159], v[192:195], v[80:83], 0
    ds_read_b64_tr_b16 v[186:187], v228 offset:20480
    s_waitcnt lgkmcnt(4)
    v_mfma_f32_16x16x32_bf16 v[156:159], v[196:199], v[84:87], v[156:159]
    ds_read_b64_tr_b16 v[188:189], v229 offset:16384
    v_mfma_f32_16x16x32_bf16 v[148:151], v[196:199], v[68:71], v[148:151]
    ds_read_b64_tr_b16 v[190:191], v229 offset:20480
    s_waitcnt lgkmcnt(5)
    v_mfma_f32_16x16x32_bf16 v[148:151], v[176:179], v[72:75], v[148:151]
    ds_read_b64_tr_b16 v[192:193], v230 offset:16384
    v_mfma_f32_16x16x32_bf16 v[156:159], v[176:179], v[88:91], v[156:159]
    ds_read_b64_tr_b16 v[194:195], v230 offset:20480
    s_waitcnt lgkmcnt(6)
    v_mfma_f32_16x16x32_bf16 v[156:159], v[180:183], v[92:95], v[156:159]
    ds_read_b64_tr_b16 v[176:177], v231 offset:16384
    v_mfma_f32_16x16x32_bf16 v[148:151], v[180:183], v[76:79], v[148:151]
    ds_read_b64_tr_b16 v[178:179], v231 offset:20480
    s_waitcnt lgkmcnt(6)
    v_mfma_f32_16x16x32_bf16 v[0:3], v[184:187], v[160:163], v[0:3]
    ds_read_b64_tr_b16 v[180:181], v232 offset:16384
    v_mfma_f32_16x16x32_bf16 v[32:35], v[184:187], v[164:167], v[32:35]
    ds_read_b64_tr_b16 v[182:183], v232 offset:20480
    s_waitcnt lgkmcnt(6)
    v_mfma_f32_16x16x32_bf16 v[36:39], v[188:191], v[164:167], v[36:39]
    ds_read_b64_tr_b16 v[184:185], v233 offset:16384
    v_mfma_f32_16x16x32_bf16 v[4:7], v[188:191], v[160:163], v[4:7]
    ds_read_b64_tr_b16 v[186:187], v233 offset:20480
    s_waitcnt lgkmcnt(6)
    v_mfma_f32_16x16x32_bf16 v[8:11], v[192:195], v[160:163], v[8:11]
    ds_read_b64_tr_b16 v[196:197], v234 offset:16384
    v_mfma_f32_16x16x32_bf16 v[40:43], v[192:195], v[164:167], v[40:43]
    ds_read_b64_tr_b16 v[198:199], v234 offset:20480
    s_waitcnt lgkmcnt(6)
    v_mfma_f32_16x16x32_bf16 v[44:47], v[176:179], v[164:167], v[44:47]
    ds_read_b64_tr_b16 v[192:193], v235 offset:16384
    v_mfma_f32_16x16x32_bf16 v[12:15], v[176:179], v[160:163], v[12:15]
    ds_read_b64_tr_b16 v[194:195], v235 offset:20480
    s_waitcnt lgkmcnt(6)
    v_mfma_f32_16x16x32_bf16 v[16:19], v[180:183], v[160:163], v[16:19]
    v_mfma_f32_16x16x32_bf16 v[48:51], v[180:183], v[164:167], v[48:51]
    s_waitcnt lgkmcnt(4)
    v_mfma_f32_16x16x32_bf16 v[52:55], v[184:187], v[164:167], v[52:55]
    v_mfma_f32_16x16x32_bf16 v[20:23], v[184:187], v[160:163], v[20:23]
    s_waitcnt lgkmcnt(2)
    v_mfma_f32_16x16x32_bf16 v[24:27], v[196:199], v[160:163], v[24:27]
    ds_read_b128 v[176:179], v224 offset:32768
    v_mfma_f32_16x16x32_bf16 v[56:59], v[196:199], v[164:167], v[56:59]
    ds_read_b128 v[180:183], v225 offset:32768
    s_waitcnt lgkmcnt(2)
    v_mfma_f32_16x16x32_bf16 v[60:63], v[192:195], v[164:167], v[60:63]
    ds_read_b128 v[184:187], v226 offset:32768
    v_mfma_f32_16x16x32_bf16 v[28:31], v[192:195], v[160:163], v[28:31]
    ds_read_b128 v[188:191], v227 offset:32768
    s_setprio 0
.p2align 3
    s_waitcnt vmcnt(6)
    s_barrier
    s_setprio 2
    s_nop 0
    v_fmamk_f32 v168, v144, 0x3e0293ee, v248
    v_fmamk_f32 v169, v145, 0x3e0293ee, v248
    buffer_store_dwordx4 v[108:111], v244, s[24:27], s34 offen offset:384 sc0 sc1
    v_fmamk_f32 v170, v146, 0x3e0293ee, v248
    v_fmamk_f32 v171, v147, 0x3e0293ee, v248
    v_exp_f32 v168, v168
    v_exp_f32 v169, v169
    v_exp_f32 v170, v170
    v_exp_f32 v171, v171
    v_fmamk_f32 v172, v152, 0x3e0293ee, v249
    v_fmamk_f32 v173, v153, 0x3e0293ee, v249
    v_fmamk_f32 v174, v154, 0x3e0293ee, v249
    v_fmamk_f32 v175, v155, 0x3e0293ee, v249
    v_cvt_pk_bf16_f32 v160, v168, v169
    v_cvt_pk_bf16_f32 v161, v170, v171
    v_exp_f32 v172, v172
    v_exp_f32 v173, v173
    v_exp_f32 v174, v174
    v_exp_f32 v175, v175
    v_fmamk_f32 v168, v148, 0x3e0293ee, v248
    v_fmamk_f32 v169, v149, 0x3e0293ee, v248
    v_fmamk_f32 v170, v150, 0x3e0293ee, v248
    v_fmamk_f32 v171, v151, 0x3e0293ee, v248
    v_cvt_pk_bf16_f32 v164, v172, v173
    v_cvt_pk_bf16_f32 v165, v174, v175
    v_exp_f32 v168, v168
    v_exp_f32 v169, v169
    v_exp_f32 v170, v170
    v_exp_f32 v171, v171
    v_fmamk_f32 v172, v156, 0x3e0293ee, v249
    v_fmamk_f32 v173, v157, 0x3e0293ee, v249
    v_fmamk_f32 v174, v158, 0x3e0293ee, v249
    v_fmamk_f32 v175, v159, 0x3e0293ee, v249
    v_cvt_pk_bf16_f32 v162, v168, v169
    v_cvt_pk_bf16_f32 v163, v170, v171
    s_waitcnt vmcnt(2)
    s_nop 0
    ds_read_b128 v[96:99], v236 offset:0
    ds_read_b128 v[100:103], v237 offset:0
    ds_read_b128 v[104:107], v238 offset:0
    ds_read_b128 v[108:111], v239 offset:0
    v_exp_f32 v172, v172
    v_exp_f32 v173, v173
    v_exp_f32 v174, v174
    v_exp_f32 v175, v175
    v_cvt_pk_bf16_f32 v166, v172, v173
    v_cvt_pk_bf16_f32 v167, v174, v175
    s_waitcnt vmcnt(1)
    v_mfma_f32_16x16x32_bf16 v[208:211], v[216:219], v[160:163], v[200:203]
    v_mfma_f32_16x16x32_bf16 v[212:215], v[216:219], v[164:167], v[204:207]
    s_waitcnt lgkmcnt(7)
    v_mfma_f32_16x16x32_bf16 v[128:131], v[176:179], v[64:67], 0
    s_setprio 3
    ds_read_b128 v[192:195], v224 offset:36864
    v_mfma_f32_16x16x32_bf16 v[136:139], v[176:179], v[80:83], 0
    s_waitcnt lgkmcnt(7)
    v_mfma_f32_16x16x32_bf16 v[136:139], v[180:183], v[84:87], v[136:139]
    ds_read_b128 v[196:199], v225 offset:36864
    v_mfma_f32_16x16x32_bf16 v[128:131], v[180:183], v[68:71], v[128:131]
    s_add_u32 m0, s37, 0xe000
    s_xor_b32 s38, s36, 0x7000
    buffer_load_dwordx4 v245, s[16:19], s38 offen offset:0 nt lds
    s_waitcnt lgkmcnt(7)
    v_mfma_f32_16x16x32_bf16 v[128:131], v[184:187], v[72:75], v[128:131]
    ds_read_b128 v[176:179], v226 offset:36864
    v_mfma_f32_16x16x32_bf16 v[136:139], v[184:187], v[88:91], v[136:139]
    v_max_f32_e64 v250, v208, v212
    v_cmp_nle_f32_e64 s[42:43], v250, s40
    s_waitcnt lgkmcnt(7)
    v_mfma_f32_16x16x32_bf16 v[136:139], v[188:191], v[92:95], v[136:139]
    ds_read_b128 v[180:183], v227 offset:36864
    v_mfma_f32_16x16x32_bf16 v[128:131], v[188:191], v[76:79], v[128:131]
    s_cmp_lg_u64 s[42:43], 0
    s_cbranch_scc1 L_stublead16
L_retlead16:
    s_add_u32 m0, s37, 0x1a000
    s_xor_b32 s38, s36, 0x5000
    buffer_load_dwordx4 v246, s[20:23], s38 offen offset:0 nt lds
    s_waitcnt lgkmcnt(3)
    v_mfma_f32_16x16x32_bf16 v[132:135], v[192:195], v[64:67], 0
    ds_read_b64_tr_b16 v[184:185], v228 offset:24576
    v_mfma_f32_16x16x32_bf16 v[140:143], v[192:195], v[80:83], 0
    ds_read_b64_tr_b16 v[186:187], v228 offset:28672
    s_waitcnt lgkmcnt(4)
    v_mfma_f32_16x16x32_bf16 v[140:143], v[196:199], v[84:87], v[140:143]
    ds_read_b64_tr_b16 v[188:189], v229 offset:24576
    v_mfma_f32_16x16x32_bf16 v[132:135], v[196:199], v[68:71], v[132:135]
    ds_read_b64_tr_b16 v[190:191], v229 offset:28672
    s_waitcnt lgkmcnt(5)
    v_mfma_f32_16x16x32_bf16 v[132:135], v[176:179], v[72:75], v[132:135]
    ds_read_b64_tr_b16 v[192:193], v230 offset:24576
    v_mfma_f32_16x16x32_bf16 v[140:143], v[176:179], v[88:91], v[140:143]
    ds_read_b64_tr_b16 v[194:195], v230 offset:28672
    s_waitcnt lgkmcnt(6)
    v_mfma_f32_16x16x32_bf16 v[140:143], v[180:183], v[92:95], v[140:143]
    ds_read_b64_tr_b16 v[176:177], v231 offset:24576
    v_mfma_f32_16x16x32_bf16 v[132:135], v[180:183], v[76:79], v[132:135]
    ds_read_b64_tr_b16 v[178:179], v231 offset:28672
    s_waitcnt lgkmcnt(6)
    v_mfma_f32_16x16x32_bf16 v[0:3], v[184:187], v[160:163], v[0:3]
    ds_read_b64_tr_b16 v[180:181], v232 offset:24576
    v_mfma_f32_16x16x32_bf16 v[32:35], v[184:187], v[164:167], v[32:35]
    ds_read_b64_tr_b16 v[182:183], v232 offset:28672
    s_waitcnt lgkmcnt(6)
    v_mfma_f32_16x16x32_bf16 v[36:39], v[188:191], v[164:167], v[36:39]
    ds_read_b64_tr_b16 v[184:185], v233 offset:24576
    v_mfma_f32_16x16x32_bf16 v[4:7], v[188:191], v[160:163], v[4:7]
    ds_read_b64_tr_b16 v[186:187], v233 offset:28672
    s_waitcnt lgkmcnt(6)
    v_mfma_f32_16x16x32_bf16 v[8:11], v[192:195], v[160:163], v[8:11]
    ds_read_b64_tr_b16 v[196:197], v234 offset:24576
    v_mfma_f32_16x16x32_bf16 v[40:43], v[192:195], v[164:167], v[40:43]
    ds_read_b64_tr_b16 v[198:199], v234 offset:28672
    s_waitcnt lgkmcnt(6)
    v_mfma_f32_16x16x32_bf16 v[44:47], v[176:179], v[164:167], v[44:47]
    ds_read_b64_tr_b16 v[192:193], v235 offset:24576
    v_mfma_f32_16x16x32_bf16 v[12:15], v[176:179], v[160:163], v[12:15]
    ds_read_b64_tr_b16 v[194:195], v235 offset:28672
    s_waitcnt lgkmcnt(6)
    v_mfma_f32_16x16x32_bf16 v[16:19], v[180:183], v[160:163], v[16:19]
    v_mfma_f32_16x16x32_bf16 v[48:51], v[180:183], v[164:167], v[48:51]
    s_waitcnt lgkmcnt(4)
    v_mfma_f32_16x16x32_bf16 v[52:55], v[184:187], v[164:167], v[52:55]
    v_mfma_f32_16x16x32_bf16 v[20:23], v[184:187], v[160:163], v[20:23]
    s_waitcnt lgkmcnt(2)
    v_mfma_f32_16x16x32_bf16 v[24:27], v[196:199], v[160:163], v[24:27]
    ds_read_b128 v[176:179], v224 offset:40960
    v_mfma_f32_16x16x32_bf16 v[56:59], v[196:199], v[164:167], v[56:59]
    ds_read_b128 v[180:183], v225 offset:40960
    s_waitcnt lgkmcnt(2)
    v_mfma_f32_16x16x32_bf16 v[60:63], v[192:195], v[164:167], v[60:63]
    ds_read_b128 v[184:187], v226 offset:40960
    v_mfma_f32_16x16x32_bf16 v[28:31], v[192:195], v[160:163], v[28:31]
    ds_read_b128 v[188:191], v227 offset:40960
    s_setprio 0
.p2align 3
    s_waitcnt vmcnt(3)
    s_barrier
    s_setprio 2
    s_nop 0
    v_fmamk_f32 v168, v128, 0x3e0293ee, v248
    v_fmamk_f32 v169, v129, 0x3e0293ee, v248
    buffer_store_dwordx4 v[220:223], v244, s[24:27], s34 offen offset:0 sc0 sc1
    v_fmamk_f32 v170, v130, 0x3e0293ee, v248
    v_fmamk_f32 v171, v131, 0x3e0293ee, v248
    v_exp_f32 v168, v168
    v_exp_f32 v169, v169
    v_exp_f32 v170, v170
    v_exp_f32 v171, v171
    v_fmamk_f32 v172, v136, 0x3e0293ee, v249
    v_fmamk_f32 v173, v137, 0x3e0293ee, v249
    v_fmamk_f32 v174, v138, 0x3e0293ee, v249
    v_fmamk_f32 v175, v139, 0x3e0293ee, v249
    v_cvt_pk_bf16_f32 v160, v168, v169
    v_cvt_pk_bf16_f32 v161, v170, v171
    v_exp_f32 v172, v172
    v_exp_f32 v173, v173
    v_exp_f32 v174, v174
    v_exp_f32 v175, v175
    v_fmamk_f32 v168, v132, 0x3e0293ee, v248
    v_fmamk_f32 v169, v133, 0x3e0293ee, v248
    v_fmamk_f32 v170, v134, 0x3e0293ee, v248
    v_fmamk_f32 v171, v135, 0x3e0293ee, v248
    v_cvt_pk_bf16_f32 v164, v172, v173
    v_cvt_pk_bf16_f32 v165, v174, v175
    v_exp_f32 v168, v168
    v_exp_f32 v169, v169
    v_exp_f32 v170, v170
    v_exp_f32 v171, v171
    v_fmamk_f32 v172, v140, 0x3e0293ee, v249
    v_fmamk_f32 v173, v141, 0x3e0293ee, v249
    v_fmamk_f32 v174, v142, 0x3e0293ee, v249
    v_fmamk_f32 v175, v143, 0x3e0293ee, v249
    v_cvt_pk_bf16_f32 v162, v168, v169
    v_cvt_pk_bf16_f32 v163, v170, v171
    v_exp_f32 v172, v172
    v_exp_f32 v173, v173
    v_exp_f32 v174, v174
    v_exp_f32 v175, v175
    v_cvt_pk_bf16_f32 v166, v172, v173
    v_cvt_pk_bf16_f32 v167, v174, v175
    s_waitcnt vmcnt(1)
    v_mfma_f32_16x16x32_bf16 v[200:203], v[216:219], v[160:163], v[208:211]
    v_mfma_f32_16x16x32_bf16 v[204:207], v[216:219], v[164:167], v[212:215]
    s_waitcnt lgkmcnt(3)
    v_mfma_f32_16x16x32_bf16 v[144:147], v[176:179], v[64:67], 0
    s_setprio 3
    ds_read_b128 v[192:195], v224 offset:45056
    v_mfma_f32_16x16x32_bf16 v[152:155], v[176:179], v[80:83], 0
    s_waitcnt lgkmcnt(3)
    v_mfma_f32_16x16x32_bf16 v[152:155], v[180:183], v[84:87], v[152:155]
    ds_read_b128 v[196:199], v225 offset:45056
    v_mfma_f32_16x16x32_bf16 v[144:147], v[180:183], v[68:71], v[144:147]
    s_add_u32 m0, s58, 0x0
    s_nop 0
    buffer_load_dwordx4 v240, s[12:15], s31 offen offset:0 nt lds
    s_waitcnt lgkmcnt(3)
    v_mfma_f32_16x16x32_bf16 v[144:147], v[184:187], v[72:75], v[144:147]
    ds_read_b128 v[176:179], v226 offset:45056
    v_mfma_f32_16x16x32_bf16 v[152:155], v[184:187], v[88:91], v[152:155]
    v_max_f32_e64 v250, v200, v204
    v_cmp_nle_f32_e64 s[42:43], v250, s40
    s_waitcnt lgkmcnt(3)
    v_mfma_f32_16x16x32_bf16 v[152:155], v[188:191], v[92:95], v[152:155]
    ds_read_b128 v[180:183], v227 offset:45056
    v_mfma_f32_16x16x32_bf16 v[144:147], v[188:191], v[76:79], v[144:147]
    s_cmp_lg_u64 s[42:43], 0
    s_cbranch_scc1 L_stublead17
L_retlead17:
    s_add_u32 m0, s37, 0x1c000
    s_xor_b32 s38, s36, 0x6000
    buffer_load_dwordx4 v246, s[20:23], s38 offen offset:0 nt lds
    s_waitcnt lgkmcnt(3)
    v_mfma_f32_16x16x32_bf16 v[148:151], v[192:195], v[64:67], 0
    ds_read_b64_tr_b16 v[184:185], v228 offset:32768
    v_mfma_f32_16x16x32_bf16 v[156:159], v[192:195], v[80:83], 0
    ds_read_b64_tr_b16 v[186:187], v228 offset:36864
    s_waitcnt lgkmcnt(4)
    v_mfma_f32_16x16x32_bf16 v[156:159], v[196:199], v[84:87], v[156:159]
    ds_read_b64_tr_b16 v[188:189], v229 offset:32768
    v_mfma_f32_16x16x32_bf16 v[148:151], v[196:199], v[68:71], v[148:151]
    ds_read_b64_tr_b16 v[190:191], v229 offset:36864
    s_waitcnt lgkmcnt(5)
    v_mfma_f32_16x16x32_bf16 v[148:151], v[176:179], v[72:75], v[148:151]
    ds_read_b64_tr_b16 v[192:193], v230 offset:32768
    v_mfma_f32_16x16x32_bf16 v[156:159], v[176:179], v[88:91], v[156:159]
    ds_read_b64_tr_b16 v[194:195], v230 offset:36864
    s_waitcnt lgkmcnt(6)
    v_mfma_f32_16x16x32_bf16 v[156:159], v[180:183], v[92:95], v[156:159]
    ds_read_b64_tr_b16 v[176:177], v231 offset:32768
    v_mfma_f32_16x16x32_bf16 v[148:151], v[180:183], v[76:79], v[148:151]
    ds_read_b64_tr_b16 v[178:179], v231 offset:36864
    s_waitcnt lgkmcnt(6)
    v_mfma_f32_16x16x32_bf16 v[0:3], v[184:187], v[160:163], v[0:3]
    ds_read_b64_tr_b16 v[180:181], v232 offset:32768
    v_mfma_f32_16x16x32_bf16 v[32:35], v[184:187], v[164:167], v[32:35]
    ds_read_b64_tr_b16 v[182:183], v232 offset:36864
    s_waitcnt lgkmcnt(6)
    v_mfma_f32_16x16x32_bf16 v[36:39], v[188:191], v[164:167], v[36:39]
    ds_read_b64_tr_b16 v[184:185], v233 offset:32768
    v_mfma_f32_16x16x32_bf16 v[4:7], v[188:191], v[160:163], v[4:7]
    ds_read_b64_tr_b16 v[186:187], v233 offset:36864
    s_waitcnt lgkmcnt(6)
    v_mfma_f32_16x16x32_bf16 v[8:11], v[192:195], v[160:163], v[8:11]
    ds_read_b64_tr_b16 v[196:197], v234 offset:32768
    v_mfma_f32_16x16x32_bf16 v[40:43], v[192:195], v[164:167], v[40:43]
    ds_read_b64_tr_b16 v[198:199], v234 offset:36864
    s_waitcnt lgkmcnt(6)
    v_mfma_f32_16x16x32_bf16 v[44:47], v[176:179], v[164:167], v[44:47]
    ds_read_b64_tr_b16 v[192:193], v235 offset:32768
    v_mfma_f32_16x16x32_bf16 v[12:15], v[176:179], v[160:163], v[12:15]
    ds_read_b64_tr_b16 v[194:195], v235 offset:36864
    s_waitcnt lgkmcnt(6)
    v_mfma_f32_16x16x32_bf16 v[16:19], v[180:183], v[160:163], v[16:19]
    v_mfma_f32_16x16x32_bf16 v[48:51], v[180:183], v[164:167], v[48:51]
    s_waitcnt lgkmcnt(4)
    v_mfma_f32_16x16x32_bf16 v[52:55], v[184:187], v[164:167], v[52:55]
    v_mfma_f32_16x16x32_bf16 v[20:23], v[184:187], v[160:163], v[20:23]
    s_waitcnt lgkmcnt(2)
    v_mfma_f32_16x16x32_bf16 v[24:27], v[196:199], v[160:163], v[24:27]
    ds_read_b128 v[176:179], v224 offset:49152
    v_mfma_f32_16x16x32_bf16 v[56:59], v[196:199], v[164:167], v[56:59]
    ds_read_b128 v[180:183], v225 offset:49152
    s_waitcnt lgkmcnt(2)
    v_mfma_f32_16x16x32_bf16 v[60:63], v[192:195], v[164:167], v[60:63]
    ds_read_b128 v[184:187], v226 offset:49152
    v_mfma_f32_16x16x32_bf16 v[28:31], v[192:195], v[160:163], v[28:31]
    ds_read_b128 v[188:191], v227 offset:49152
    s_setprio 0
.p2align 3
    s_waitcnt vmcnt(3)
    s_barrier
    s_setprio 2
    s_nop 0
    v_fmamk_f32 v168, v144, 0x3e0293ee, v248
    v_fmamk_f32 v169, v145, 0x3e0293ee, v248
    v_permlane16_swap_b32 v112, v114
    v_permlane16_swap_b32 v113, v115
    v_fmamk_f32 v170, v146, 0x3e0293ee, v248
    v_fmamk_f32 v171, v147, 0x3e0293ee, v248
    v_exp_f32 v168, v168
    v_exp_f32 v169, v169
    v_permlane16_swap_b32 v116, v118
    v_permlane16_swap_b32 v117, v119
    v_exp_f32 v170, v170
    v_exp_f32 v171, v171
    v_fmamk_f32 v172, v152, 0x3e0293ee, v249
    v_fmamk_f32 v173, v153, 0x3e0293ee, v249
    v_cndmask_b32_dpp v220, v116, v112, vcc quad_perm:[1,0,3,2] row_mask:0xf bank_mask:0xf
    v_cndmask_b32_dpp v221, v117, v113, vcc quad_perm:[1,0,3,2] row_mask:0xf bank_mask:0xf
    v_fmamk_f32 v174, v154, 0x3e0293ee, v249
    v_fmamk_f32 v175, v155, 0x3e0293ee, v249
    v_cvt_pk_bf16_f32 v160, v168, v169
    v_cvt_pk_bf16_f32 v161, v170, v171
    v_cndmask_b32_dpp v222, v118, v114, vcc quad_perm:[1,0,3,2] row_mask:0xf bank_mask:0xf
    v_cndmask_b32_dpp v223, v119, v115, vcc quad_perm:[1,0,3,2] row_mask:0xf bank_mask:0xf
    s_not_b64 vcc, vcc
    s_nop 0
    v_exp_f32 v172, v172
    v_exp_f32 v173, v173
    v_exp_f32 v174, v174
    v_exp_f32 v175, v175
    v_cndmask_b32_dpp v116, v112, v116, vcc quad_perm:[1,0,3,2] row_mask:0xf bank_mask:0xf
    v_cndmask_b32_dpp v117, v113, v117, vcc quad_perm:[1,0,3,2] row_mask:0xf bank_mask:0xf
    v_fmamk_f32 v168, v148, 0x3e0293ee, v248
    v_fmamk_f32 v169, v149, 0x3e0293ee, v248
    v_fmamk_f32 v170, v150, 0x3e0293ee, v248
    v_fmamk_f32 v171, v151, 0x3e0293ee, v248
    v_cndmask_b32_dpp v118, v114, v118, vcc quad_perm:[1,0,3,2] row_mask:0xf bank_mask:0xf
    v_cndmask_b32_dpp v119, v115, v119, vcc quad_perm:[1,0,3,2] row_mask:0xf bank_mask:0xf
    s_not_b64 vcc, vcc
    s_nop 0
    v_cvt_pk_bf16_f32 v164, v172, v173
    v_cvt_pk_bf16_f32 v165, v174, v175
    v_exp_f32 v168, v168
    v_exp_f32 v169, v169
    buffer_store_dwordx4 v[116:119], v244, s[24:27], s35 offen offset:256 sc0 sc1
    v_exp_f32 v170, v170
    v_exp_f32 v171, v171
    v_fmamk_f32 v172, v156, 0x3e0293ee, v249
    v_fmamk_f32 v173, v157, 0x3e0293ee, v249
    v_fmamk_f32 v174, v158, 0x3e0293ee, v249
    v_fmamk_f32 v175, v159, 0x3e0293ee, v249
    v_cvt_pk_bf16_f32 v162, v168, v169
    v_cvt_pk_bf16_f32 v163, v170, v171
    v_exp_f32 v172, v172
    v_exp_f32 v173, v173
    v_exp_f32 v174, v174
    v_exp_f32 v175, v175
    v_cvt_pk_bf16_f32 v166, v172, v173
    v_cvt_pk_bf16_f32 v167, v174, v175
    s_waitcnt vmcnt(1)
    v_mfma_f32_16x16x32_bf16 v[208:211], v[216:219], v[160:163], v[200:203]
    v_mfma_f32_16x16x32_bf16 v[212:215], v[216:219], v[164:167], v[204:207]
    s_waitcnt lgkmcnt(3)
    v_mfma_f32_16x16x32_bf16 v[128:131], v[176:179], v[64:67], 0
    s_setprio 3
    ds_read_b128 v[192:195], v224 offset:53248
    v_mfma_f32_16x16x32_bf16 v[136:139], v[176:179], v[80:83], 0
    s_waitcnt lgkmcnt(3)
    v_mfma_f32_16x16x32_bf16 v[136:139], v[180:183], v[84:87], v[136:139]
    ds_read_b128 v[196:199], v225 offset:53248
    v_mfma_f32_16x16x32_bf16 v[128:131], v[180:183], v[68:71], v[128:131]
    s_add_u32 m0, s58, 0x400
    s_nop 0
    buffer_load_dwordx4 v241, s[12:15], s31 offen offset:0 nt lds
    s_waitcnt lgkmcnt(3)
    v_mfma_f32_16x16x32_bf16 v[128:131], v[184:187], v[72:75], v[128:131]
    ds_read_b128 v[176:179], v226 offset:53248
    v_mfma_f32_16x16x32_bf16 v[136:139], v[184:187], v[88:91], v[136:139]
    v_max_f32_e64 v250, v208, v212
    v_cmp_nle_f32_e64 s[42:43], v250, s40
    s_waitcnt lgkmcnt(3)
    v_mfma_f32_16x16x32_bf16 v[136:139], v[188:191], v[92:95], v[136:139]
    ds_read_b128 v[180:183], v227 offset:53248
    v_mfma_f32_16x16x32_bf16 v[128:131], v[188:191], v[76:79], v[128:131]
    s_cmp_lg_u64 s[42:43], 0
    s_cbranch_scc1 L_stublead18
L_retlead18:
    s_add_u32 m0, s37, 0x1e000
    s_xor_b32 s38, s36, 0x7000
    buffer_load_dwordx4 v246, s[20:23], s38 offen offset:0 nt lds
    s_waitcnt lgkmcnt(3)
    v_mfma_f32_16x16x32_bf16 v[132:135], v[192:195], v[64:67], 0
    ds_read_b64_tr_b16 v[184:185], v228 offset:40960
    v_mfma_f32_16x16x32_bf16 v[140:143], v[192:195], v[80:83], 0
    ds_read_b64_tr_b16 v[186:187], v228 offset:45056
    s_waitcnt lgkmcnt(4)
    v_mfma_f32_16x16x32_bf16 v[140:143], v[196:199], v[84:87], v[140:143]
    ds_read_b64_tr_b16 v[188:189], v229 offset:40960
    v_mfma_f32_16x16x32_bf16 v[132:135], v[196:199], v[68:71], v[132:135]
    ds_read_b64_tr_b16 v[190:191], v229 offset:45056
    s_waitcnt lgkmcnt(5)
    v_mfma_f32_16x16x32_bf16 v[132:135], v[176:179], v[72:75], v[132:135]
    ds_read_b64_tr_b16 v[192:193], v230 offset:40960
    v_mfma_f32_16x16x32_bf16 v[140:143], v[176:179], v[88:91], v[140:143]
    ds_read_b64_tr_b16 v[194:195], v230 offset:45056
    s_waitcnt lgkmcnt(6)
    v_mfma_f32_16x16x32_bf16 v[140:143], v[180:183], v[92:95], v[140:143]
    ds_read_b64_tr_b16 v[176:177], v231 offset:40960
    v_mfma_f32_16x16x32_bf16 v[132:135], v[180:183], v[76:79], v[132:135]
    ds_read_b64_tr_b16 v[178:179], v231 offset:45056
    s_waitcnt lgkmcnt(6)
    v_mfma_f32_16x16x32_bf16 v[0:3], v[184:187], v[160:163], v[0:3]
    ds_read_b64_tr_b16 v[180:181], v232 offset:40960
    v_mfma_f32_16x16x32_bf16 v[32:35], v[184:187], v[164:167], v[32:35]
    ds_read_b64_tr_b16 v[182:183], v232 offset:45056
    s_waitcnt lgkmcnt(6)
    v_mfma_f32_16x16x32_bf16 v[36:39], v[188:191], v[164:167], v[36:39]
    ds_read_b64_tr_b16 v[184:185], v233 offset:40960
    v_mfma_f32_16x16x32_bf16 v[4:7], v[188:191], v[160:163], v[4:7]
    ds_read_b64_tr_b16 v[186:187], v233 offset:45056
    s_waitcnt lgkmcnt(6)
    v_mfma_f32_16x16x32_bf16 v[8:11], v[192:195], v[160:163], v[8:11]
    ds_read_b64_tr_b16 v[196:197], v234 offset:40960
    v_mfma_f32_16x16x32_bf16 v[40:43], v[192:195], v[164:167], v[40:43]
    ds_read_b64_tr_b16 v[198:199], v234 offset:45056
    s_waitcnt lgkmcnt(6)
    v_mfma_f32_16x16x32_bf16 v[44:47], v[176:179], v[164:167], v[44:47]
    ds_read_b64_tr_b16 v[192:193], v235 offset:40960
    v_mfma_f32_16x16x32_bf16 v[12:15], v[176:179], v[160:163], v[12:15]
    ds_read_b64_tr_b16 v[194:195], v235 offset:45056
    s_waitcnt lgkmcnt(6)
    v_mfma_f32_16x16x32_bf16 v[16:19], v[180:183], v[160:163], v[16:19]
    v_mfma_f32_16x16x32_bf16 v[48:51], v[180:183], v[164:167], v[48:51]
    s_waitcnt lgkmcnt(4)
    v_mfma_f32_16x16x32_bf16 v[52:55], v[184:187], v[164:167], v[52:55]
    v_mfma_f32_16x16x32_bf16 v[20:23], v[184:187], v[160:163], v[20:23]
    s_waitcnt lgkmcnt(2)
    v_mfma_f32_16x16x32_bf16 v[24:27], v[196:199], v[160:163], v[24:27]
    ds_read_b128 v[176:179], v224 offset:57344
    v_mfma_f32_16x16x32_bf16 v[56:59], v[196:199], v[164:167], v[56:59]
    ds_read_b128 v[180:183], v225 offset:57344
    s_waitcnt lgkmcnt(2)
    v_mfma_f32_16x16x32_bf16 v[60:63], v[192:195], v[164:167], v[60:63]
    ds_read_b128 v[184:187], v226 offset:57344
    v_mfma_f32_16x16x32_bf16 v[28:31], v[192:195], v[160:163], v[28:31]
    ds_read_b128 v[188:191], v227 offset:57344
    s_setprio 0
.p2align 3
    s_waitcnt vmcnt(3)
    s_barrier
    s_setprio 2
    s_nop 0
    v_fmamk_f32 v168, v128, 0x3e0293ee, v248
    v_fmamk_f32 v169, v129, 0x3e0293ee, v248
    v_permlane16_swap_b32 v120, v122
    v_permlane16_swap_b32 v121, v123
    v_fmamk_f32 v170, v130, 0x3e0293ee, v248
    v_fmamk_f32 v171, v131, 0x3e0293ee, v248
    v_exp_f32 v168, v168
    v_exp_f32 v169, v169
    v_permlane16_swap_b32 v124, v126
    v_permlane16_swap_b32 v125, v127
    v_exp_f32 v170, v170
    v_exp_f32 v171, v171
    v_fmamk_f32 v172, v136, 0x3e0293ee, v249
    v_fmamk_f32 v173, v137, 0x3e0293ee, v249
    v_cndmask_b32_dpp v112, v124, v120, vcc quad_perm:[1,0,3,2] row_mask:0xf bank_mask:0xf
    v_cndmask_b32_dpp v113, v125, v121, vcc quad_perm:[1,0,3,2] row_mask:0xf bank_mask:0xf
    v_fmamk_f32 v174, v138, 0x3e0293ee, v249
    v_fmamk_f32 v175, v139, 0x3e0293ee, v249
    v_cvt_pk_bf16_f32 v160, v168, v169
    v_cvt_pk_bf16_f32 v161, v170, v171
    v_cndmask_b32_dpp v114, v126, v122, vcc quad_perm:[1,0,3,2] row_mask:0xf bank_mask:0xf
    v_cndmask_b32_dpp v115, v127, v123, vcc quad_perm:[1,0,3,2] row_mask:0xf bank_mask:0xf
    s_not_b64 vcc, vcc
    s_nop 0
    v_exp_f32 v172, v172
    v_exp_f32 v173, v173
    v_exp_f32 v174, v174
    v_exp_f32 v175, v175
    v_cndmask_b32_dpp v124, v120, v124, vcc quad_perm:[1,0,3,2] row_mask:0xf bank_mask:0xf
    v_cndmask_b32_dpp v125, v121, v125, vcc quad_perm:[1,0,3,2] row_mask:0xf bank_mask:0xf
    v_fmamk_f32 v168, v132, 0x3e0293ee, v248
    v_fmamk_f32 v169, v133, 0x3e0293ee, v248
    v_fmamk_f32 v170, v134, 0x3e0293ee, v248
    v_fmamk_f32 v171, v135, 0x3e0293ee, v248
    v_cndmask_b32_dpp v126, v122, v126, vcc quad_perm:[1,0,3,2] row_mask:0xf bank_mask:0xf
    v_cndmask_b32_dpp v127, v123, v127, vcc quad_perm:[1,0,3,2] row_mask:0xf bank_mask:0xf
    s_not_b64 vcc, vcc
    s_nop 0
    v_cvt_pk_bf16_f32 v164, v172, v173
    v_cvt_pk_bf16_f32 v165, v174, v175
    v_exp_f32 v168, v168
    v_exp_f32 v169, v169
    buffer_store_dwordx4 v[112:115], v244, s[24:27], s35 offen offset:128 sc0 sc1
    v_exp_f32 v170, v170
    v_exp_f32 v171, v171
    v_fmamk_f32 v172, v140, 0x3e0293ee, v249
    v_fmamk_f32 v173, v141, 0x3e0293ee, v249
    v_fmamk_f32 v174, v142, 0x3e0293ee, v249
    v_fmamk_f32 v175, v143, 0x3e0293ee, v249
    v_cvt_pk_bf16_f32 v162, v168, v169
    v_cvt_pk_bf16_f32 v163, v170, v171
    v_exp_f32 v172, v172
    v_exp_f32 v173, v173
    v_exp_f32 v174, v174
    v_exp_f32 v175, v175
    v_cvt_pk_bf16_f32 v166, v172, v173
    v_cvt_pk_bf16_f32 v167, v174, v175
    s_waitcnt vmcnt(1)
    v_mfma_f32_16x16x32_bf16 v[200:203], v[216:219], v[160:163], v[208:211]
    v_mfma_f32_16x16x32_bf16 v[204:207], v[216:219], v[164:167], v[212:215]
    s_waitcnt lgkmcnt(3)
    v_mfma_f32_16x16x32_bf16 v[144:147], v[176:179], v[64:67], 0
    s_setprio 3
    ds_read_b128 v[192:195], v224 offset:61440
    v_mfma_f32_16x16x32_bf16 v[152:155], v[176:179], v[80:83], 0
    s_waitcnt lgkmcnt(3)
    v_mfma_f32_16x16x32_bf16 v[152:155], v[180:183], v[84:87], v[152:155]
    ds_read_b128 v[196:199], v225 offset:61440
    v_mfma_f32_16x16x32_bf16 v[144:147], v[180:183], v[68:71], v[144:147]
    s_add_u32 m0, s58, 0x800
    s_nop 0
    buffer_load_dwordx4 v242, s[12:15], s31 offen offset:0 nt lds
    s_waitcnt lgkmcnt(3)
    v_mfma_f32_16x16x32_bf16 v[144:147], v[184:187], v[72:75], v[144:147]
    ds_read_b128 v[176:179], v226 offset:61440
    v_mfma_f32_16x16x32_bf16 v[152:155], v[184:187], v[88:91], v[152:155]
    v_max_f32_e64 v250, v200, v204
    v_cmp_nle_f32_e64 s[42:43], v250, s40
    s_waitcnt lgkmcnt(3)
    v_mfma_f32_16x16x32_bf16 v[152:155], v[188:191], v[92:95], v[152:155]
    ds_read_b128 v[180:183], v227 offset:61440
    v_mfma_f32_16x16x32_bf16 v[144:147], v[188:191], v[76:79], v[144:147]
    s_cmp_lg_u64 s[42:43], 0
    s_cbranch_scc1 L_stublead19
L_retlead19:
    s_add_u32 m0, s58, 0xc00
    s_nop 0
    buffer_load_dwordx4 v243, s[12:15], s31 offen offset:0 nt lds
    s_waitcnt lgkmcnt(3)
    v_mfma_f32_16x16x32_bf16 v[148:151], v[192:195], v[64:67], 0
    ds_read_b64_tr_b16 v[184:185], v228 offset:49152
    v_mfma_f32_16x16x32_bf16 v[156:159], v[192:195], v[80:83], 0
    ds_read_b64_tr_b16 v[186:187], v228 offset:53248
    s_waitcnt lgkmcnt(4)
    v_mfma_f32_16x16x32_bf16 v[156:159], v[196:199], v[84:87], v[156:159]
    ds_read_b64_tr_b16 v[188:189], v229 offset:49152
    v_mfma_f32_16x16x32_bf16 v[148:151], v[196:199], v[68:71], v[148:151]
    ds_read_b64_tr_b16 v[190:191], v229 offset:53248
    s_waitcnt lgkmcnt(5)
    v_mfma_f32_16x16x32_bf16 v[148:151], v[176:179], v[72:75], v[148:151]
    ds_read_b64_tr_b16 v[192:193], v230 offset:49152
    v_mfma_f32_16x16x32_bf16 v[156:159], v[176:179], v[88:91], v[156:159]
    ds_read_b64_tr_b16 v[194:195], v230 offset:53248
    s_waitcnt lgkmcnt(6)
    v_mfma_f32_16x16x32_bf16 v[156:159], v[180:183], v[92:95], v[156:159]
    ds_read_b64_tr_b16 v[176:177], v231 offset:49152
    v_mfma_f32_16x16x32_bf16 v[148:151], v[180:183], v[76:79], v[148:151]
    ds_read_b64_tr_b16 v[178:179], v231 offset:53248
    s_waitcnt lgkmcnt(6)
    v_mfma_f32_16x16x32_bf16 v[0:3], v[184:187], v[160:163], v[0:3]
    ds_read_b64_tr_b16 v[180:181], v232 offset:49152
    v_mfma_f32_16x16x32_bf16 v[32:35], v[184:187], v[164:167], v[32:35]
    ds_read_b64_tr_b16 v[182:183], v232 offset:53248
    s_waitcnt lgkmcnt(6)
    v_mfma_f32_16x16x32_bf16 v[36:39], v[188:191], v[164:167], v[36:39]
    ds_read_b64_tr_b16 v[184:185], v233 offset:49152
    v_mfma_f32_16x16x32_bf16 v[4:7], v[188:191], v[160:163], v[4:7]
    ds_read_b64_tr_b16 v[186:187], v233 offset:53248
    s_waitcnt lgkmcnt(6)
    v_mfma_f32_16x16x32_bf16 v[8:11], v[192:195], v[160:163], v[8:11]
    ds_read_b64_tr_b16 v[196:197], v234 offset:49152
    v_mfma_f32_16x16x32_bf16 v[40:43], v[192:195], v[164:167], v[40:43]
    ds_read_b64_tr_b16 v[198:199], v234 offset:53248
    s_waitcnt lgkmcnt(6)
    v_mfma_f32_16x16x32_bf16 v[44:47], v[176:179], v[164:167], v[44:47]
    ds_read_b64_tr_b16 v[192:193], v235 offset:49152
    v_mfma_f32_16x16x32_bf16 v[12:15], v[176:179], v[160:163], v[12:15]
    ds_read_b64_tr_b16 v[194:195], v235 offset:53248
    s_waitcnt lgkmcnt(6)
    v_mfma_f32_16x16x32_bf16 v[16:19], v[180:183], v[160:163], v[16:19]
    v_mfma_f32_16x16x32_bf16 v[48:51], v[180:183], v[164:167], v[48:51]
    s_waitcnt lgkmcnt(4)
    v_mfma_f32_16x16x32_bf16 v[52:55], v[184:187], v[164:167], v[52:55]
    v_mfma_f32_16x16x32_bf16 v[20:23], v[184:187], v[160:163], v[20:23]
    s_waitcnt lgkmcnt(2)
    v_mfma_f32_16x16x32_bf16 v[24:27], v[196:199], v[160:163], v[24:27]
    ds_read_b128 v[176:179], v224 offset:0
    v_mfma_f32_16x16x32_bf16 v[56:59], v[196:199], v[164:167], v[56:59]
    ds_read_b128 v[180:183], v225 offset:0
    s_waitcnt lgkmcnt(2)
    v_mfma_f32_16x16x32_bf16 v[60:63], v[192:195], v[164:167], v[60:63]
    ds_read_b128 v[184:187], v226 offset:0
    v_mfma_f32_16x16x32_bf16 v[28:31], v[192:195], v[160:163], v[28:31]
    ds_read_b128 v[188:191], v227 offset:0
    s_setprio 0
.p2align 3
    s_waitcnt vmcnt(3)
    s_barrier
    s_setprio 2
    s_nop 0
    v_fmamk_f32 v168, v144, 0x3e0293ee, v248
    v_fmamk_f32 v169, v145, 0x3e0293ee, v248
    buffer_store_dwordx4 v[124:127], v244, s[24:27], s35 offen offset:384 sc0 sc1
    v_fmamk_f32 v170, v146, 0x3e0293ee, v248
    v_fmamk_f32 v171, v147, 0x3e0293ee, v248
    v_exp_f32 v168, v168
    v_exp_f32 v169, v169
    v_exp_f32 v170, v170
    v_exp_f32 v171, v171
    v_fmamk_f32 v172, v152, 0x3e0293ee, v249
    v_fmamk_f32 v173, v153, 0x3e0293ee, v249
    v_fmamk_f32 v174, v154, 0x3e0293ee, v249
    v_fmamk_f32 v175, v155, 0x3e0293ee, v249
    v_cvt_pk_bf16_f32 v160, v168, v169
    v_cvt_pk_bf16_f32 v161, v170, v171
    v_exp_f32 v172, v172
    v_exp_f32 v173, v173
    v_exp_f32 v174, v174
    v_exp_f32 v175, v175
    v_fmamk_f32 v168, v148, 0x3e0293ee, v248
    v_fmamk_f32 v169, v149, 0x3e0293ee, v248
    v_fmamk_f32 v170, v150, 0x3e0293ee, v248
    v_fmamk_f32 v171, v151, 0x3e0293ee, v248
    v_cvt_pk_bf16_f32 v164, v172, v173
    v_cvt_pk_bf16_f32 v165, v174, v175
    v_exp_f32 v168, v168
    v_exp_f32 v169, v169
    v_exp_f32 v170, v170
    v_exp_f32 v171, v171
    v_fmamk_f32 v172, v156, 0x3e0293ee, v249
    v_fmamk_f32 v173, v157, 0x3e0293ee, v249
    v_fmamk_f32 v174, v158, 0x3e0293ee, v249
    v_fmamk_f32 v175, v159, 0x3e0293ee, v249
    v_cvt_pk_bf16_f32 v162, v168, v169
    v_cvt_pk_bf16_f32 v163, v170, v171
    s_waitcnt vmcnt(1)
    s_nop 0
    ds_read_b128 v[112:115], v236 offset:0
    ds_read_b128 v[116:119], v237 offset:0
    ds_read_b128 v[120:123], v238 offset:0
    ds_read_b128 v[124:127], v239 offset:0
    v_exp_f32 v172, v172
    v_exp_f32 v173, v173
    v_exp_f32 v174, v174
    v_exp_f32 v175, v175
    v_cvt_pk_bf16_f32 v166, v172, v173
    v_cvt_pk_bf16_f32 v167, v174, v175
    s_waitcnt vmcnt(1)
    v_mfma_f32_16x16x32_bf16 v[208:211], v[216:219], v[160:163], v[200:203]
    v_mfma_f32_16x16x32_bf16 v[212:215], v[216:219], v[164:167], v[204:207]
    s_waitcnt lgkmcnt(7)
    v_mfma_f32_16x16x32_bf16 v[128:131], v[176:179], v[96:99], 0
    s_setprio 3
    ds_read_b128 v[192:195], v224 offset:4096
    s_waitcnt lgkmcnt(4)
    v_mfma_f32_16x16x32_bf16 v[136:139], v[176:179], v[112:115], 0
    s_waitcnt lgkmcnt(3)
    v_mfma_f32_16x16x32_bf16 v[136:139], v[180:183], v[116:119], v[136:139]
    ds_read_b128 v[196:199], v225 offset:4096
    v_mfma_f32_16x16x32_bf16 v[128:131], v[180:183], v[100:103], v[128:131]
    s_waitcnt lgkmcnt(2)
    s_cmp_eq_u32 s29, 3
    s_cselect_b32 s14, 0, s14
    s_add_u32 m0, s58, 0x0
    s_add_u32 s38, s32, 0x2000000
    buffer_load_dwordx4 v240, s[12:15], s38 offen offset:0 nt lds
    v_mfma_f32_16x16x32_bf16 v[128:131], v[184:187], v[104:107], v[128:131]
    ds_read_b128 v[176:179], v226 offset:4096
    v_mfma_f32_16x16x32_bf16 v[136:139], v[184:187], v[120:123], v[136:139]
    v_max_f32_e64 v250, v208, v212
    v_cmp_nle_f32_e64 s[42:43], v250, s40
    v_mfma_f32_16x16x32_bf16 v[136:139], v[188:191], v[124:127], v[136:139]
    ds_read_b128 v[180:183], v227 offset:4096
    v_mfma_f32_16x16x32_bf16 v[128:131], v[188:191], v[108:111], v[128:131]
    s_cmp_lg_u64 s[42:43], 0
    s_cbranch_scc1 L_stublead20
L_retlead20:
    s_add_u32 m0, s58, 0x400
    s_add_u32 s38, s32, 0x2000000
    buffer_load_dwordx4 v241, s[12:15], s38 offen offset:0 nt lds
    s_waitcnt lgkmcnt(3)
    v_mfma_f32_16x16x32_bf16 v[132:135], v[192:195], v[96:99], 0
    ds_read_b64_tr_b16 v[184:185], v228 offset:57344
    v_mfma_f32_16x16x32_bf16 v[140:143], v[192:195], v[112:115], 0
    ds_read_b64_tr_b16 v[186:187], v228 offset:61440
    s_waitcnt lgkmcnt(4)
    v_mfma_f32_16x16x32_bf16 v[140:143], v[196:199], v[116:119], v[140:143]
    ds_read_b64_tr_b16 v[188:189], v229 offset:57344
    v_mfma_f32_16x16x32_bf16 v[132:135], v[196:199], v[100:103], v[132:135]
    ds_read_b64_tr_b16 v[190:191], v229 offset:61440
    s_waitcnt lgkmcnt(5)
    v_mfma_f32_16x16x32_bf16 v[132:135], v[176:179], v[104:107], v[132:135]
    ds_read_b64_tr_b16 v[192:193], v230 offset:57344
    v_mfma_f32_16x16x32_bf16 v[140:143], v[176:179], v[120:123], v[140:143]
    ds_read_b64_tr_b16 v[194:195], v230 offset:61440
    s_waitcnt lgkmcnt(6)
    v_mfma_f32_16x16x32_bf16 v[140:143], v[180:183], v[124:127], v[140:143]
    ds_read_b64_tr_b16 v[176:177], v231 offset:57344
    v_mfma_f32_16x16x32_bf16 v[132:135], v[180:183], v[108:111], v[132:135]
    ds_read_b64_tr_b16 v[178:179], v231 offset:61440
    s_waitcnt lgkmcnt(6)
    v_mfma_f32_16x16x32_bf16 v[0:3], v[184:187], v[160:163], v[0:3]
    ds_read_b64_tr_b16 v[180:181], v232 offset:57344
    v_mfma_f32_16x16x32_bf16 v[32:35], v[184:187], v[164:167], v[32:35]
    ds_read_b64_tr_b16 v[182:183], v232 offset:61440
    s_waitcnt lgkmcnt(6)
    v_mfma_f32_16x16x32_bf16 v[36:39], v[188:191], v[164:167], v[36:39]
    ds_read_b64_tr_b16 v[184:185], v233 offset:57344
    v_mfma_f32_16x16x32_bf16 v[4:7], v[188:191], v[160:163], v[4:7]
    ds_read_b64_tr_b16 v[186:187], v233 offset:61440
    s_waitcnt lgkmcnt(6)
    v_mfma_f32_16x16x32_bf16 v[8:11], v[192:195], v[160:163], v[8:11]
    ds_read_b64_tr_b16 v[196:197], v234 offset:57344
    v_mfma_f32_16x16x32_bf16 v[40:43], v[192:195], v[164:167], v[40:43]
    ds_read_b64_tr_b16 v[198:199], v234 offset:61440
    s_waitcnt lgkmcnt(6)
    v_mfma_f32_16x16x32_bf16 v[44:47], v[176:179], v[164:167], v[44:47]
    ds_read_b64_tr_b16 v[192:193], v235 offset:57344
    v_mfma_f32_16x16x32_bf16 v[12:15], v[176:179], v[160:163], v[12:15]
    ds_read_b64_tr_b16 v[194:195], v235 offset:61440
    s_waitcnt lgkmcnt(6)
    v_mfma_f32_16x16x32_bf16 v[16:19], v[180:183], v[160:163], v[16:19]
    v_mfma_f32_16x16x32_bf16 v[48:51], v[180:183], v[164:167], v[48:51]
    s_waitcnt lgkmcnt(4)
    v_mfma_f32_16x16x32_bf16 v[52:55], v[184:187], v[164:167], v[52:55]
    v_mfma_f32_16x16x32_bf16 v[20:23], v[184:187], v[160:163], v[20:23]
    s_waitcnt lgkmcnt(2)
    v_mfma_f32_16x16x32_bf16 v[24:27], v[196:199], v[160:163], v[24:27]
    ds_read_b128 v[176:179], v224 offset:8192
    v_mfma_f32_16x16x32_bf16 v[56:59], v[196:199], v[164:167], v[56:59]
    ds_read_b128 v[180:183], v225 offset:8192
    s_waitcnt lgkmcnt(2)
    v_mfma_f32_16x16x32_bf16 v[60:63], v[192:195], v[164:167], v[60:63]
    ds_read_b128 v[184:187], v226 offset:8192
    v_mfma_f32_16x16x32_bf16 v[28:31], v[192:195], v[160:163], v[28:31]
    ds_read_b128 v[188:191], v227 offset:8192
    s_cmp_lg_u32 s29, 3
    s_cbranch_scc1 L_looplead
L_prelead:
L_lastlead:
    s_mov_b32 s50, s35
    s_mov_b32 s34, s32
    s_mov_b32 s32, s30
    s_xor_b32 s30, s30, 0x4000
    s_mov_b32 s35, s33
    s_mov_b32 s33, s31
    s_xor_b32 s31, s31, 0x4000
    s_setprio 0
.p2align 3
    v_rcp_f32 v208, v208
    v_rcp_f32 v212, v212
    v_max_f32_e64 v248, v128, v129
    v_max_f32_e64 v249, v136, v137
    v_max3_f32 v248, v248, v130, v131
    v_max3_f32 v249, v249, v138, v139
    v_max3_f32 v248, v248, v132, v133
    v_max3_f32 v249, v249, v140, v141
    v_max3_f32 v248, v248, v134, v135
    v_max3_f32 v249, v249, v142, v143
    s_nop 1
    v_permlane32_swap_b32 v248, v249
    v_max_f32 v248, v248, v249
    v_mov_b32 v249, v248
    s_nop 1
    v_permlane16_swap_b32 v248, v249
    v_max_f32 v248, v248, v249
    v_mul_f32 v248, 0xbe0293ee, v248
    v_mov_b32 v249, v248
    s_nop 1
    v_permlane32_swap_b32 v248, v249
.p2align 3
    v_fmamk_f32 v168, v128, 0x3e0293ee, v248
    v_fmamk_f32 v169, v129, 0x3e0293ee, v248
    v_fmamk_f32 v170, v130, 0x3e0293ee, v248
    v_fmamk_f32 v171, v131, 0x3e0293ee, v248
    v_exp_f32 v168, v168
    v_exp_f32 v169, v169
    v_exp_f32 v170, v170
    v_exp_f32 v171, v171
    v_fmamk_f32 v172, v136, 0x3e0293ee, v249
    v_fmamk_f32 v173, v137, 0x3e0293ee, v249
    v_fmamk_f32 v174, v138, 0x3e0293ee, v249
    v_fmamk_f32 v175, v139, 0x3e0293ee, v249
    s_setprio 2
    s_nop 0
    v_cvt_pk_bf16_f32 v160, v168, v169
    v_cvt_pk_bf16_f32 v161, v170, v171
    v_exp_f32 v172, v172
    v_exp_f32 v173, v173
    v_exp_f32 v174, v174
    v_exp_f32 v175, v175
    v_fmamk_f32 v168, v132, 0x3e0293ee, v248
    v_fmamk_f32 v169, v133, 0x3e0293ee, v248
    v_fmamk_f32 v170, v134, 0x3e0293ee, v248
    v_fmamk_f32 v171, v135, 0x3e0293ee, v248
    v_cvt_pk_bf16_f32 v164, v172, v173
    v_cvt_pk_bf16_f32 v165, v174, v175
    v_exp_f32 v168, v168
    v_exp_f32 v169, v169
    v_exp_f32 v170, v170
    v_exp_f32 v171, v171
    v_fmamk_f32 v172, v140, 0x3e0293ee, v249
    v_fmamk_f32 v173, v141, 0x3e0293ee, v249
    v_fmamk_f32 v174, v142, 0x3e0293ee, v249
    v_fmamk_f32 v175, v143, 0x3e0293ee, v249
    v_cvt_pk_bf16_f32 v162, v168, v169
    v_cvt_pk_bf16_f32 v163, v170, v171
    v_exp_f32 v172, v172
    v_exp_f32 v173, v173
    v_exp_f32 v174, v174
    v_exp_f32 v175, v175
    v_cvt_pk_bf16_f32 v166, v172, v173
    v_cvt_pk_bf16_f32 v167, v174, v175
    v_pk_mul_f32 v[0:1], v[0:1], v[208:209] op_sel_hi:[1,0]
    v_pk_mul_f32 v[2:3], v[2:3], v[208:209] op_sel_hi:[1,0]
    v_pk_mul_f32 v[4:5], v[4:5], v[208:209] op_sel_hi:[1,0]
    v_pk_mul_f32 v[6:7], v[6:7], v[208:209] op_sel_hi:[1,0]
    v_cvt_pk_bf16_f32 v64, v0, v1
    v_cvt_pk_bf16_f32 v65, v2, v3
    v_cvt_pk_bf16_f32 v66, v4, v5
    v_cvt_pk_bf16_f32 v67, v6, v7
    v_pk_mul_f32 v[8:9], v[8:9], v[208:209] op_sel_hi:[1,0]
    v_pk_mul_f32 v[10:11], v[10:11], v[208:209] op_sel_hi:[1,0]
    v_pk_mul_f32 v[12:13], v[12:13], v[208:209] op_sel_hi:[1,0]
    v_pk_mul_f32 v[14:15], v[14:15], v[208:209] op_sel_hi:[1,0]
    v_cvt_pk_bf16_f32 v68, v8, v9
    v_cvt_pk_bf16_f32 v69, v10, v11
    v_cvt_pk_bf16_f32 v70, v12, v13
    v_cvt_pk_bf16_f32 v71, v14, v15
    v_pk_mul_f32 v[16:17], v[16:17], v[208:209] op_sel_hi:[1,0]
    v_pk_mul_f32 v[18:19], v[18:19], v[208:209] op_sel_hi:[1,0]
    v_pk_mul_f32 v[20:21], v[20:21], v[208:209] op_sel_hi:[1,0]
    v_pk_mul_f32 v[22:23], v[22:23], v[208:209] op_sel_hi:[1,0]
    v_cvt_pk_bf16_f32 v72, v16, v17
    v_cvt_pk_bf16_f32 v73, v18, v19
    v_cvt_pk_bf16_f32 v74, v20, v21
    v_cvt_pk_bf16_f32 v75, v22, v23
    v_pk_mul_f32 v[24:25], v[24:25], v[208:209] op_sel_hi:[1,0]
    v_pk_mul_f32 v[26:27], v[26:27], v[208:209] op_sel_hi:[1,0]
    v_pk_mul_f32 v[28:29], v[28:29], v[208:209] op_sel_hi:[1,0]
    v_pk_mul_f32 v[30:31], v[30:31], v[208:209] op_sel_hi:[1,0]
    v_cvt_pk_bf16_f32 v76, v24, v25
    v_cvt_pk_bf16_f32 v77, v26, v27
    v_cvt_pk_bf16_f32 v78, v28, v29
    v_cvt_pk_bf16_f32 v79, v30, v31
    v_pk_mul_f32 v[32:33], v[32:33], v[212:213] op_sel_hi:[1,0]
    v_pk_mul_f32 v[34:35], v[34:35], v[212:213] op_sel_hi:[1,0]
    v_pk_mul_f32 v[36:37], v[36:37], v[212:213] op_sel_hi:[1,0]
    v_pk_mul_f32 v[38:39], v[38:39], v[212:213] op_sel_hi:[1,0]
    v_cvt_pk_bf16_f32 v80, v32, v33
    v_cvt_pk_bf16_f32 v81, v34, v35
    v_cvt_pk_bf16_f32 v82, v36, v37
    v_cvt_pk_bf16_f32 v83, v38, v39
    v_pk_mul_f32 v[40:41], v[40:41], v[212:213] op_sel_hi:[1,0]
    v_pk_mul_f32 v[42:43], v[42:43], v[212:213] op_sel_hi:[1,0]
    v_pk_mul_f32 v[44:45], v[44:45], v[212:213] op_sel_hi:[1,0]
    v_pk_mul_f32 v[46:47], v[46:47], v[212:213] op_sel_hi:[1,0]
    v_cvt_pk_bf16_f32 v84, v40, v41
    v_cvt_pk_bf16_f32 v85, v42, v43
    v_cvt_pk_bf16_f32 v86, v44, v45
    v_cvt_pk_bf16_f32 v87, v46, v47
    v_pk_mul_f32 v[48:49], v[48:49], v[212:213] op_sel_hi:[1,0]
    v_pk_mul_f32 v[50:51], v[50:51], v[212:213] op_sel_hi:[1,0]
    v_pk_mul_f32 v[52:53], v[52:53], v[212:213] op_sel_hi:[1,0]
    v_pk_mul_f32 v[54:55], v[54:55], v[212:213] op_sel_hi:[1,0]
    v_cvt_pk_bf16_f32 v88, v48, v49
    v_cvt_pk_bf16_f32 v89, v50, v51
    v_cvt_pk_bf16_f32 v90, v52, v53
    v_cvt_pk_bf16_f32 v91, v54, v55
    v_pk_mul_f32 v[56:57], v[56:57], v[212:213] op_sel_hi:[1,0]
    v_pk_mul_f32 v[58:59], v[58:59], v[212:213] op_sel_hi:[1,0]
    v_pk_mul_f32 v[60:61], v[60:61], v[212:213] op_sel_hi:[1,0]
    v_pk_mul_f32 v[62:63], v[62:63], v[212:213] op_sel_hi:[1,0]
    v_cvt_pk_bf16_f32 v92, v56, v57
    v_cvt_pk_bf16_f32 v93, v58, v59
    v_cvt_pk_bf16_f32 v94, v60, v61
    v_cvt_pk_bf16_f32 v95, v62, v63
    v_mfma_f32_16x16x32_bf16 v[200:203], v[216:219], v[160:163], 0
    v_mfma_f32_16x16x32_bf16 v[204:207], v[216:219], v[164:167], 0
    s_waitcnt lgkmcnt(3)
    v_mfma_f32_16x16x32_bf16 v[144:147], v[176:179], v[96:99], 0
    s_setprio 3
    ds_read_b128 v[192:195], v224 offset:12288
    v_mfma_f32_16x16x32_bf16 v[152:155], v[176:179], v[112:115], 0
    s_waitcnt lgkmcnt(3)
    v_mfma_f32_16x16x32_bf16 v[152:155], v[180:183], v[116:119], v[152:155]
    ds_read_b128 v[196:199], v225 offset:12288
    v_mfma_f32_16x16x32_bf16 v[144:147], v[180:183], v[100:103], v[144:147]
    s_waitcnt lgkmcnt(3)
    v_mfma_f32_16x16x32_bf16 v[144:147], v[184:187], v[104:107], v[144:147]
    ds_read_b128 v[176:179], v226 offset:12288
    v_mfma_f32_16x16x32_bf16 v[152:155], v[184:187], v[120:123], v[152:155]
    s_waitcnt lgkmcnt(3)
    v_mfma_f32_16x16x32_bf16 v[152:155], v[188:191], v[124:127], v[152:155]
    ds_read_b128 v[180:183], v227 offset:12288
    v_mfma_f32_16x16x32_bf16 v[144:147], v[188:191], v[108:111], v[144:147]
    s_waitcnt lgkmcnt(3)
    v_mfma_f32_16x16x32_bf16 v[148:151], v[192:195], v[96:99], 0
    ds_read_b64_tr_b16 v[184:185], v228 offset:0
    v_mfma_f32_16x16x32_bf16 v[156:159], v[192:195], v[112:115], 0
    ds_read_b64_tr_b16 v[186:187], v228 offset:4096
    s_waitcnt lgkmcnt(4)
    v_mfma_f32_16x16x32_bf16 v[156:159], v[196:199], v[116:119], v[156:159]
    ds_read_b64_tr_b16 v[188:189], v229 offset:0
    v_mfma_f32_16x16x32_bf16 v[148:151], v[196:199], v[100:103], v[148:151]
    ds_read_b64_tr_b16 v[190:191], v229 offset:4096
    s_waitcnt lgkmcnt(5)
    v_mfma_f32_16x16x32_bf16 v[148:151], v[176:179], v[104:107], v[148:151]
    ds_read_b64_tr_b16 v[192:193], v230 offset:0
    v_mfma_f32_16x16x32_bf16 v[156:159], v[176:179], v[120:123], v[156:159]
    ds_read_b64_tr_b16 v[194:195], v230 offset:4096
    s_waitcnt lgkmcnt(6)
    v_mfma_f32_16x16x32_bf16 v[156:159], v[180:183], v[124:127], v[156:159]
    ds_read_b64_tr_b16 v[176:177], v231 offset:0
    v_mfma_f32_16x16x32_bf16 v[148:151], v[180:183], v[108:111], v[148:151]
    ds_read_b64_tr_b16 v[178:179], v231 offset:4096
    s_waitcnt lgkmcnt(6)
    v_mfma_f32_16x16x32_bf16 v[0:3], v[184:187], v[160:163], 0
    ds_read_b64_tr_b16 v[180:181], v232 offset:0
    v_mfma_f32_16x16x32_bf16 v[32:35], v[184:187], v[164:167], 0
    ds_read_b64_tr_b16 v[182:183], v232 offset:4096
    s_waitcnt lgkmcnt(6)
    v_mfma_f32_16x16x32_bf16 v[36:39], v[188:191], v[164:167], 0
    ds_read_b64_tr_b16 v[184:185], v233 offset:0
    v_mfma_f32_16x16x32_bf16 v[4:7], v[188:191], v[160:163], 0
    ds_read_b64_tr_b16 v[186:187], v233 offset:4096
    s_waitcnt lgkmcnt(6)
    v_mfma_f32_16x16x32_bf16 v[8:11], v[192:195], v[160:163], 0
    ds_read_b64_tr_b16 v[196:197], v234 offset:0
    v_mfma_f32_16x16x32_bf16 v[40:43], v[192:195], v[164:167], 0
    ds_read_b64_tr_b16 v[198:199], v234 offset:4096
    s_waitcnt lgkmcnt(6)
    v_mfma_f32_16x16x32_bf16 v[44:47], v[176:179], v[164:167], 0
    ds_read_b64_tr_b16 v[192:193], v235 offset:0
    v_mfma_f32_16x16x32_bf16 v[12:15], v[176:179], v[160:163], 0
    ds_read_b64_tr_b16 v[194:195], v235 offset:4096
    s_waitcnt lgkmcnt(6)
    v_mfma_f32_16x16x32_bf16 v[16:19], v[180:183], v[160:163], 0
    v_mfma_f32_16x16x32_bf16 v[48:51], v[180:183], v[164:167], 0
    s_waitcnt lgkmcnt(4)
    v_mfma_f32_16x16x32_bf16 v[52:55], v[184:187], v[164:167], 0
    v_mfma_f32_16x16x32_bf16 v[20:23], v[184:187], v[160:163], 0
    buffer_store_dwordx4 v[220:223], v244, s[52:55], s50 offen offset:0 sc0 sc1
    s_waitcnt lgkmcnt(2)
    v_mfma_f32_16x16x32_bf16 v[24:27], v[196:199], v[160:163], 0
    ds_read_b128 v[176:179], v224 offset:16384
    v_mfma_f32_16x16x32_bf16 v[56:59], v[196:199], v[164:167], 0
    ds_read_b128 v[180:183], v225 offset:16384
    s_waitcnt lgkmcnt(2)
    v_mfma_f32_16x16x32_bf16 v[60:63], v[192:195], v[164:167], 0
    ds_read_b128 v[184:187], v226 offset:16384
    v_mfma_f32_16x16x32_bf16 v[28:31], v[192:195], v[160:163], 0
    ds_read_b128 v[188:191], v227 offset:16384
    s_setprio 0
.p2align 3
    v_fmamk_f32 v168, v144, 0x3e0293ee, v248
    v_fmamk_f32 v169, v145, 0x3e0293ee, v248
    v_permlane16_swap_b32 v64, v66
    v_permlane16_swap_b32 v65, v67
    v_fmamk_f32 v170, v146, 0x3e0293ee, v248
    v_fmamk_f32 v171, v147, 0x3e0293ee, v248
    v_exp_f32 v168, v168
    v_exp_f32 v169, v169
    v_permlane16_swap_b32 v68, v70
    v_permlane16_swap_b32 v69, v71
    v_exp_f32 v170, v170
    v_exp_f32 v171, v171
    v_fmamk_f32 v172, v152, 0x3e0293ee, v249
    v_fmamk_f32 v173, v153, 0x3e0293ee, v249
    v_fmamk_f32 v174, v154, 0x3e0293ee, v249
    v_fmamk_f32 v175, v155, 0x3e0293ee, v249
    v_cndmask_b32_dpp v220, v68, v64, vcc quad_perm:[1,0,3,2] row_mask:0xf bank_mask:0xf
    v_cndmask_b32_dpp v221, v69, v65, vcc quad_perm:[1,0,3,2] row_mask:0xf bank_mask:0xf
    v_cvt_pk_bf16_f32 v160, v168, v169
    v_cvt_pk_bf16_f32 v161, v170, v171
    v_exp_f32 v172, v172
    v_exp_f32 v173, v173
    v_cndmask_b32_dpp v222, v70, v66, vcc quad_perm:[1,0,3,2] row_mask:0xf bank_mask:0xf
    v_cndmask_b32_dpp v223, v71, v67, vcc quad_perm:[1,0,3,2] row_mask:0xf bank_mask:0xf
    s_not_b64 vcc, vcc
    s_nop 0
    v_exp_f32 v174, v174
    v_exp_f32 v175, v175
    v_fmamk_f32 v168, v148, 0x3e0293ee, v248
    v_fmamk_f32 v169, v149, 0x3e0293ee, v248
    v_fmamk_f32 v170, v150, 0x3e0293ee, v248
    v_fmamk_f32 v171, v151, 0x3e0293ee, v248
    s_setprio 1
    s_nop 0
    v_cndmask_b32_dpp v68, v64, v68, vcc quad_perm:[1,0,3,2] row_mask:0xf bank_mask:0xf
    v_cndmask_b32_dpp v69, v65, v69, vcc quad_perm:[1,0,3,2] row_mask:0xf bank_mask:0xf
    v_cvt_pk_bf16_f32 v164, v172, v173
    v_cvt_pk_bf16_f32 v165, v174, v175
    v_exp_f32 v168, v168
    v_exp_f32 v169, v169
    v_cndmask_b32_dpp v70, v66, v70, vcc quad_perm:[1,0,3,2] row_mask:0xf bank_mask:0xf
    v_cndmask_b32_dpp v71, v67, v71, vcc quad_perm:[1,0,3,2] row_mask:0xf bank_mask:0xf
    s_not_b64 vcc, vcc
    s_nop 0
    v_exp_f32 v170, v170
    v_exp_f32 v171, v171
    v_fmamk_f32 v172, v156, 0x3e0293ee, v249
    v_fmamk_f32 v173, v157, 0x3e0293ee, v249
    v_fmamk_f32 v174, v158, 0x3e0293ee, v249
    v_fmamk_f32 v175, v159, 0x3e0293ee, v249
    v_cvt_pk_bf16_f32 v162, v168, v169
    v_cvt_pk_bf16_f32 v163, v170, v171
    v_exp_f32 v172, v172
    v_exp_f32 v173, v173
    v_exp_f32 v174, v174
    v_exp_f32 v175, v175
    v_cvt_pk_bf16_f32 v166, v172, v173
    v_cvt_pk_bf16_f32 v167, v174, v175
    v_mfma_f32_16x16x32_bf16 v[208:211], v[216:219], v[160:163], v[200:203]
    s_nop 0
    v_mfma_f32_16x16x32_bf16 v[212:215], v[216:219], v[164:167], v[204:207]
    s_waitcnt lgkmcnt(3)
    v_mfma_f32_16x16x32_bf16 v[128:131], v[176:179], v[96:99], 0
    s_setprio 3
    ds_read_b128 v[192:195], v224 offset:20480
    v_mfma_f32_16x16x32_bf16 v[136:139], v[176:179], v[112:115], 0
    s_waitcnt lgkmcnt(3)
    v_mfma_f32_16x16x32_bf16 v[136:139], v[180:183], v[116:119], v[136:139]
    ds_read_b128 v[196:199], v225 offset:20480
    v_mfma_f32_16x16x32_bf16 v[128:131], v[180:183], v[100:103], v[128:131]
    s_waitcnt lgkmcnt(3)
    v_mfma_f32_16x16x32_bf16 v[128:131], v[184:187], v[104:107], v[128:131]
    ds_read_b128 v[176:179], v226 offset:20480
    v_mfma_f32_16x16x32_bf16 v[136:139], v[184:187], v[120:123], v[136:139]
    v_max_f32_e64 v250, v208, v212
    v_cmp_nle_f32_e64 s[42:43], v250, s40
    s_waitcnt lgkmcnt(3)
    v_mfma_f32_16x16x32_bf16 v[136:139], v[188:191], v[124:127], v[136:139]
    ds_read_b128 v[180:183], v227 offset:20480
    v_mfma_f32_16x16x32_bf16 v[128:131], v[188:191], v[108:111], v[128:131]
    s_cmp_lg_u64 s[42:43], 0
    s_cbranch_scc1 L_stublead21
L_retlead21:
    s_waitcnt lgkmcnt(3)
    v_mfma_f32_16x16x32_bf16 v[132:135], v[192:195], v[96:99], 0
    ds_read_b64_tr_b16 v[184:185], v228 offset:8192
    v_mfma_f32_16x16x32_bf16 v[140:143], v[192:195], v[112:115], 0
    ds_read_b64_tr_b16 v[186:187], v228 offset:12288
    s_waitcnt lgkmcnt(4)
    v_mfma_f32_16x16x32_bf16 v[140:143], v[196:199], v[116:119], v[140:143]
    ds_read_b64_tr_b16 v[188:189], v229 offset:8192
    v_mfma_f32_16x16x32_bf16 v[132:135], v[196:199], v[100:103], v[132:135]
    ds_read_b64_tr_b16 v[190:191], v229 offset:12288
    s_waitcnt lgkmcnt(5)
    v_mfma_f32_16x16x32_bf16 v[132:135], v[176:179], v[104:107], v[132:135]
    ds_read_b64_tr_b16 v[192:193], v230 offset:8192
    v_mfma_f32_16x16x32_bf16 v[140:143], v[176:179], v[120:123], v[140:143]
    ds_read_b64_tr_b16 v[194:195], v230 offset:12288
    s_waitcnt lgkmcnt(6)
    v_mfma_f32_16x16x32_bf16 v[140:143], v[180:183], v[124:127], v[140:143]
    ds_read_b64_tr_b16 v[176:177], v231 offset:8192
    v_mfma_f32_16x16x32_bf16 v[132:135], v[180:183], v[108:111], v[132:135]
    ds_read_b64_tr_b16 v[178:179], v231 offset:12288
    s_waitcnt lgkmcnt(6)
    v_mfma_f32_16x16x32_bf16 v[0:3], v[184:187], v[160:163], v[0:3]
    ds_read_b64_tr_b16 v[180:181], v232 offset:8192
    v_mfma_f32_16x16x32_bf16 v[32:35], v[184:187], v[164:167], v[32:35]
    ds_read_b64_tr_b16 v[182:183], v232 offset:12288
    s_waitcnt lgkmcnt(6)
    v_mfma_f32_16x16x32_bf16 v[36:39], v[188:191], v[164:167], v[36:39]
    ds_read_b64_tr_b16 v[184:185], v233 offset:8192
    v_mfma_f32_16x16x32_bf16 v[4:7], v[188:191], v[160:163], v[4:7]
    ds_read_b64_tr_b16 v[186:187], v233 offset:12288
    s_waitcnt lgkmcnt(6)
    v_mfma_f32_16x16x32_bf16 v[8:11], v[192:195], v[160:163], v[8:11]
    ds_read_b64_tr_b16 v[196:197], v234 offset:8192
    v_mfma_f32_16x16x32_bf16 v[40:43], v[192:195], v[164:167], v[40:43]
    ds_read_b64_tr_b16 v[198:199], v234 offset:12288
    s_waitcnt lgkmcnt(6)
    v_mfma_f32_16x16x32_bf16 v[44:47], v[176:179], v[164:167], v[44:47]
    ds_read_b64_tr_b16 v[192:193], v235 offset:8192
    v_mfma_f32_16x16x32_bf16 v[12:15], v[176:179], v[160:163], v[12:15]
    ds_read_b64_tr_b16 v[194:195], v235 offset:12288
    s_waitcnt lgkmcnt(6)
    v_mfma_f32_16x16x32_bf16 v[16:19], v[180:183], v[160:163], v[16:19]
    v_mfma_f32_16x16x32_bf16 v[48:51], v[180:183], v[164:167], v[48:51]
    s_waitcnt lgkmcnt(4)
    v_mfma_f32_16x16x32_bf16 v[52:55], v[184:187], v[164:167], v[52:55]
    v_mfma_f32_16x16x32_bf16 v[20:23], v[184:187], v[160:163], v[20:23]
    buffer_store_dwordx4 v[68:71], v244, s[24:27], s34 offen offset:256 sc0 sc1
    s_waitcnt lgkmcnt(2)
    v_mfma_f32_16x16x32_bf16 v[24:27], v[196:199], v[160:163], v[24:27]
    ds_read_b128 v[176:179], v224 offset:24576
    v_mfma_f32_16x16x32_bf16 v[56:59], v[196:199], v[164:167], v[56:59]
    ds_read_b128 v[180:183], v225 offset:24576
    s_waitcnt lgkmcnt(2)
    v_mfma_f32_16x16x32_bf16 v[60:63], v[192:195], v[164:167], v[60:63]
    ds_read_b128 v[184:187], v226 offset:24576
    v_mfma_f32_16x16x32_bf16 v[28:31], v[192:195], v[160:163], v[28:31]
    ds_read_b128 v[188:191], v227 offset:24576
    s_setprio 0
.p2align 3
    v_fmamk_f32 v168, v128, 0x3e0293ee, v248
    v_fmamk_f32 v169, v129, 0x3e0293ee, v248
    v_permlane16_swap_b32 v72, v74
    v_permlane16_swap_b32 v73, v75
    v_fmamk_f32 v170, v130, 0x3e0293ee, v248
    v_fmamk_f32 v171, v131, 0x3e0293ee, v248
    v_exp_f32 v168, v168
    v_exp_f32 v169, v169
    v_permlane16_swap_b32 v76, v78
    v_permlane16_swap_b32 v77, v79
    v_exp_f32 v170, v170
    v_exp_f32 v171, v171
    v_fmamk_f32 v172, v136, 0x3e0293ee, v249
    v_fmamk_f32 v173, v137, 0x3e0293ee, v249
    v_fmamk_f32 v174, v138, 0x3e0293ee, v249
    v_fmamk_f32 v175, v139, 0x3e0293ee, v249
    v_cndmask_b32_dpp v64, v76, v72, vcc quad_perm:[1,0,3,2] row_mask:0xf bank_mask:0xf
    v_cndmask_b32_dpp v65, v77, v73, vcc quad_perm:[1,0,3,2] row_mask:0xf bank_mask:0xf
    v_cvt_pk_bf16_f32 v160, v168, v169
    v_cvt_pk_bf16_f32 v161, v170, v171
    v_exp_f32 v172, v172
    v_exp_f32 v173, v173
    v_cndmask_b32_dpp v66, v78, v74, vcc quad_perm:[1,0,3,2] row_mask:0xf bank_mask:0xf
    v_cndmask_b32_dpp v67, v79, v75, vcc quad_perm:[1,0,3,2] row_mask:0xf bank_mask:0xf
    s_not_b64 vcc, vcc
    s_nop 0
    v_exp_f32 v174, v174
    v_exp_f32 v175, v175
    v_fmamk_f32 v168, v132, 0x3e0293ee, v248
    v_fmamk_f32 v169, v133, 0x3e0293ee, v248
    v_fmamk_f32 v170, v134, 0x3e0293ee, v248
    v_fmamk_f32 v171, v135, 0x3e0293ee, v248
    s_setprio 1
    s_nop 0
    v_cndmask_b32_dpp v76, v72, v76, vcc quad_perm:[1,0,3,2] row_mask:0xf bank_mask:0xf
    v_cndmask_b32_dpp v77, v73, v77, vcc quad_perm:[1,0,3,2] row_mask:0xf bank_mask:0xf
    v_cvt_pk_bf16_f32 v164, v172, v173
    v_cvt_pk_bf16_f32 v165, v174, v175
    v_exp_f32 v168, v168
    v_exp_f32 v169, v169
    v_cndmask_b32_dpp v78, v74, v78, vcc quad_perm:[1,0,3,2] row_mask:0xf bank_mask:0xf
    v_cndmask_b32_dpp v79, v75, v79, vcc quad_perm:[1,0,3,2] row_mask:0xf bank_mask:0xf
    s_not_b64 vcc, vcc
    s_nop 0
    v_exp_f32 v170, v170
    v_exp_f32 v171, v171
    v_fmamk_f32 v172, v140, 0x3e0293ee, v249
    v_fmamk_f32 v173, v141, 0x3e0293ee, v249
    v_fmamk_f32 v174, v142, 0x3e0293ee, v249
    v_fmamk_f32 v175, v143, 0x3e0293ee, v249
    v_cvt_pk_bf16_f32 v162, v168, v169
    v_cvt_pk_bf16_f32 v163, v170, v171
    v_exp_f32 v172, v172
    v_exp_f32 v173, v173
    v_exp_f32 v174, v174
    v_exp_f32 v175, v175
    v_cvt_pk_bf16_f32 v166, v172, v173
    v_cvt_pk_bf16_f32 v167, v174, v175
    v_mfma_f32_16x16x32_bf16 v[200:203], v[216:219], v[160:163], v[208:211]
    s_nop 0
    v_mfma_f32_16x16x32_bf16 v[204:207], v[216:219], v[164:167], v[212:215]
    s_waitcnt lgkmcnt(3)
    v_mfma_f32_16x16x32_bf16 v[144:147], v[176:179], v[96:99], 0
    s_setprio 3
    ds_read_b128 v[192:195], v224 offset:28672
    v_mfma_f32_16x16x32_bf16 v[152:155], v[176:179], v[112:115], 0
    s_waitcnt lgkmcnt(3)
    v_mfma_f32_16x16x32_bf16 v[152:155], v[180:183], v[116:119], v[152:155]
    ds_read_b128 v[196:199], v225 offset:28672
    v_mfma_f32_16x16x32_bf16 v[144:147], v[180:183], v[100:103], v[144:147]
    s_waitcnt lgkmcnt(3)
    v_mfma_f32_16x16x32_bf16 v[144:147], v[184:187], v[104:107], v[144:147]
    ds_read_b128 v[176:179], v226 offset:28672
    v_mfma_f32_16x16x32_bf16 v[152:155], v[184:187], v[120:123], v[152:155]
    v_max_f32_e64 v250, v200, v204
    v_cmp_nle_f32_e64 s[42:43], v250, s40
    s_waitcnt lgkmcnt(3)
    v_mfma_f32_16x16x32_bf16 v[152:155], v[188:191], v[124:127], v[152:155]
    ds_read_b128 v[180:183], v227 offset:28672
    v_mfma_f32_16x16x32_bf16 v[144:147], v[188:191], v[108:111], v[144:147]
    s_cmp_lg_u64 s[42:43], 0
    s_cbranch_scc1 L_stublead22
L_retlead22:
    s_waitcnt lgkmcnt(3)
    v_mfma_f32_16x16x32_bf16 v[148:151], v[192:195], v[96:99], 0
    ds_read_b64_tr_b16 v[184:185], v228 offset:16384
    v_mfma_f32_16x16x32_bf16 v[156:159], v[192:195], v[112:115], 0
    ds_read_b64_tr_b16 v[186:187], v228 offset:20480
    s_waitcnt lgkmcnt(4)
    v_mfma_f32_16x16x32_bf16 v[156:159], v[196:199], v[116:119], v[156:159]
    ds_read_b64_tr_b16 v[188:189], v229 offset:16384
    v_mfma_f32_16x16x32_bf16 v[148:151], v[196:199], v[100:103], v[148:151]
    ds_read_b64_tr_b16 v[190:191], v229 offset:20480
    s_waitcnt lgkmcnt(5)
    v_mfma_f32_16x16x32_bf16 v[148:151], v[176:179], v[104:107], v[148:151]
    ds_read_b64_tr_b16 v[192:193], v230 offset:16384
    v_mfma_f32_16x16x32_bf16 v[156:159], v[176:179], v[120:123], v[156:159]
    ds_read_b64_tr_b16 v[194:195], v230 offset:20480
    s_waitcnt lgkmcnt(6)
    v_mfma_f32_16x16x32_bf16 v[156:159], v[180:183], v[124:127], v[156:159]
    ds_read_b64_tr_b16 v[176:177], v231 offset:16384
    v_mfma_f32_16x16x32_bf16 v[148:151], v[180:183], v[108:111], v[148:151]
    ds_read_b64_tr_b16 v[178:179], v231 offset:20480
    s_waitcnt lgkmcnt(6)
    v_mfma_f32_16x16x32_bf16 v[0:3], v[184:187], v[160:163], v[0:3]
    ds_read_b64_tr_b16 v[180:181], v232 offset:16384
    v_mfma_f32_16x16x32_bf16 v[32:35], v[184:187], v[164:167], v[32:35]
    ds_read_b64_tr_b16 v[182:183], v232 offset:20480
    s_waitcnt lgkmcnt(6)
    v_mfma_f32_16x16x32_bf16 v[36:39], v[188:191], v[164:167], v[36:39]
    ds_read_b64_tr_b16 v[184:185], v233 offset:16384
    v_mfma_f32_16x16x32_bf16 v[4:7], v[188:191], v[160:163], v[4:7]
    ds_read_b64_tr_b16 v[186:187], v233 offset:20480
    s_waitcnt lgkmcnt(6)
    v_mfma_f32_16x16x32_bf16 v[8:11], v[192:195], v[160:163], v[8:11]
    ds_read_b64_tr_b16 v[196:197], v234 offset:16384
    v_mfma_f32_16x16x32_bf16 v[40:43], v[192:195], v[164:167], v[40:43]
    ds_read_b64_tr_b16 v[198:199], v234 offset:20480
    s_waitcnt lgkmcnt(6)
    v_mfma_f32_16x16x32_bf16 v[44:47], v[176:179], v[164:167], v[44:47]
    ds_read_b64_tr_b16 v[192:193], v235 offset:16384
    v_mfma_f32_16x16x32_bf16 v[12:15], v[176:179], v[160:163], v[12:15]
    ds_read_b64_tr_b16 v[194:195], v235 offset:20480
    s_waitcnt lgkmcnt(6)
    v_mfma_f32_16x16x32_bf16 v[16:19], v[180:183], v[160:163], v[16:19]
    v_mfma_f32_16x16x32_bf16 v[48:51], v[180:183], v[164:167], v[48:51]
    s_waitcnt lgkmcnt(4)
    v_mfma_f32_16x16x32_bf16 v[52:55], v[184:187], v[164:167], v[52:55]
    v_mfma_f32_16x16x32_bf16 v[20:23], v[184:187], v[160:163], v[20:23]
    buffer_store_dwordx4 v[64:67], v244, s[24:27], s34 offen offset:128 sc0 sc1
    buffer_store_dwordx4 v[76:79], v244, s[24:27], s34 offen offset:384 sc0 sc1
    s_waitcnt lgkmcnt(2)
    v_mfma_f32_16x16x32_bf16 v[24:27], v[196:199], v[160:163], v[24:27]
    ds_read_b128 v[176:179], v224 offset:32768
    v_mfma_f32_16x16x32_bf16 v[56:59], v[196:199], v[164:167], v[56:59]
    ds_read_b128 v[180:183], v225 offset:32768
    s_waitcnt lgkmcnt(2)
    v_mfma_f32_16x16x32_bf16 v[60:63], v[192:195], v[164:167], v[60:63]
    ds_read_b128 v[184:187], v226 offset:32768
    v_mfma_f32_16x16x32_bf16 v[28:31], v[192:195], v[160:163], v[28:31]
    ds_read_b128 v[188:191], v227 offset:32768
    s_setprio 0
.p2align 3
    v_fmamk_f32 v168, v144, 0x3e0293ee, v248
    v_fmamk_f32 v169, v145, 0x3e0293ee, v248
    v_fmamk_f32 v170, v146, 0x3e0293ee, v248
    v_fmamk_f32 v171, v147, 0x3e0293ee, v248
    v_exp_f32 v168, v168
    v_exp_f32 v169, v169
    v_exp_f32 v170, v170
    v_exp_f32 v171, v171
    v_fmamk_f32 v172, v152, 0x3e0293ee, v249
    v_fmamk_f32 v173, v153, 0x3e0293ee, v249
    v_fmamk_f32 v174, v154, 0x3e0293ee, v249
    v_fmamk_f32 v175, v155, 0x3e0293ee, v249
    v_cvt_pk_bf16_f32 v160, v168, v169
    v_cvt_pk_bf16_f32 v161, v170, v171
    v_exp_f32 v172, v172
    v_exp_f32 v173, v173
    v_exp_f32 v174, v174
    v_exp_f32 v175, v175
    v_fmamk_f32 v168, v148, 0x3e0293ee, v248
    v_fmamk_f32 v169, v149, 0x3e0293ee, v248
    v_fmamk_f32 v170, v150, 0x3e0293ee, v248
    v_fmamk_f32 v171, v151, 0x3e0293ee, v248
    s_setprio 1
    s_nop 0
    v_cvt_pk_bf16_f32 v164, v172, v173
    v_cvt_pk_bf16_f32 v165, v174, v175
    v_exp_f32 v168, v168
    v_exp_f32 v169, v169
    v_exp_f32 v170, v170
    v_exp_f32 v171, v171
    v_fmamk_f32 v172, v156, 0x3e0293ee, v249
    v_fmamk_f32 v173, v157, 0x3e0293ee, v249
    v_fmamk_f32 v174, v158, 0x3e0293ee, v249
    v_fmamk_f32 v175, v159, 0x3e0293ee, v249
    v_cvt_pk_bf16_f32 v162, v168, v169
    v_cvt_pk_bf16_f32 v163, v170, v171
    v_exp_f32 v172, v172
    v_exp_f32 v173, v173
    v_exp_f32 v174, v174
    v_exp_f32 v175, v175
    v_cvt_pk_bf16_f32 v166, v172, v173
    v_cvt_pk_bf16_f32 v167, v174, v175
    v_mfma_f32_16x16x32_bf16 v[208:211], v[216:219], v[160:163], v[200:203]
    s_nop 0
    v_mfma_f32_16x16x32_bf16 v[212:215], v[216:219], v[164:167], v[204:207]
    s_waitcnt lgkmcnt(3)
    v_mfma_f32_16x16x32_bf16 v[128:131], v[176:179], v[96:99], 0
    s_setprio 3
    ds_read_b128 v[192:195], v224 offset:36864
    v_mfma_f32_16x16x32_bf16 v[136:139], v[176:179], v[112:115], 0
    s_waitcnt lgkmcnt(3)
    v_mfma_f32_16x16x32_bf16 v[136:139], v[180:183], v[116:119], v[136:139]
    ds_read_b128 v[196:199], v225 offset:36864
    v_mfma_f32_16x16x32_bf16 v[128:131], v[180:183], v[100:103], v[128:131]
    s_waitcnt lgkmcnt(3)
    v_mfma_f32_16x16x32_bf16 v[128:131], v[184:187], v[104:107], v[128:131]
    ds_read_b128 v[176:179], v226 offset:36864
    v_mfma_f32_16x16x32_bf16 v[136:139], v[184:187], v[120:123], v[136:139]
    v_max_f32_e64 v250, v208, v212
    v_cmp_nle_f32_e64 s[42:43], v250, s40
    s_waitcnt lgkmcnt(3)
    v_mfma_f32_16x16x32_bf16 v[136:139], v[188:191], v[124:127], v[136:139]
    ds_read_b128 v[180:183], v227 offset:36864
    v_mfma_f32_16x16x32_bf16 v[128:131], v[188:191], v[108:111], v[128:131]
    s_cmp_lg_u64 s[42:43], 0
    s_cbranch_scc1 L_stublead23
L_retlead23:
    s_waitcnt lgkmcnt(3)
    v_mfma_f32_16x16x32_bf16 v[132:135], v[192:195], v[96:99], 0
    ds_read_b64_tr_b16 v[184:185], v228 offset:24576
    v_mfma_f32_16x16x32_bf16 v[140:143], v[192:195], v[112:115], 0
    ds_read_b64_tr_b16 v[186:187], v228 offset:28672
    s_waitcnt lgkmcnt(4)
    v_mfma_f32_16x16x32_bf16 v[140:143], v[196:199], v[116:119], v[140:143]
    ds_read_b64_tr_b16 v[188:189], v229 offset:24576
    v_mfma_f32_16x16x32_bf16 v[132:135], v[196:199], v[100:103], v[132:135]
    ds_read_b64_tr_b16 v[190:191], v229 offset:28672
    s_waitcnt lgkmcnt(5)
    v_mfma_f32_16x16x32_bf16 v[132:135], v[176:179], v[104:107], v[132:135]
    ds_read_b64_tr_b16 v[192:193], v230 offset:24576
    v_mfma_f32_16x16x32_bf16 v[140:143], v[176:179], v[120:123], v[140:143]
    ds_read_b64_tr_b16 v[194:195], v230 offset:28672
    s_waitcnt lgkmcnt(6)
    v_mfma_f32_16x16x32_bf16 v[140:143], v[180:183], v[124:127], v[140:143]
    ds_read_b64_tr_b16 v[176:177], v231 offset:24576
    v_mfma_f32_16x16x32_bf16 v[132:135], v[180:183], v[108:111], v[132:135]
    ds_read_b64_tr_b16 v[178:179], v231 offset:28672
    s_waitcnt lgkmcnt(6)
    v_mfma_f32_16x16x32_bf16 v[0:3], v[184:187], v[160:163], v[0:3]
    ds_read_b64_tr_b16 v[180:181], v232 offset:24576
    v_mfma_f32_16x16x32_bf16 v[32:35], v[184:187], v[164:167], v[32:35]
    ds_read_b64_tr_b16 v[182:183], v232 offset:28672
    s_waitcnt lgkmcnt(6)
    v_mfma_f32_16x16x32_bf16 v[36:39], v[188:191], v[164:167], v[36:39]
    ds_read_b64_tr_b16 v[184:185], v233 offset:24576
    v_mfma_f32_16x16x32_bf16 v[4:7], v[188:191], v[160:163], v[4:7]
    ds_read_b64_tr_b16 v[186:187], v233 offset:28672
    s_waitcnt lgkmcnt(6)
    v_mfma_f32_16x16x32_bf16 v[8:11], v[192:195], v[160:163], v[8:11]
    ds_read_b64_tr_b16 v[196:197], v234 offset:24576
    v_mfma_f32_16x16x32_bf16 v[40:43], v[192:195], v[164:167], v[40:43]
    ds_read_b64_tr_b16 v[198:199], v234 offset:28672
    s_waitcnt lgkmcnt(6)
    v_mfma_f32_16x16x32_bf16 v[44:47], v[176:179], v[164:167], v[44:47]
    ds_read_b64_tr_b16 v[192:193], v235 offset:24576
    v_mfma_f32_16x16x32_bf16 v[12:15], v[176:179], v[160:163], v[12:15]
    ds_read_b64_tr_b16 v[194:195], v235 offset:28672
    s_waitcnt lgkmcnt(6)
    v_mfma_f32_16x16x32_bf16 v[16:19], v[180:183], v[160:163], v[16:19]
    v_mfma_f32_16x16x32_bf16 v[48:51], v[180:183], v[164:167], v[48:51]
    s_waitcnt lgkmcnt(4)
    v_mfma_f32_16x16x32_bf16 v[52:55], v[184:187], v[164:167], v[52:55]
    v_mfma_f32_16x16x32_bf16 v[20:23], v[184:187], v[160:163], v[20:23]
    buffer_store_dwordx4 v[220:223], v244, s[24:27], s34 offen offset:0 sc0 sc1
    s_waitcnt lgkmcnt(2)
    v_mfma_f32_16x16x32_bf16 v[24:27], v[196:199], v[160:163], v[24:27]
    ds_read_b128 v[176:179], v224 offset:40960
    v_mfma_f32_16x16x32_bf16 v[56:59], v[196:199], v[164:167], v[56:59]
    ds_read_b128 v[180:183], v225 offset:40960
    s_waitcnt lgkmcnt(2)
    v_mfma_f32_16x16x32_bf16 v[60:63], v[192:195], v[164:167], v[60:63]
    ds_read_b128 v[184:187], v226 offset:40960
    v_mfma_f32_16x16x32_bf16 v[28:31], v[192:195], v[160:163], v[28:31]
    ds_read_b128 v[188:191], v227 offset:40960
    s_setprio 0
.p2align 3
    v_fmamk_f32 v168, v128, 0x3e0293ee, v248
    v_fmamk_f32 v169, v129, 0x3e0293ee, v248
    v_permlane16_swap_b32 v80, v82
    v_permlane16_swap_b32 v81, v83
    v_fmamk_f32 v170, v130, 0x3e0293ee, v248
    v_fmamk_f32 v171, v131, 0x3e0293ee, v248
    v_exp_f32 v168, v168
    v_exp_f32 v169, v169
    v_permlane16_swap_b32 v84, v86
    v_permlane16_swap_b32 v85, v87
    v_exp_f32 v170, v170
    v_exp_f32 v171, v171
    v_fmamk_f32 v172, v136, 0x3e0293ee, v249
    v_fmamk_f32 v173, v137, 0x3e0293ee, v249
    v_fmamk_f32 v174, v138, 0x3e0293ee, v249
    v_fmamk_f32 v175, v139, 0x3e0293ee, v249
    v_cndmask_b32_dpp v220, v84, v80, vcc quad_perm:[1,0,3,2] row_mask:0xf bank_mask:0xf
    v_cndmask_b32_dpp v221, v85, v81, vcc quad_perm:[1,0,3,2] row_mask:0xf bank_mask:0xf
    v_cvt_pk_bf16_f32 v160, v168, v169
    v_cvt_pk_bf16_f32 v161, v170, v171
    v_exp_f32 v172, v172
    v_exp_f32 v173, v173
    v_cndmask_b32_dpp v222, v86, v82, vcc quad_perm:[1,0,3,2] row_mask:0xf bank_mask:0xf
    v_cndmask_b32_dpp v223, v87, v83, vcc quad_perm:[1,0,3,2] row_mask:0xf bank_mask:0xf
    s_not_b64 vcc, vcc
    s_nop 0
    v_exp_f32 v174, v174
    v_exp_f32 v175, v175
    v_fmamk_f32 v168, v132, 0x3e0293ee, v248
    v_fmamk_f32 v169, v133, 0x3e0293ee, v248
    v_fmamk_f32 v170, v134, 0x3e0293ee, v248
    v_fmamk_f32 v171, v135, 0x3e0293ee, v248
    s_setprio 1
    s_nop 0
    v_cndmask_b32_dpp v84, v80, v84, vcc quad_perm:[1,0,3,2] row_mask:0xf bank_mask:0xf
    v_cndmask_b32_dpp v85, v81, v85, vcc quad_perm:[1,0,3,2] row_mask:0xf bank_mask:0xf
    v_cvt_pk_bf16_f32 v164, v172, v173
    v_cvt_pk_bf16_f32 v165, v174, v175
    v_exp_f32 v168, v168
    v_exp_f32 v169, v169
    v_cndmask_b32_dpp v86, v82, v86, vcc quad_perm:[1,0,3,2] row_mask:0xf bank_mask:0xf
    v_cndmask_b32_dpp v87, v83, v87, vcc quad_perm:[1,0,3,2] row_mask:0xf bank_mask:0xf
    s_not_b64 vcc, vcc
    s_nop 0
    v_exp_f32 v170, v170
    v_exp_f32 v171, v171
    v_fmamk_f32 v172, v140, 0x3e0293ee, v249
    v_fmamk_f32 v173, v141, 0x3e0293ee, v249
    v_fmamk_f32 v174, v142, 0x3e0293ee, v249
    v_fmamk_f32 v175, v143, 0x3e0293ee, v249
    v_cvt_pk_bf16_f32 v162, v168, v169
    v_cvt_pk_bf16_f32 v163, v170, v171
    v_exp_f32 v172, v172
    v_exp_f32 v173, v173
    v_exp_f32 v174, v174
    v_exp_f32 v175, v175
    v_cvt_pk_bf16_f32 v166, v172, v173
    v_cvt_pk_bf16_f32 v167, v174, v175
    v_mfma_f32_16x16x32_bf16 v[200:203], v[216:219], v[160:163], v[208:211]
    s_nop 0
    v_mfma_f32_16x16x32_bf16 v[204:207], v[216:219], v[164:167], v[212:215]
    s_waitcnt lgkmcnt(3)
    v_mfma_f32_16x16x32_bf16 v[144:147], v[176:179], v[96:99], 0
    s_setprio 3
    ds_read_b128 v[192:195], v224 offset:45056
    v_mfma_f32_16x16x32_bf16 v[152:155], v[176:179], v[112:115], 0
    s_waitcnt lgkmcnt(3)
    v_mfma_f32_16x16x32_bf16 v[152:155], v[180:183], v[116:119], v[152:155]
    ds_read_b128 v[196:199], v225 offset:45056
    v_mfma_f32_16x16x32_bf16 v[144:147], v[180:183], v[100:103], v[144:147]
    s_waitcnt lgkmcnt(3)
    v_mfma_f32_16x16x32_bf16 v[144:147], v[184:187], v[104:107], v[144:147]
    ds_read_b128 v[176:179], v226 offset:45056
    v_mfma_f32_16x16x32_bf16 v[152:155], v[184:187], v[120:123], v[152:155]
    v_max_f32_e64 v250, v200, v204
    v_cmp_nle_f32_e64 s[42:43], v250, s40
    s_waitcnt lgkmcnt(3)
    v_mfma_f32_16x16x32_bf16 v[152:155], v[188:191], v[124:127], v[152:155]
    ds_read_b128 v[180:183], v227 offset:45056
    v_mfma_f32_16x16x32_bf16 v[144:147], v[188:191], v[108:111], v[144:147]
    s_cmp_lg_u64 s[42:43], 0
    s_cbranch_scc1 L_stublead24
L_retlead24:
    s_waitcnt lgkmcnt(3)
    v_mfma_f32_16x16x32_bf16 v[148:151], v[192:195], v[96:99], 0
    ds_read_b64_tr_b16 v[184:185], v228 offset:32768
    v_mfma_f32_16x16x32_bf16 v[156:159], v[192:195], v[112:115], 0
    ds_read_b64_tr_b16 v[186:187], v228 offset:36864
    s_waitcnt lgkmcnt(4)
    v_mfma_f32_16x16x32_bf16 v[156:159], v[196:199], v[116:119], v[156:159]
    ds_read_b64_tr_b16 v[188:189], v229 offset:32768
    v_mfma_f32_16x16x32_bf16 v[148:151], v[196:199], v[100:103], v[148:151]
    ds_read_b64_tr_b16 v[190:191], v229 offset:36864
    s_waitcnt lgkmcnt(5)
    v_mfma_f32_16x16x32_bf16 v[148:151], v[176:179], v[104:107], v[148:151]
    ds_read_b64_tr_b16 v[192:193], v230 offset:32768
    v_mfma_f32_16x16x32_bf16 v[156:159], v[176:179], v[120:123], v[156:159]
    ds_read_b64_tr_b16 v[194:195], v230 offset:36864
    s_waitcnt lgkmcnt(6)
    v_mfma_f32_16x16x32_bf16 v[156:159], v[180:183], v[124:127], v[156:159]
    ds_read_b64_tr_b16 v[176:177], v231 offset:32768
    v_mfma_f32_16x16x32_bf16 v[148:151], v[180:183], v[108:111], v[148:151]
    ds_read_b64_tr_b16 v[178:179], v231 offset:36864
    s_waitcnt lgkmcnt(6)
    v_mfma_f32_16x16x32_bf16 v[0:3], v[184:187], v[160:163], v[0:3]
    ds_read_b64_tr_b16 v[180:181], v232 offset:32768
    v_mfma_f32_16x16x32_bf16 v[32:35], v[184:187], v[164:167], v[32:35]
    ds_read_b64_tr_b16 v[182:183], v232 offset:36864
    s_waitcnt lgkmcnt(6)
    v_mfma_f32_16x16x32_bf16 v[36:39], v[188:191], v[164:167], v[36:39]
    ds_read_b64_tr_b16 v[184:185], v233 offset:32768
    v_mfma_f32_16x16x32_bf16 v[4:7], v[188:191], v[160:163], v[4:7]
    ds_read_b64_tr_b16 v[186:187], v233 offset:36864
    s_waitcnt lgkmcnt(6)
    v_mfma_f32_16x16x32_bf16 v[8:11], v[192:195], v[160:163], v[8:11]
    ds_read_b64_tr_b16 v[196:197], v234 offset:32768
    v_mfma_f32_16x16x32_bf16 v[40:43], v[192:195], v[164:167], v[40:43]
    ds_read_b64_tr_b16 v[198:199], v234 offset:36864
    s_waitcnt lgkmcnt(6)
    v_mfma_f32_16x16x32_bf16 v[44:47], v[176:179], v[164:167], v[44:47]
    ds_read_b64_tr_b16 v[192:193], v235 offset:32768
    v_mfma_f32_16x16x32_bf16 v[12:15], v[176:179], v[160:163], v[12:15]
    ds_read_b64_tr_b16 v[194:195], v235 offset:36864
    s_waitcnt lgkmcnt(6)
    v_mfma_f32_16x16x32_bf16 v[16:19], v[180:183], v[160:163], v[16:19]
    v_mfma_f32_16x16x32_bf16 v[48:51], v[180:183], v[164:167], v[48:51]
    s_waitcnt lgkmcnt(4)
    v_mfma_f32_16x16x32_bf16 v[52:55], v[184:187], v[164:167], v[52:55]
    v_mfma_f32_16x16x32_bf16 v[20:23], v[184:187], v[160:163], v[20:23]
    buffer_store_dwordx4 v[84:87], v244, s[24:27], s35 offen offset:256 sc0 sc1
    s_waitcnt lgkmcnt(2)
    v_mfma_f32_16x16x32_bf16 v[24:27], v[196:199], v[160:163], v[24:27]
    ds_read_b128 v[176:179], v224 offset:49152
    v_mfma_f32_16x16x32_bf16 v[56:59], v[196:199], v[164:167], v[56:59]
    ds_read_b128 v[180:183], v225 offset:49152
    s_waitcnt lgkmcnt(2)
    v_mfma_f32_16x16x32_bf16 v[60:63], v[192:195], v[164:167], v[60:63]
    ds_read_b128 v[184:187], v226 offset:49152
    v_mfma_f32_16x16x32_bf16 v[28:31], v[192:195], v[160:163], v[28:31]
    ds_read_b128 v[188:191], v227 offset:49152
    s_setprio 2
.p2align 3
    v_fmamk_f32 v168, v144, 0x3e0293ee, v248
    v_fmamk_f32 v169, v145, 0x3e0293ee, v248
    v_permlane16_swap_b32 v88, v90
    v_permlane16_swap_b32 v89, v91
    v_fmamk_f32 v170, v146, 0x3e0293ee, v248
    v_fmamk_f32 v171, v147, 0x3e0293ee, v248
    v_exp_f32 v168, v168
    v_exp_f32 v169, v169
    v_permlane16_swap_b32 v92, v94
    v_permlane16_swap_b32 v93, v95
    v_exp_f32 v170, v170
    v_exp_f32 v171, v171
    v_fmamk_f32 v172, v152, 0x3e0293ee, v249
    v_fmamk_f32 v173, v153, 0x3e0293ee, v249
    v_fmamk_f32 v174, v154, 0x3e0293ee, v249
    v_fmamk_f32 v175, v155, 0x3e0293ee, v249
    v_cndmask_b32_dpp v80, v92, v88, vcc quad_perm:[1,0,3,2] row_mask:0xf bank_mask:0xf
    v_cndmask_b32_dpp v81, v93, v89, vcc quad_perm:[1,0,3,2] row_mask:0xf bank_mask:0xf
    v_cvt_pk_bf16_f32 v160, v168, v169
    v_cvt_pk_bf16_f32 v161, v170, v171
    v_exp_f32 v172, v172
    v_exp_f32 v173, v173
    v_cndmask_b32_dpp v82, v94, v90, vcc quad_perm:[1,0,3,2] row_mask:0xf bank_mask:0xf
    v_cndmask_b32_dpp v83, v95, v91, vcc quad_perm:[1,0,3,2] row_mask:0xf bank_mask:0xf
    s_not_b64 vcc, vcc
    s_nop 0
    v_exp_f32 v174, v174
    v_exp_f32 v175, v175
    v_fmamk_f32 v168, v148, 0x3e0293ee, v248
    v_fmamk_f32 v169, v149, 0x3e0293ee, v248
    v_fmamk_f32 v170, v150, 0x3e0293ee, v248
    v_fmamk_f32 v171, v151, 0x3e0293ee, v248
    v_cndmask_b32_dpp v92, v88, v92, vcc quad_perm:[1,0,3,2] row_mask:0xf bank_mask:0xf
    v_cndmask_b32_dpp v93, v89, v93, vcc quad_perm:[1,0,3,2] row_mask:0xf bank_mask:0xf
    v_cvt_pk_bf16_f32 v164, v172, v173
    v_cvt_pk_bf16_f32 v165, v174, v175
    v_exp_f32 v168, v168
    v_exp_f32 v169, v169
    v_cndmask_b32_dpp v94, v90, v94, vcc quad_perm:[1,0,3,2] row_mask:0xf bank_mask:0xf
    v_cndmask_b32_dpp v95, v91, v95, vcc quad_perm:[1,0,3,2] row_mask:0xf bank_mask:0xf
    s_not_b64 vcc, vcc
    s_nop 0
    v_exp_f32 v170, v170
    v_exp_f32 v171, v171
    v_fmamk_f32 v172, v156, 0x3e0293ee, v249
    v_fmamk_f32 v173, v157, 0x3e0293ee, v249
    v_fmamk_f32 v174, v158, 0x3e0293ee, v249
    v_fmamk_f32 v175, v159, 0x3e0293ee, v249
    v_cvt_pk_bf16_f32 v162, v168, v169
    v_cvt_pk_bf16_f32 v163, v170, v171
    v_exp_f32 v172, v172
    v_exp_f32 v173, v173
    v_exp_f32 v174, v174
    v_exp_f32 v175, v175
    v_cvt_pk_bf16_f32 v166, v172, v173
    v_cvt_pk_bf16_f32 v167, v174, v175
    v_mfma_f32_16x16x32_bf16 v[208:211], v[216:219], v[160:163], v[200:203]
    s_nop 0
    v_mfma_f32_16x16x32_bf16 v[212:215], v[216:219], v[164:167], v[204:207]
    s_waitcnt lgkmcnt(3)
    v_mfma_f32_16x16x32_bf16 v[128:131], v[176:179], v[96:99], 0
    ds_read_b128 v[192:195], v224 offset:53248
    v_mfma_f32_16x16x32_bf16 v[136:139], v[176:179], v[112:115], 0
    s_waitcnt lgkmcnt(3)
    v_mfma_f32_16x16x32_bf16 v[136:139], v[180:183], v[116:119], v[136:139]
    ds_read_b128 v[196:199], v225 offset:53248
    v_mfma_f32_16x16x32_bf16 v[128:131], v[180:183], v[100:103], v[128:131]
    s_waitcnt lgkmcnt(3)
    v_mfma_f32_16x16x32_bf16 v[128:131], v[184:187], v[104:107], v[128:131]
    ds_read_b128 v[176:179], v226 offset:53248
    v_mfma_f32_16x16x32_bf16 v[136:139], v[184:187], v[120:123], v[136:139]
    v_max_f32_e64 v250, v208, v212
    v_cmp_nle_f32_e64 s[42:43], v250, s40
    s_waitcnt lgkmcnt(3)
    v_mfma_f32_16x16x32_bf16 v[136:139], v[188:191], v[124:127], v[136:139]
    ds_read_b128 v[180:183], v227 offset:53248
    v_mfma_f32_16x16x32_bf16 v[128:131], v[188:191], v[108:111], v[128:131]
    s_cmp_lg_u64 s[42:43], 0
    s_cbranch_scc1 L_stublead25
L_retlead25:
    s_waitcnt lgkmcnt(3)
    v_mfma_f32_16x16x32_bf16 v[132:135], v[192:195], v[96:99], 0
    ds_read_b64_tr_b16 v[184:185], v228 offset:40960
    v_mfma_f32_16x16x32_bf16 v[140:143], v[192:195], v[112:115], 0
    ds_read_b64_tr_b16 v[186:187], v228 offset:45056
    s_waitcnt lgkmcnt(4)
    v_mfma_f32_16x16x32_bf16 v[140:143], v[196:199], v[116:119], v[140:143]
    ds_read_b64_tr_b16 v[188:189], v229 offset:40960
    v_mfma_f32_16x16x32_bf16 v[132:135], v[196:199], v[100:103], v[132:135]
    ds_read_b64_tr_b16 v[190:191], v229 offset:45056
    s_waitcnt lgkmcnt(5)
    v_mfma_f32_16x16x32_bf16 v[132:135], v[176:179], v[104:107], v[132:135]
    ds_read_b64_tr_b16 v[192:193], v230 offset:40960
    v_mfma_f32_16x16x32_bf16 v[140:143], v[176:179], v[120:123], v[140:143]
    ds_read_b64_tr_b16 v[194:195], v230 offset:45056
    s_waitcnt lgkmcnt(6)
    v_mfma_f32_16x16x32_bf16 v[140:143], v[180:183], v[124:127], v[140:143]
    ds_read_b64_tr_b16 v[176:177], v231 offset:40960
    v_mfma_f32_16x16x32_bf16 v[132:135], v[180:183], v[108:111], v[132:135]
    ds_read_b64_tr_b16 v[178:179], v231 offset:45056
    s_waitcnt lgkmcnt(6)
    v_mfma_f32_16x16x32_bf16 v[0:3], v[184:187], v[160:163], v[0:3]
    ds_read_b64_tr_b16 v[180:181], v232 offset:40960
    v_mfma_f32_16x16x32_bf16 v[32:35], v[184:187], v[164:167], v[32:35]
    ds_read_b64_tr_b16 v[182:183], v232 offset:45056
    s_waitcnt lgkmcnt(6)
    v_mfma_f32_16x16x32_bf16 v[36:39], v[188:191], v[164:167], v[36:39]
    ds_read_b64_tr_b16 v[184:185], v233 offset:40960
    v_mfma_f32_16x16x32_bf16 v[4:7], v[188:191], v[160:163], v[4:7]
    ds_read_b64_tr_b16 v[186:187], v233 offset:45056
    s_waitcnt lgkmcnt(6)
    v_mfma_f32_16x16x32_bf16 v[8:11], v[192:195], v[160:163], v[8:11]
    ds_read_b64_tr_b16 v[196:197], v234 offset:40960
    v_mfma_f32_16x16x32_bf16 v[40:43], v[192:195], v[164:167], v[40:43]
    ds_read_b64_tr_b16 v[198:199], v234 offset:45056
    s_waitcnt lgkmcnt(6)
    v_mfma_f32_16x16x32_bf16 v[44:47], v[176:179], v[164:167], v[44:47]
    ds_read_b64_tr_b16 v[192:193], v235 offset:40960
    v_mfma_f32_16x16x32_bf16 v[12:15], v[176:179], v[160:163], v[12:15]
    ds_read_b64_tr_b16 v[194:195], v235 offset:45056
    s_waitcnt lgkmcnt(6)
    v_mfma_f32_16x16x32_bf16 v[16:19], v[180:183], v[160:163], v[16:19]
    v_mfma_f32_16x16x32_bf16 v[48:51], v[180:183], v[164:167], v[48:51]
    s_waitcnt lgkmcnt(4)
    v_mfma_f32_16x16x32_bf16 v[52:55], v[184:187], v[164:167], v[52:55]
    v_mfma_f32_16x16x32_bf16 v[20:23], v[184:187], v[160:163], v[20:23]
    buffer_store_dwordx4 v[80:83], v244, s[24:27], s35 offen offset:128 sc0 sc1
    buffer_store_dwordx4 v[92:95], v244, s[24:27], s35 offen offset:384 sc0 sc1
    s_waitcnt lgkmcnt(2)
    v_mfma_f32_16x16x32_bf16 v[24:27], v[196:199], v[160:163], v[24:27]
    ds_read_b128 v[176:179], v224 offset:57344
    v_mfma_f32_16x16x32_bf16 v[56:59], v[196:199], v[164:167], v[56:59]
    ds_read_b128 v[180:183], v225 offset:57344
    s_waitcnt lgkmcnt(2)
    v_mfma_f32_16x16x32_bf16 v[60:63], v[192:195], v[164:167], v[60:63]
    ds_read_b128 v[184:187], v226 offset:57344
    v_mfma_f32_16x16x32_bf16 v[28:31], v[192:195], v[160:163], v[28:31]
    ds_read_b128 v[188:191], v227 offset:57344
.p2align 3
    v_fmamk_f32 v168, v128, 0x3e0293ee, v248
    v_fmamk_f32 v169, v129, 0x3e0293ee, v248
    v_fmamk_f32 v170, v130, 0x3e0293ee, v248
    v_fmamk_f32 v171, v131, 0x3e0293ee, v248
    v_exp_f32 v168, v168
    v_exp_f32 v169, v169
    v_exp_f32 v170, v170
    v_exp_f32 v171, v171
    v_fmamk_f32 v172, v136, 0x3e0293ee, v249
    v_fmamk_f32 v173, v137, 0x3e0293ee, v249
    v_fmamk_f32 v174, v138, 0x3e0293ee, v249
    v_fmamk_f32 v175, v139, 0x3e0293ee, v249
    v_cvt_pk_bf16_f32 v160, v168, v169
    v_cvt_pk_bf16_f32 v161, v170, v171
    v_exp_f32 v172, v172
    v_exp_f32 v173, v173
    v_exp_f32 v174, v174
    v_exp_f32 v175, v175
    v_fmamk_f32 v168, v132, 0x3e0293ee, v248
    v_fmamk_f32 v169, v133, 0x3e0293ee, v248
    v_fmamk_f32 v170, v134, 0x3e0293ee, v248
    v_fmamk_f32 v171, v135, 0x3e0293ee, v248
    v_cvt_pk_bf16_f32 v164, v172, v173
    v_cvt_pk_bf16_f32 v165, v174, v175
    v_exp_f32 v168, v168
    v_exp_f32 v169, v169
    v_exp_f32 v170, v170
    v_exp_f32 v171, v171
    v_fmamk_f32 v172, v140, 0x3e0293ee, v249
    v_fmamk_f32 v173, v141, 0x3e0293ee, v249
    v_fmamk_f32 v174, v142, 0x3e0293ee, v249
    v_fmamk_f32 v175, v143, 0x3e0293ee, v249
    v_cvt_pk_bf16_f32 v162, v168, v169
    v_cvt_pk_bf16_f32 v163, v170, v171
    v_exp_f32 v172, v172
    v_exp_f32 v173, v173
    v_exp_f32 v174, v174
    v_exp_f32 v175, v175
    v_cvt_pk_bf16_f32 v166, v172, v173
    v_cvt_pk_bf16_f32 v167, v174, v175
    v_mfma_f32_16x16x32_bf16 v[200:203], v[216:219], v[160:163], v[208:211]
    s_nop 0
    v_mfma_f32_16x16x32_bf16 v[204:207], v[216:219], v[164:167], v[212:215]
    s_waitcnt lgkmcnt(3)
    v_mfma_f32_16x16x32_bf16 v[144:147], v[176:179], v[96:99], 0
    ds_read_b128 v[192:195], v224 offset:61440
    v_mfma_f32_16x16x32_bf16 v[152:155], v[176:179], v[112:115], 0
    s_waitcnt lgkmcnt(3)
    v_mfma_f32_16x16x32_bf16 v[152:155], v[180:183], v[116:119], v[152:155]
    ds_read_b128 v[196:199], v225 offset:61440
    v_mfma_f32_16x16x32_bf16 v[144:147], v[180:183], v[100:103], v[144:147]
    s_waitcnt lgkmcnt(3)
    v_mfma_f32_16x16x32_bf16 v[144:147], v[184:187], v[104:107], v[144:147]
    ds_read_b128 v[176:179], v226 offset:61440
    v_mfma_f32_16x16x32_bf16 v[152:155], v[184:187], v[120:123], v[152:155]
    v_max_f32_e64 v250, v200, v204
    v_cmp_nle_f32_e64 s[42:43], v250, s40
    s_waitcnt lgkmcnt(3)
    v_mfma_f32_16x16x32_bf16 v[152:155], v[188:191], v[124:127], v[152:155]
    ds_read_b128 v[180:183], v227 offset:61440
    v_mfma_f32_16x16x32_bf16 v[144:147], v[188:191], v[108:111], v[144:147]
    s_cmp_lg_u64 s[42:43], 0
    s_cbranch_scc1 L_stublead26
L_retlead26:
    s_waitcnt lgkmcnt(3)
    v_mfma_f32_16x16x32_bf16 v[148:151], v[192:195], v[96:99], 0
    ds_read_b64_tr_b16 v[184:185], v228 offset:49152
    v_mfma_f32_16x16x32_bf16 v[156:159], v[192:195], v[112:115], 0
    ds_read_b64_tr_b16 v[186:187], v228 offset:53248
    s_waitcnt lgkmcnt(4)
    v_mfma_f32_16x16x32_bf16 v[156:159], v[196:199], v[116:119], v[156:159]
    ds_read_b64_tr_b16 v[188:189], v229 offset:49152
    v_mfma_f32_16x16x32_bf16 v[148:151], v[196:199], v[100:103], v[148:151]
    ds_read_b64_tr_b16 v[190:191], v229 offset:53248
    s_waitcnt lgkmcnt(5)
    v_mfma_f32_16x16x32_bf16 v[148:151], v[176:179], v[104:107], v[148:151]
    ds_read_b64_tr_b16 v[192:193], v230 offset:49152
    v_mfma_f32_16x16x32_bf16 v[156:159], v[176:179], v[120:123], v[156:159]
    ds_read_b64_tr_b16 v[194:195], v230 offset:53248
    s_waitcnt lgkmcnt(6)
    v_mfma_f32_16x16x32_bf16 v[156:159], v[180:183], v[124:127], v[156:159]
    ds_read_b64_tr_b16 v[176:177], v231 offset:49152
    v_mfma_f32_16x16x32_bf16 v[148:151], v[180:183], v[108:111], v[148:151]
    ds_read_b64_tr_b16 v[178:179], v231 offset:53248
    s_waitcnt lgkmcnt(6)
    v_mfma_f32_16x16x32_bf16 v[0:3], v[184:187], v[160:163], v[0:3]
    ds_read_b64_tr_b16 v[180:181], v232 offset:49152
    v_mfma_f32_16x16x32_bf16 v[32:35], v[184:187], v[164:167], v[32:35]
    ds_read_b64_tr_b16 v[182:183], v232 offset:53248
    s_waitcnt lgkmcnt(6)
    v_mfma_f32_16x16x32_bf16 v[36:39], v[188:191], v[164:167], v[36:39]
    ds_read_b64_tr_b16 v[184:185], v233 offset:49152
    v_mfma_f32_16x16x32_bf16 v[4:7], v[188:191], v[160:163], v[4:7]
    ds_read_b64_tr_b16 v[186:187], v233 offset:53248
    s_waitcnt lgkmcnt(6)
    v_mfma_f32_16x16x32_bf16 v[8:11], v[192:195], v[160:163], v[8:11]
    ds_read_b64_tr_b16 v[196:197], v234 offset:49152
    v_mfma_f32_16x16x32_bf16 v[40:43], v[192:195], v[164:167], v[40:43]
    ds_read_b64_tr_b16 v[198:199], v234 offset:53248
    s_waitcnt lgkmcnt(6)
    v_mfma_f32_16x16x32_bf16 v[44:47], v[176:179], v[164:167], v[44:47]
    ds_read_b64_tr_b16 v[192:193], v235 offset:49152
    v_mfma_f32_16x16x32_bf16 v[12:15], v[176:179], v[160:163], v[12:15]
    ds_read_b64_tr_b16 v[194:195], v235 offset:53248
    s_waitcnt lgkmcnt(6)
    v_mfma_f32_16x16x32_bf16 v[16:19], v[180:183], v[160:163], v[16:19]
    v_mfma_f32_16x16x32_bf16 v[48:51], v[180:183], v[164:167], v[48:51]
    s_waitcnt lgkmcnt(4)
    v_mfma_f32_16x16x32_bf16 v[52:55], v[184:187], v[164:167], v[52:55]
    v_mfma_f32_16x16x32_bf16 v[20:23], v[184:187], v[160:163], v[20:23]
    buffer_store_dwordx4 v[220:223], v244, s[24:27], s35 offen offset:0 sc0 sc1
    s_waitcnt lgkmcnt(2)
    v_mfma_f32_16x16x32_bf16 v[24:27], v[196:199], v[160:163], v[24:27]
    v_mfma_f32_16x16x32_bf16 v[56:59], v[196:199], v[164:167], v[56:59]
    s_waitcnt lgkmcnt(0)
    v_mfma_f32_16x16x32_bf16 v[60:63], v[192:195], v[164:167], v[60:63]
    v_mfma_f32_16x16x32_bf16 v[28:31], v[192:195], v[160:163], v[28:31]
.p2align 3
    v_fmamk_f32 v168, v144, 0x3e0293ee, v248
    v_fmamk_f32 v169, v145, 0x3e0293ee, v248
    v_fmamk_f32 v170, v146, 0x3e0293ee, v248
    v_fmamk_f32 v171, v147, 0x3e0293ee, v248
    v_exp_f32 v168, v168
    v_exp_f32 v169, v169
    v_exp_f32 v170, v170
    v_exp_f32 v171, v171
    v_fmamk_f32 v172, v152, 0x3e0293ee, v249
    v_fmamk_f32 v173, v153, 0x3e0293ee, v249
    v_fmamk_f32 v174, v154, 0x3e0293ee, v249
    v_fmamk_f32 v175, v155, 0x3e0293ee, v249
    v_cvt_pk_bf16_f32 v160, v168, v169
    v_cvt_pk_bf16_f32 v161, v170, v171
    v_exp_f32 v172, v172
    v_exp_f32 v173, v173
    v_exp_f32 v174, v174
    v_exp_f32 v175, v175
    v_fmamk_f32 v168, v148, 0x3e0293ee, v248
    v_fmamk_f32 v169, v149, 0x3e0293ee, v248
    v_fmamk_f32 v170, v150, 0x3e0293ee, v248
    v_fmamk_f32 v171, v151, 0x3e0293ee, v248
    v_cvt_pk_bf16_f32 v164, v172, v173
    v_cvt_pk_bf16_f32 v165, v174, v175
    v_exp_f32 v168, v168
    v_exp_f32 v169, v169
    v_exp_f32 v170, v170
    v_exp_f32 v171, v171
    v_fmamk_f32 v172, v156, 0x3e0293ee, v249
    v_fmamk_f32 v173, v157, 0x3e0293ee, v249
    v_fmamk_f32 v174, v158, 0x3e0293ee, v249
    v_fmamk_f32 v175, v159, 0x3e0293ee, v249
    v_cvt_pk_bf16_f32 v162, v168, v169
    v_cvt_pk_bf16_f32 v163, v170, v171
    v_exp_f32 v172, v172
    v_exp_f32 v173, v173
    v_exp_f32 v174, v174
    v_exp_f32 v175, v175
    v_cvt_pk_bf16_f32 v166, v172, v173
    v_cvt_pk_bf16_f32 v167, v174, v175
    ds_read_b64_tr_b16 v[184:185], v228 offset:57344
    ds_read_b64_tr_b16 v[186:187], v228 offset:61440
    ds_read_b64_tr_b16 v[188:189], v229 offset:57344
    ds_read_b64_tr_b16 v[190:191], v229 offset:61440
    ds_read_b64_tr_b16 v[192:193], v230 offset:57344
    ds_read_b64_tr_b16 v[194:195], v230 offset:61440
    ds_read_b64_tr_b16 v[176:177], v231 offset:57344
    ds_read_b64_tr_b16 v[178:179], v231 offset:61440
    v_mfma_f32_16x16x32_bf16 v[208:211], v[216:219], v[160:163], v[200:203]
    v_mfma_f32_16x16x32_bf16 v[212:215], v[216:219], v[164:167], v[204:207]
    s_nop 7
    v_max_f32_e64 v250, v208, v212
    v_cmp_nle_f32_e64 s[42:43], v250, s40
    s_nop 1
    s_cmp_lg_u64 s[42:43], 0
    s_cbranch_scc1 L_stublead27
L_retlead27:
    s_waitcnt lgkmcnt(6)
    v_mfma_f32_16x16x32_bf16 v[0:3], v[184:187], v[160:163], v[0:3]
    ds_read_b64_tr_b16 v[180:181], v232 offset:57344
    v_mfma_f32_16x16x32_bf16 v[32:35], v[184:187], v[164:167], v[32:35]
    ds_read_b64_tr_b16 v[182:183], v232 offset:61440
    s_waitcnt lgkmcnt(6)
    v_mfma_f32_16x16x32_bf16 v[36:39], v[188:191], v[164:167], v[36:39]
    ds_read_b64_tr_b16 v[184:185], v233 offset:57344
    v_mfma_f32_16x16x32_bf16 v[4:7], v[188:191], v[160:163], v[4:7]
    ds_read_b64_tr_b16 v[186:187], v233 offset:61440
    s_waitcnt lgkmcnt(6)
    v_mfma_f32_16x16x32_bf16 v[8:11], v[192:195], v[160:163], v[8:11]
    ds_read_b64_tr_b16 v[196:197], v234 offset:57344
    v_mfma_f32_16x16x32_bf16 v[40:43], v[192:195], v[164:167], v[40:43]
    ds_read_b64_tr_b16 v[198:199], v234 offset:61440
    s_waitcnt lgkmcnt(6)
    v_mfma_f32_16x16x32_bf16 v[44:47], v[176:179], v[164:167], v[44:47]
    ds_read_b64_tr_b16 v[192:193], v235 offset:57344
    v_mfma_f32_16x16x32_bf16 v[12:15], v[176:179], v[160:163], v[12:15]
    ds_read_b64_tr_b16 v[194:195], v235 offset:61440
    s_waitcnt lgkmcnt(6)
    v_mfma_f32_16x16x32_bf16 v[16:19], v[180:183], v[160:163], v[16:19]
    v_mfma_f32_16x16x32_bf16 v[48:51], v[180:183], v[164:167], v[48:51]
    s_waitcnt lgkmcnt(4)
    v_mfma_f32_16x16x32_bf16 v[52:55], v[184:187], v[164:167], v[52:55]
    v_mfma_f32_16x16x32_bf16 v[20:23], v[184:187], v[160:163], v[20:23]
    s_waitcnt lgkmcnt(2)
    v_mfma_f32_16x16x32_bf16 v[24:27], v[196:199], v[160:163], v[24:27]
    v_mfma_f32_16x16x32_bf16 v[56:59], v[196:199], v[164:167], v[56:59]
    s_waitcnt lgkmcnt(0)
    v_mfma_f32_16x16x32_bf16 v[60:63], v[192:195], v[164:167], v[60:63]
    v_mfma_f32_16x16x32_bf16 v[28:31], v[192:195], v[160:163], v[28:31]
    s_setprio 0
    s_mov_b32 s34, s32
    s_mov_b32 s35, s33
    v_rcp_f32 v208, v208
    v_rcp_f32 v212, v212
.p2align 3
    v_mul_f32 v0, v0, v208
    v_mul_f32 v1, v1, v208
    v_mul_f32 v2, v2, v208
    v_mul_f32 v3, v3, v208
    v_mul_f32 v4, v4, v208
    v_mul_f32 v5, v5, v208
    v_mul_f32 v6, v6, v208
    v_mul_f32 v7, v7, v208
    v_cvt_pk_bf16_f32 v96, v0, v1
    v_cvt_pk_bf16_f32 v97, v2, v3
    v_cvt_pk_bf16_f32 v98, v4, v5
    v_cvt_pk_bf16_f32 v99, v6, v7
    v_mul_f32 v8, v8, v208
    v_mul_f32 v9, v9, v208
    v_mul_f32 v10, v10, v208
    v_mul_f32 v11, v11, v208
    v_mul_f32 v12, v12, v208
    v_mul_f32 v13, v13, v208
    v_mul_f32 v14, v14, v208
    v_mul_f32 v15, v15, v208
    v_cvt_pk_bf16_f32 v100, v8, v9
    v_cvt_pk_bf16_f32 v101, v10, v11
    v_cvt_pk_bf16_f32 v102, v12, v13
    v_cvt_pk_bf16_f32 v103, v14, v15
    v_mul_f32 v16, v16, v208
    v_mul_f32 v17, v17, v208
    v_mul_f32 v18, v18, v208
    v_mul_f32 v19, v19, v208
    v_permlane16_swap_b32 v96, v98
    v_permlane16_swap_b32 v97, v99
    v_mul_f32 v20, v20, v208
    v_mul_f32 v21, v21, v208
    v_mul_f32 v22, v22, v208
    v_mul_f32 v23, v23, v208
    v_permlane16_swap_b32 v100, v102
    v_permlane16_swap_b32 v101, v103
    v_cvt_pk_bf16_f32 v104, v16, v17
    v_cvt_pk_bf16_f32 v105, v18, v19
    v_cvt_pk_bf16_f32 v106, v20, v21
    v_cvt_pk_bf16_f32 v107, v22, v23
    v_cndmask_b32_dpp v220, v100, v96, vcc quad_perm:[1,0,3,2] row_mask:0xf bank_mask:0xf
    v_cndmask_b32_dpp v221, v101, v97, vcc quad_perm:[1,0,3,2] row_mask:0xf bank_mask:0xf
    v_mul_f32 v24, v24, v208
    v_mul_f32 v25, v25, v208
    v_mul_f32 v26, v26, v208
    v_mul_f32 v27, v27, v208
    v_cndmask_b32_dpp v222, v102, v98, vcc quad_perm:[1,0,3,2] row_mask:0xf bank_mask:0xf
    v_cndmask_b32_dpp v223, v103, v99, vcc quad_perm:[1,0,3,2] row_mask:0xf bank_mask:0xf
    s_not_b64 vcc, vcc
    s_nop 0
    v_mul_f32 v28, v28, v208
    v_mul_f32 v29, v29, v208
    v_mul_f32 v30, v30, v208
    v_mul_f32 v31, v31, v208
    v_cndmask_b32_dpp v100, v96, v100, vcc quad_perm:[1,0,3,2] row_mask:0xf bank_mask:0xf
    v_cndmask_b32_dpp v101, v97, v101, vcc quad_perm:[1,0,3,2] row_mask:0xf bank_mask:0xf
    v_cvt_pk_bf16_f32 v108, v24, v25
    v_cvt_pk_bf16_f32 v109, v26, v27
    v_cvt_pk_bf16_f32 v110, v28, v29
    v_cvt_pk_bf16_f32 v111, v30, v31
    v_cndmask_b32_dpp v102, v98, v102, vcc quad_perm:[1,0,3,2] row_mask:0xf bank_mask:0xf
    v_cndmask_b32_dpp v103, v99, v103, vcc quad_perm:[1,0,3,2] row_mask:0xf bank_mask:0xf
    s_not_b64 vcc, vcc
    s_nop 0
    buffer_store_dwordx4 v[220:223], v244, s[24:27], s34 offen offset:0 sc0 sc1
    buffer_store_dwordx4 v[100:103], v244, s[24:27], s34 offen offset:256 sc0 sc1
    v_mul_f32 v32, v32, v212
    v_mul_f32 v33, v33, v212
    v_mul_f32 v34, v34, v212
    v_mul_f32 v35, v35, v212
    v_permlane16_swap_b32 v104, v106
    v_permlane16_swap_b32 v105, v107
    v_mul_f32 v36, v36, v212
    v_mul_f32 v37, v37, v212
    v_mul_f32 v38, v38, v212
    v_mul_f32 v39, v39, v212
    v_permlane16_swap_b32 v108, v110
    v_permlane16_swap_b32 v109, v111
    v_cvt_pk_bf16_f32 v112, v32, v33
    v_cvt_pk_bf16_f32 v113, v34, v35
    v_cvt_pk_bf16_f32 v114, v36, v37
    v_cvt_pk_bf16_f32 v115, v38, v39
    v_cndmask_b32_dpp v96, v108, v104, vcc quad_perm:[1,0,3,2] row_mask:0xf bank_mask:0xf
    v_cndmask_b32_dpp v97, v109, v105, vcc quad_perm:[1,0,3,2] row_mask:0xf bank_mask:0xf
    v_mul_f32 v40, v40, v212
    v_mul_f32 v41, v41, v212
    v_mul_f32 v42, v42, v212
    v_mul_f32 v43, v43, v212
    v_cndmask_b32_dpp v98, v110, v106, vcc quad_perm:[1,0,3,2] row_mask:0xf bank_mask:0xf
    v_cndmask_b32_dpp v99, v111, v107, vcc quad_perm:[1,0,3,2] row_mask:0xf bank_mask:0xf
    s_not_b64 vcc, vcc
    s_nop 0
    v_mul_f32 v44, v44, v212
    v_mul_f32 v45, v45, v212
    v_mul_f32 v46, v46, v212
    v_mul_f32 v47, v47, v212
    v_cndmask_b32_dpp v108, v104, v108, vcc quad_perm:[1,0,3,2] row_mask:0xf bank_mask:0xf
    v_cndmask_b32_dpp v109, v105, v109, vcc quad_perm:[1,0,3,2] row_mask:0xf bank_mask:0xf
    v_cvt_pk_bf16_f32 v116, v40, v41
    v_cvt_pk_bf16_f32 v117, v42, v43
    v_cvt_pk_bf16_f32 v118, v44, v45
    v_cvt_pk_bf16_f32 v119, v46, v47
    v_cndmask_b32_dpp v110, v106, v110, vcc quad_perm:[1,0,3,2] row_mask:0xf bank_mask:0xf
    v_cndmask_b32_dpp v111, v107, v111, vcc quad_perm:[1,0,3,2] row_mask:0xf bank_mask:0xf
    s_not_b64 vcc, vcc
    s_nop 0
    buffer_store_dwordx4 v[96:99], v244, s[24:27], s34 offen offset:128 sc0 sc1
    buffer_store_dwordx4 v[108:111], v244, s[24:27], s34 offen offset:384 sc0 sc1
    v_mul_f32 v48, v48, v212
    v_mul_f32 v49, v49, v212
    v_mul_f32 v50, v50, v212
    v_mul_f32 v51, v51, v212
    v_permlane16_swap_b32 v112, v114
    v_permlane16_swap_b32 v113, v115
    v_mul_f32 v52, v52, v212
    v_mul_f32 v53, v53, v212
    v_mul_f32 v54, v54, v212
    v_mul_f32 v55, v55, v212
    v_permlane16_swap_b32 v116, v118
    v_permlane16_swap_b32 v117, v119
    v_cvt_pk_bf16_f32 v120, v48, v49
    v_cvt_pk_bf16_f32 v121, v50, v51
    v_cvt_pk_bf16_f32 v122, v52, v53
    v_cvt_pk_bf16_f32 v123, v54, v55
    v_cndmask_b32_dpp v220, v116, v112, vcc quad_perm:[1,0,3,2] row_mask:0xf bank_mask:0xf
    v_cndmask_b32_dpp v221, v117, v113, vcc quad_perm:[1,0,3,2] row_mask:0xf bank_mask:0xf
    v_mul_f32 v56, v56, v212
    v_mul_f32 v57, v57, v212
    v_mul_f32 v58, v58, v212
    v_mul_f32 v59, v59, v212
    v_cndmask_b32_dpp v222, v118, v114, vcc quad_perm:[1,0,3,2] row_mask:0xf bank_mask:0xf
    v_cndmask_b32_dpp v223, v119, v115, vcc quad_perm:[1,0,3,2] row_mask:0xf bank_mask:0xf
    s_not_b64 vcc, vcc
    s_nop 0
    v_mul_f32 v60, v60, v212
    v_mul_f32 v61, v61, v212
    v_mul_f32 v62, v62, v212
    v_mul_f32 v63, v63, v212
    v_cndmask_b32_dpp v116, v112, v116, vcc quad_perm:[1,0,3,2] row_mask:0xf bank_mask:0xf
    v_cndmask_b32_dpp v117, v113, v117, vcc quad_perm:[1,0,3,2] row_mask:0xf bank_mask:0xf
    v_cvt_pk_bf16_f32 v124, v56, v57
    v_cvt_pk_bf16_f32 v125, v58, v59
    v_cvt_pk_bf16_f32 v126, v60, v61
    v_cvt_pk_bf16_f32 v127, v62, v63
    v_cndmask_b32_dpp v118, v114, v118, vcc quad_perm:[1,0,3,2] row_mask:0xf bank_mask:0xf
    v_cndmask_b32_dpp v119, v115, v119, vcc quad_perm:[1,0,3,2] row_mask:0xf bank_mask:0xf
    s_not_b64 vcc, vcc
    s_nop 0
    buffer_store_dwordx4 v[220:223], v244, s[24:27], s35 offen offset:0 sc0 sc1
    buffer_store_dwordx4 v[116:119], v244, s[24:27], s35 offen offset:256 sc0 sc1
    v_permlane16_swap_b32 v120, v122
    v_permlane16_swap_b32 v121, v123
    v_permlane16_swap_b32 v124, v126
    v_permlane16_swap_b32 v125, v127
    s_nop 0
    v_cndmask_b32_dpp v112, v124, v120, vcc quad_perm:[1,0,3,2] row_mask:0xf bank_mask:0xf
    v_cndmask_b32_dpp v113, v125, v121, vcc quad_perm:[1,0,3,2] row_mask:0xf bank_mask:0xf
    v_cndmask_b32_dpp v114, v126, v122, vcc quad_perm:[1,0,3,2] row_mask:0xf bank_mask:0xf
    v_cndmask_b32_dpp v115, v127, v123, vcc quad_perm:[1,0,3,2] row_mask:0xf bank_mask:0xf
    s_not_b64 vcc, vcc
    s_nop 0
    v_cndmask_b32_dpp v124, v120, v124, vcc quad_perm:[1,0,3,2] row_mask:0xf bank_mask:0xf
    v_cndmask_b32_dpp v125, v121, v125, vcc quad_perm:[1,0,3,2] row_mask:0xf bank_mask:0xf
    v_cndmask_b32_dpp v126, v122, v126, vcc quad_perm:[1,0,3,2] row_mask:0xf bank_mask:0xf
    v_cndmask_b32_dpp v127, v123, v127, vcc quad_perm:[1,0,3,2] row_mask:0xf bank_mask:0xf
    s_not_b64 vcc, vcc
    s_nop 0
    buffer_store_dwordx4 v[112:115], v244, s[24:27], s35 offen offset:128 sc0 sc1
    buffer_store_dwordx4 v[124:127], v244, s[24:27], s35 offen offset:384 sc0 sc1
    s_waitcnt vmcnt(0)
    s_endpgm
L_endlead:
L_stublead0:
    s_call_b64 s[56:57], L_rare1
    s_branch L_retlead0
L_stublead1:
    s_call_b64 s[56:57], L_rare0
    s_branch L_retlead1
L_stublead2:
    s_call_b64 s[56:57], L_rare1
    s_branch L_retlead2
L_stublead3:
    s_call_b64 s[56:57], L_rare0
    s_branch L_retlead3
L_stublead4:
    s_call_b64 s[56:57], L_rare1
    s_branch L_retlead4
L_stublead5:
    s_call_b64 s[56:57], L_rare0
    s_branch L_retlead5
L_stublead6:
    s_call_b64 s[56:57], L_rare1
    s_branch L_retlead6
L_stublead7:
    s_call_b64 s[56:57], L_rare1
    s_branch L_retlead7
L_stublead8:
    s_call_b64 s[56:57], L_rare0
    s_branch L_retlead8
L_stublead9:
    s_call_b64 s[56:57], L_rare1
    s_branch L_retlead9
L_stublead10:
    s_call_b64 s[56:57], L_rare0
    s_branch L_retlead10
L_stublead11:
    s_call_b64 s[56:57], L_rare1
    s_branch L_retlead11
L_stublead12:
    s_call_b64 s[56:57], L_rare0
    s_branch L_retlead12
L_stublead13:
    s_call_b64 s[56:57], L_rare1
    s_branch L_retlead13
L_stublead14:
    s_call_b64 s[56:57], L_rare1
    s_branch L_retlead14
L_stublead15:
    s_call_b64 s[56:57], L_rare0
    s_branch L_retlead15
L_stublead16:
    s_call_b64 s[56:57], L_rare1
    s_branch L_retlead16
L_stublead17:
    s_call_b64 s[56:57], L_rare0
    s_branch L_retlead17
L_stublead18:
    s_call_b64 s[56:57], L_rare1
    s_branch L_retlead18
L_stublead19:
    s_call_b64 s[56:57], L_rare0
    s_branch L_retlead19
L_stublead20:
    s_call_b64 s[56:57], L_rare1
    s_branch L_retlead20
L_stublead21:
    s_call_b64 s[56:57], L_rare1
    s_branch L_retlead21
L_stublead22:
    s_call_b64 s[56:57], L_rare0
    s_branch L_retlead22
L_stublead23:
    s_call_b64 s[56:57], L_rare1
    s_branch L_retlead23
L_stublead24:
    s_call_b64 s[56:57], L_rare0
    s_branch L_retlead24
L_stublead25:
    s_call_b64 s[56:57], L_rare1
    s_branch L_retlead25
L_stublead26:
    s_call_b64 s[56:57], L_rare0
    s_branch L_retlead26
L_stublead27:
    s_call_b64 s[56:57], L_rare1
    s_branch L_retlead27
L_rare0:
    s_nop 7
    v_max_f32_e64 v250, v128, v129
    v_max_f32_e64 v251, v136, v137
    v_max3_f32 v250, v250, v130, v131
    v_max3_f32 v251, v251, v138, v139
    v_max3_f32 v250, v250, v132, v133
    v_max3_f32 v251, v251, v140, v141
    v_max3_f32 v250, v250, v134, v135
    v_max3_f32 v251, v251, v142, v143
    s_nop 1
    v_permlane32_swap_b32 v250, v251
    v_max_f32 v250, v250, v251
    v_mov_b32 v251, v250
    s_nop 1
    v_permlane16_swap_b32 v250, v251
    v_max_f32 v250, v250, v251
    v_mul_f32 v250, 0xbe0293ee, v250
    v_mov_b32 v251, v250
    s_nop 1
    v_permlane32_swap_b32 v250, v251
    v_min_f32 v250, v250, v248
    v_sub_f32 v252, v250, v248
    v_mov_b32 v248, v250
    v_exp_f32 v252, v252
    v_min_f32 v251, v251, v249
    v_sub_f32 v253, v251, v249
    v_mov_b32 v249, v251
    v_exp_f32 v253, v253
    v_mul_f32 v0, v0, v252
    v_mul_f32 v1, v1, v252
    v_mul_f32 v2, v2, v252
    v_mul_f32 v3, v3, v252
    v_mul_f32 v4, v4, v252
    v_mul_f32 v5, v5, v252
    v_mul_f32 v6, v6, v252
    v_mul_f32 v7, v7, v252
    v_mul_f32 v8, v8, v252
    v_mul_f32 v9, v9, v252
    v_mul_f32 v10, v10, v252
    v_mul_f32 v11, v11, v252
    v_mul_f32 v12, v12, v252
    v_mul_f32 v13, v13, v252
    v_mul_f32 v14, v14, v252
    v_mul_f32 v15, v15, v252
    v_mul_f32 v16, v16, v252
    v_mul_f32 v17, v17, v252
    v_mul_f32 v18, v18, v252
    v_mul_f32 v19, v19, v252
    v_mul_f32 v20, v20, v252
    v_mul_f32 v21, v21, v252
    v_mul_f32 v22, v22, v252
    v_mul_f32 v23, v23, v252
    v_mul_f32 v24, v24, v252
    v_mul_f32 v25, v25, v252
    v_mul_f32 v26, v26, v252
    v_mul_f32 v27, v27, v252
    v_mul_f32 v28, v28, v252
    v_mul_f32 v29, v29, v252
    v_mul_f32 v30, v30, v252
    v_mul_f32 v31, v31, v252
    v_mul_f32 v208, v208, v252
    v_mul_f32 v209, v209, v252
    v_mul_f32 v210, v210, v252
    v_mul_f32 v211, v211, v252
    v_mul_f32 v32, v32, v253
    v_mul_f32 v33, v33, v253
    v_mul_f32 v34, v34, v253
    v_mul_f32 v35, v35, v253
    v_mul_f32 v36, v36, v253
    v_mul_f32 v37, v37, v253
    v_mul_f32 v38, v38, v253
    v_mul_f32 v39, v39, v253
    v_mul_f32 v40, v40, v253
    v_mul_f32 v41, v41, v253
    v_mul_f32 v42, v42, v253
    v_mul_f32 v43, v43, v253
    v_mul_f32 v44, v44, v253
    v_mul_f32 v45, v45, v253
    v_mul_f32 v46, v46, v253
    v_mul_f32 v47, v47, v253
    v_mul_f32 v48, v48, v253
    v_mul_f32 v49, v49, v253
    v_mul_f32 v50, v50, v253
    v_mul_f32 v51, v51, v253
    v_mul_f32 v52, v52, v253
    v_mul_f32 v53, v53, v253
    v_mul_f32 v54, v54, v253
    v_mul_f32 v55, v55, v253
    v_mul_f32 v56, v56, v253
    v_mul_f32 v57, v57, v253
    v_mul_f32 v58, v58, v253
    v_mul_f32 v59, v59, v253
    v_mul_f32 v60, v60, v253
    v_mul_f32 v61, v61, v253
    v_mul_f32 v62, v62, v253
    v_mul_f32 v63, v63, v253
    v_mul_f32 v212, v212, v253
    v_mul_f32 v213, v213, v253
    v_mul_f32 v214, v214, v253
    v_mul_f32 v215, v215, v253
    v_fmamk_f32 v168, v128, 0x3e0293ee, v248
    v_fmamk_f32 v169, v129, 0x3e0293ee, v248
    v_fmamk_f32 v170, v130, 0x3e0293ee, v248
    v_fmamk_f32 v171, v131, 0x3e0293ee, v248
    v_exp_f32 v168, v168
    v_exp_f32 v169, v169
    v_exp_f32 v170, v170
    v_exp_f32 v171, v171
    v_fmamk_f32 v172, v136, 0x3e0293ee, v249
    v_fmamk_f32 v173, v137, 0x3e0293ee, v249
    v_fmamk_f32 v174, v138, 0x3e0293ee, v249
    v_fmamk_f32 v175, v139, 0x3e0293ee, v249
    v_cvt_pk_bf16_f32 v160, v168, v169
    v_cvt_pk_bf16_f32 v161, v170, v171
    v_exp_f32 v172, v172
    v_exp_f32 v173, v173
    v_exp_f32 v174, v174
    v_exp_f32 v175, v175
    v_fmamk_f32 v168, v132, 0x3e0293ee, v248
    v_fmamk_f32 v169, v133, 0x3e0293ee, v248
    v_fmamk_f32 v170, v134, 0x3e0293ee, v248
    v_fmamk_f32 v171, v135, 0x3e0293ee, v248
    v_cvt_pk_bf16_f32 v164, v172, v173
    v_cvt_pk_bf16_f32 v165, v174, v175
    v_exp_f32 v168, v168
    v_exp_f32 v169, v169
    v_exp_f32 v170, v170
    v_exp_f32 v171, v171
    v_fmamk_f32 v172, v140, 0x3e0293ee, v249
    v_fmamk_f32 v173, v141, 0x3e0293ee, v249
    v_fmamk_f32 v174, v142, 0x3e0293ee, v249
    v_fmamk_f32 v175, v143, 0x3e0293ee, v249
    v_cvt_pk_bf16_f32 v162, v168, v169
    v_cvt_pk_bf16_f32 v163, v170, v171
    v_exp_f32 v172, v172
    v_exp_f32 v173, v173
    v_exp_f32 v174, v174
    v_exp_f32 v175, v175
    v_cvt_pk_bf16_f32 v166, v172, v173
    v_cvt_pk_bf16_f32 v167, v174, v175
    v_mfma_f32_16x16x32_bf16 v[200:203], v[216:219], v[160:163], v[208:211]
    s_nop 0
    v_mfma_f32_16x16x32_bf16 v[204:207], v[216:219], v[164:167], v[212:215]
    s_nop 7
    s_setpc_b64 s[56:57]
L_rare1:
    s_nop 7
    v_max_f32_e64 v250, v144, v145
    v_max_f32_e64 v251, v152, v153
    v_max3_f32 v250, v250, v146, v147
    v_max3_f32 v251, v251, v154, v155
    v_max3_f32 v250, v250, v148, v149
    v_max3_f32 v251, v251, v156, v157
    v_max3_f32 v250, v250, v150, v151
    v_max3_f32 v251, v251, v158, v159
    s_nop 1
    v_permlane32_swap_b32 v250, v251
    v_max_f32 v250, v250, v251
    v_mov_b32 v251, v250
    s_nop 1
    v_permlane16_swap_b32 v250, v251
    v_max_f32 v250, v250, v251
    v_mul_f32 v250, 0xbe0293ee, v250
    v_mov_b32 v251, v250
    s_nop 1
    v_permlane32_swap_b32 v250, v251
    v_min_f32 v250, v250, v248
    v_sub_f32 v252, v250, v248
    v_mov_b32 v248, v250
    v_exp_f32 v252, v252
    v_min_f32 v251, v251, v249
    v_sub_f32 v253, v251, v249
    v_mov_b32 v249, v251
    v_exp_f32 v253, v253
    v_mul_f32 v0, v0, v252
    v_mul_f32 v1, v1, v252
    v_mul_f32 v2, v2, v252
    v_mul_f32 v3, v3, v252
    v_mul_f32 v4, v4, v252
    v_mul_f32 v5, v5, v252
    v_mul_f32 v6, v6, v252
    v_mul_f32 v7, v7, v252
    v_mul_f32 v8, v8, v252
    v_mul_f32 v9, v9, v252
    v_mul_f32 v10, v10, v252
    v_mul_f32 v11, v11, v252
    v_mul_f32 v12, v12, v252
    v_mul_f32 v13, v13, v252
    v_mul_f32 v14, v14, v252
    v_mul_f32 v15, v15, v252
    v_mul_f32 v16, v16, v252
    v_mul_f32 v17, v17, v252
    v_mul_f32 v18, v18, v252
    v_mul_f32 v19, v19, v252
    v_mul_f32 v20, v20, v252
    v_mul_f32 v21, v21, v252
    v_mul_f32 v22, v22, v252
    v_mul_f32 v23, v23, v252
    v_mul_f32 v24, v24, v252
    v_mul_f32 v25, v25, v252
    v_mul_f32 v26, v26, v252
    v_mul_f32 v27, v27, v252
    v_mul_f32 v28, v28, v252
    v_mul_f32 v29, v29, v252
    v_mul_f32 v30, v30, v252
    v_mul_f32 v31, v31, v252
    v_mul_f32 v200, v200, v252
    v_mul_f32 v201, v201, v252
    v_mul_f32 v202, v202, v252
    v_mul_f32 v203, v203, v252
    v_mul_f32 v32, v32, v253
    v_mul_f32 v33, v33, v253
    v_mul_f32 v34, v34, v253
    v_mul_f32 v35, v35, v253
    v_mul_f32 v36, v36, v253
    v_mul_f32 v37, v37, v253
    v_mul_f32 v38, v38, v253
    v_mul_f32 v39, v39, v253
    v_mul_f32 v40, v40, v253
    v_mul_f32 v41, v41, v253
    v_mul_f32 v42, v42, v253
    v_mul_f32 v43, v43, v253
    v_mul_f32 v44, v44, v253
    v_mul_f32 v45, v45, v253
    v_mul_f32 v46, v46, v253
    v_mul_f32 v47, v47, v253
    v_mul_f32 v48, v48, v253
    v_mul_f32 v49, v49, v253
    v_mul_f32 v50, v50, v253
    v_mul_f32 v51, v51, v253
    v_mul_f32 v52, v52, v253
    v_mul_f32 v53, v53, v253
    v_mul_f32 v54, v54, v253
    v_mul_f32 v55, v55, v253
    v_mul_f32 v56, v56, v253
    v_mul_f32 v57, v57, v253
    v_mul_f32 v58, v58, v253
    v_mul_f32 v59, v59, v253
    v_mul_f32 v60, v60, v253
    v_mul_f32 v61, v61, v253
    v_mul_f32 v62, v62, v253
    v_mul_f32 v63, v63, v253
    v_mul_f32 v204, v204, v253
    v_mul_f32 v205, v205, v253
    v_mul_f32 v206, v206, v253
    v_mul_f32 v207, v207, v253
    v_fmamk_f32 v168, v144, 0x3e0293ee, v248
    v_fmamk_f32 v169, v145, 0x3e0293ee, v248
    v_fmamk_f32 v170, v146, 0x3e0293ee, v248
    v_fmamk_f32 v171, v147, 0x3e0293ee, v248
    v_exp_f32 v168, v168
    v_exp_f32 v169, v169
    v_exp_f32 v170, v170
    v_exp_f32 v171, v171
    v_fmamk_f32 v172, v152, 0x3e0293ee, v249
    v_fmamk_f32 v173, v153, 0x3e0293ee, v249
    v_fmamk_f32 v174, v154, 0x3e0293ee, v249
    v_fmamk_f32 v175, v155, 0x3e0293ee, v249
    v_cvt_pk_bf16_f32 v160, v168, v169
    v_cvt_pk_bf16_f32 v161, v170, v171
    v_exp_f32 v172, v172
    v_exp_f32 v173, v173
    v_exp_f32 v174, v174
    v_exp_f32 v175, v175
    v_fmamk_f32 v168, v148, 0x3e0293ee, v248
    v_fmamk_f32 v169, v149, 0x3e0293ee, v248
    v_fmamk_f32 v170, v150, 0x3e0293ee, v248
    v_fmamk_f32 v171, v151, 0x3e0293ee, v248
    v_cvt_pk_bf16_f32 v164, v172, v173
    v_cvt_pk_bf16_f32 v165, v174, v175
    v_exp_f32 v168, v168
    v_exp_f32 v169, v169
    v_exp_f32 v170, v170
    v_exp_f32 v171, v171
    v_fmamk_f32 v172, v156, 0x3e0293ee, v249
    v_fmamk_f32 v173, v157, 0x3e0293ee, v249
    v_fmamk_f32 v174, v158, 0x3e0293ee, v249
    v_fmamk_f32 v175, v159, 0x3e0293ee, v249
    v_cvt_pk_bf16_f32 v162, v168, v169
    v_cvt_pk_bf16_f32 v163, v170, v171
    v_exp_f32 v172, v172
    v_exp_f32 v173, v173
    v_exp_f32 v174, v174
    v_exp_f32 v175, v175
    v_cvt_pk_bf16_f32 v166, v172, v173
    v_cvt_pk_bf16_f32 v167, v174, v175
    v_mfma_f32_16x16x32_bf16 v[208:211], v[216:219], v[160:163], v[200:203]
    s_nop 0
    v_mfma_f32_16x16x32_bf16 v[212:215], v[216:219], v[164:167], v[204:207]
    s_nop 7
    s_setpc_b64 s[56:57]
.p2align 6
L_lag:
    s_waitcnt vmcnt(9)
    s_barrier
    s_add_u32 m0, s37, 0x2000
    s_xor_b32 s38, s36, 0x1000
    buffer_load_dwordx4 v245, s[16:19], s38 offen offset:0 nt lds
    s_add_u32 m0, s37, 0x10000
    s_xor_b32 s38, s36, 0x0
    buffer_load_dwordx4 v246, s[20:23], s38 offen offset:0 nt lds
    s_add_u32 m0, s37, 0x4000
    s_xor_b32 s38, s36, 0x2000
    buffer_load_dwordx4 v245, s[16:19], s38 offen offset:0 nt lds
    s_waitcnt vmcnt(4)
    ds_read_b128 v[64:67], v236 offset:0
    ds_read_b128 v[68:71], v237 offset:0
    ds_read_b128 v[72:75], v238 offset:0
    ds_read_b128 v[76:79], v239 offset:0
    ds_read_b128 v[80:83], v168 offset:0
    ds_read_b128 v[84:87], v169 offset:0
    ds_read_b128 v[88:91], v170 offset:0
    ds_read_b128 v[92:95], v171 offset:0
    s_setprio 0
.p2align 3
    ds_read_b128 v[176:179], v224 offset:0
    ds_read_b128 v[180:183], v225 offset:0
    ds_read_b128 v[184:187], v226 offset:0
    ds_read_b128 v[188:191], v227 offset:0
    s_waitcnt lgkmcnt(3)
    v_mfma_f32_16x16x32_bf16 v[128:131], v[176:179], v[64:67], 0
    s_setprio 3
    ds_read_b128 v[192:195], v224 offset:4096
    v_mfma_f32_16x16x32_bf16 v[136:139], v[176:179], v[80:83], 0
    s_waitcnt lgkmcnt(3)
    v_mfma_f32_16x16x32_bf16 v[136:139], v[180:183], v[84:87], v[136:139]
    ds_read_b128 v[196:199], v225 offset:4096
    v_mfma_f32_16x16x32_bf16 v[128:131], v[180:183], v[68:71], v[128:131]
    s_waitcnt lgkmcnt(3)
    v_mfma_f32_16x16x32_bf16 v[128:131], v[184:187], v[72:75], v[128:131]
    ds_read_b128 v[176:179], v226 offset:4096
    v_mfma_f32_16x16x32_bf16 v[136:139], v[184:187], v[88:91], v[136:139]
    s_waitcnt lgkmcnt(3)
    v_mfma_f32_16x16x32_bf16 v[136:139], v[188:191], v[92:95], v[136:139]
    ds_read_b128 v[180:183], v227 offset:4096
    v_mfma_f32_16x16x32_bf16 v[128:131], v[188:191], v[76:79], v[128:131]
    s_waitcnt lgkmcnt(3)
    v_mfma_f32_16x16x32_bf16 v[132:135], v[192:195], v[64:67], 0
    v_mfma_f32_16x16x32_bf16 v[140:143], v[192:195], v[80:83], 0
    s_waitcnt lgkmcnt(2)
    v_mfma_f32_16x16x32_bf16 v[140:143], v[196:199], v[84:87], v[140:143]
    v_mfma_f32_16x16x32_bf16 v[132:135], v[196:199], v[68:71], v[132:135]
    s_waitcnt lgkmcnt(1)
    v_mfma_f32_16x16x32_bf16 v[132:135], v[176:179], v[72:75], v[132:135]
    v_mfma_f32_16x16x32_bf16 v[140:143], v[176:179], v[88:91], v[140:143]
    s_waitcnt lgkmcnt(0)
    s_waitcnt vmcnt(1)
    s_barrier
    v_mfma_f32_16x16x32_bf16 v[140:143], v[180:183], v[92:95], v[140:143]
    v_mfma_f32_16x16x32_bf16 v[132:135], v[180:183], v[76:79], v[132:135]
    s_mov_b32 s50, s35
    s_mov_b32 s34, s32
    s_mov_b32 s32, s30
    s_xor_b32 s30, s30, 0x4000
    s_mov_b32 s35, s33
    s_mov_b32 s33, s31
    s_xor_b32 s31, s31, 0x4000
    s_setprio 0
.p2align 3
    v_max_f32_e64 v248, v128, v129
    v_max_f32_e64 v249, v136, v137
    v_max3_f32 v248, v248, v130, v131
    v_max3_f32 v249, v249, v138, v139
    v_max3_f32 v248, v248, v132, v133
    v_max3_f32 v249, v249, v140, v141
    v_max3_f32 v248, v248, v134, v135
    v_max3_f32 v249, v249, v142, v143
    s_nop 1
    v_permlane32_swap_b32 v248, v249
    v_max_f32 v248, v248, v249
    v_mov_b32 v249, v248
    s_nop 1
    v_permlane16_swap_b32 v248, v249
    v_max_f32 v248, v248, v249
    v_mul_f32 v248, 0xbe0293ee, v248
    v_mov_b32 v249, v248
    s_nop 1
    v_permlane32_swap_b32 v248, v249
.p2align 3
    v_fmamk_f32 v168, v128, 0x3e0293ee, v248
    v_fmamk_f32 v169, v129, 0x3e0293ee, v248
    v_fmamk_f32 v170, v130, 0x3e0293ee, v248
    v_fmamk_f32 v171, v131, 0x3e0293ee, v248
    v_exp_f32 v168, v168
    v_exp_f32 v169, v169
    v_exp_f32 v170, v170
    v_exp_f32 v171, v171
    v_fmamk_f32 v172, v136, 0x3e0293ee, v249
    v_fmamk_f32 v173, v137, 0x3e0293ee, v249
    v_fmamk_f32 v174, v138, 0x3e0293ee, v249
    v_fmamk_f32 v175, v139, 0x3e0293ee, v249
    s_setprio 1
    s_nop 0
    v_cvt_pk_bf16_f32 v160, v168, v169
    v_cvt_pk_bf16_f32 v161, v170, v171
    v_exp_f32 v172, v172
    v_exp_f32 v173, v173
    v_exp_f32 v174, v174
    v_exp_f32 v175, v175
    v_fmamk_f32 v168, v132, 0x3e0293ee, v248
    v_fmamk_f32 v169, v133, 0x3e0293ee, v248
    v_fmamk_f32 v170, v134, 0x3e0293ee, v248
    v_fmamk_f32 v171, v135, 0x3e0293ee, v248
    v_cvt_pk_bf16_f32 v164, v172, v173
    v_cvt_pk_bf16_f32 v165, v174, v175
    v_exp_f32 v168, v168
    v_exp_f32 v169, v169
    v_exp_f32 v170, v170
    v_exp_f32 v171, v171
    v_fmamk_f32 v172, v140, 0x3e0293ee, v249
    v_fmamk_f32 v173, v141, 0x3e0293ee, v249
    v_fmamk_f32 v174, v142, 0x3e0293ee, v249
    v_fmamk_f32 v175, v143, 0x3e0293ee, v249
    v_cvt_pk_bf16_f32 v162, v168, v169
    v_cvt_pk_bf16_f32 v163, v170, v171
    v_exp_f32 v172, v172
    v_exp_f32 v173, v173
    v_exp_f32 v174, v174
    v_exp_f32 v175, v175
    v_cvt_pk_bf16_f32 v166, v172, v173
    v_cvt_pk_bf16_f32 v167, v174, v175
    ds_read_b128 v[176:179], v224 offset:8192
    ds_read_b128 v[180:183], v225 offset:8192
    ds_read_b128 v[184:187], v226 offset:8192
    ds_read_b128 v[188:191], v227 offset:8192
    v_mfma_f32_16x16x32_bf16 v[200:203], v[216:219], v[160:163], 0
    v_mfma_f32_16x16x32_bf16 v[204:207], v[216:219], v[164:167], 0
    s_waitcnt lgkmcnt(3)
    v_mfma_f32_16x16x32_bf16 v[144:147], v[176:179], v[64:67], 0
    s_setprio 3
    ds_read_b128 v[192:195], v224 offset:12288
    v_mfma_f32_16x16x32_bf16 v[152:155], v[176:179], v[80:83], 0
    s_add_u32 m0, s37, 0x6000
    s_xor_b32 s38, s36, 0x3000
    buffer_load_dwordx4 v245, s[16:19], s38 offen offset:0 nt lds
    s_waitcnt lgkmcnt(3)
    v_mfma_f32_16x16x32_bf16 v[152:155], v[180:183], v[84:87], v[152:155]
    ds_read_b128 v[196:199], v225 offset:12288
    v_mfma_f32_16x16x32_bf16 v[144:147], v[180:183], v[68:71], v[144:147]
    s_waitcnt lgkmcnt(3)
    v_mfma_f32_16x16x32_bf16 v[144:147], v[184:187], v[72:75], v[144:147]
    ds_read_b128 v[176:179], v226 offset:12288
    v_mfma_f32_16x16x32_bf16 v[152:155], v[184:187], v[88:91], v[152:155]
    s_add_u32 m0, s37, 0x12000
    s_xor_b32 s38, s36, 0x1000
    buffer_load_dwordx4 v246, s[20:23], s38 offen offset:0 nt lds
    s_waitcnt lgkmcnt(3)
    v_mfma_f32_16x16x32_bf16 v[152:155], v[188:191], v[92:95], v[152:155]
    ds_read_b128 v[180:183], v227 offset:12288
    v_mfma_f32_16x16x32_bf16 v[144:147], v[188:191], v[76:79], v[144:147]
    s_waitcnt lgkmcnt(3)
    v_mfma_f32_16x16x32_bf16 v[148:151], v[192:195], v[64:67], 0
    ds_read_b64_tr_b16 v[184:185], v228 offset:0
    v_mfma_f32_16x16x32_bf16 v[156:159], v[192:195], v[80:83], 0
    ds_read_b64_tr_b16 v[186:187], v228 offset:4096
    s_add_u32 m0, s58, 0x0
    s_nop 0
    buffer_load_dwordx4 v240, s[12:15], s30 offen offset:0 nt lds
    s_waitcnt lgkmcnt(4)
    v_mfma_f32_16x16x32_bf16 v[156:159], v[196:199], v[84:87], v[156:159]
    ds_read_b64_tr_b16 v[188:189], v229 offset:0
    v_mfma_f32_16x16x32_bf16 v[148:151], v[196:199], v[68:71], v[148:151]
    ds_read_b64_tr_b16 v[190:191], v229 offset:4096
    s_waitcnt lgkmcnt(5)
    v_mfma_f32_16x16x32_bf16 v[148:151], v[176:179], v[72:75], v[148:151]
    ds_read_b64_tr_b16 v[192:193], v230 offset:0
    v_mfma_f32_16x16x32_bf16 v[156:159], v[176:179], v[88:91], v[156:159]
    ds_read_b64_tr_b16 v[194:195], v230 offset:4096
    s_waitcnt lgkmcnt(6)
    v_mfma_f32_16x16x32_bf16 v[156:159], v[180:183], v[92:95], v[156:159]
    ds_read_b64_tr_b16 v[176:177], v231 offset:0
    v_mfma_f32_16x16x32_bf16 v[148:151], v[180:183], v[76:79], v[148:151]
    ds_read_b64_tr_b16 v[178:179], v231 offset:4096
    s_waitcnt lgkmcnt(6)
    v_mfma_f32_16x16x32_bf16 v[0:3], v[184:187], v[160:163], 0
    ds_read_b64_tr_b16 v[180:181], v232 offset:0
    v_mfma_f32_16x16x32_bf16 v[32:35], v[184:187], v[164:167], 0
    ds_read_b64_tr_b16 v[182:183], v232 offset:4096
    s_waitcnt lgkmcnt(6)
    v_mfma_f32_16x16x32_bf16 v[36:39], v[188:191], v[164:167], 0
    ds_read_b64_tr_b16 v[184:185], v233 offset:0
    v_mfma_f32_16x16x32_bf16 v[4:7], v[188:191], v[160:163], 0
    ds_read_b64_tr_b16 v[186:187], v233 offset:4096
    s_waitcnt lgkmcnt(6)
    v_mfma_f32_16x16x32_bf16 v[8:11], v[192:195], v[160:163], 0
    ds_read_b64_tr_b16 v[196:197], v234 offset:0
    v_mfma_f32_16x16x32_bf16 v[40:43], v[192:195], v[164:167], 0
    ds_read_b64_tr_b16 v[198:199], v234 offset:4096
    s_waitcnt lgkmcnt(6)
    v_mfma_f32_16x16x32_bf16 v[44:47], v[176:179], v[164:167], 0
    ds_read_b64_tr_b16 v[192:193], v235 offset:0
    v_mfma_f32_16x16x32_bf16 v[12:15], v[176:179], v[160:163], 0
    ds_read_b64_tr_b16 v[194:195], v235 offset:4096
    s_waitcnt lgkmcnt(6)
    v_mfma_f32_16x16x32_bf16 v[16:19], v[180:183], v[160:163], 0
    v_mfma_f32_16x16x32_bf16 v[48:51], v[180:183], v[164:167], 0
    s_waitcnt lgkmcnt(4)
    v_mfma_f32_16x16x32_bf16 v[52:55], v[184:187], v[164:167], 0
    v_mfma_f32_16x16x32_bf16 v[20:23], v[184:187], v[160:163], 0
    s_waitcnt lgkmcnt(2)
    v_mfma_f32_16x16x32_bf16 v[24:27], v[196:199], v[160:163], 0
    v_mfma_f32_16x16x32_bf16 v[56:59], v[196:199], v[164:167], 0
    s_waitcnt lgkmcnt(0)
    s_waitcnt vmcnt(1)
    s_barrier
    v_mfma_f32_16x16x32_bf16 v[60:63], v[192:195], v[164:167], 0
    v_mfma_f32_16x16x32_bf16 v[28:31], v[192:195], v[160:163], 0
    s_setprio 0
.p2align 3
    v_fmamk_f32 v168, v144, 0x3e0293ee, v248
    v_fmamk_f32 v169, v145, 0x3e0293ee, v248
    v_fmamk_f32 v170, v146, 0x3e0293ee, v248
    v_fmamk_f32 v171, v147, 0x3e0293ee, v248
    v_exp_f32 v168, v168
    v_exp_f32 v169, v169
    v_exp_f32 v170, v170
    v_exp_f32 v171, v171
    v_fmamk_f32 v172, v152, 0x3e0293ee, v249
    v_fmamk_f32 v173, v153, 0x3e0293ee, v249
    v_fmamk_f32 v174, v154, 0x3e0293ee, v249
    v_fmamk_f32 v175, v155, 0x3e0293ee, v249
    v_cvt_pk_bf16_f32 v160, v168, v169
    v_cvt_pk_bf16_f32 v161, v170, v171
    v_exp_f32 v172, v172
    v_exp_f32 v173, v173
    v_exp_f32 v174, v174
    v_exp_f32 v175, v175
    v_fmamk_f32 v168, v148, 0x3e0293ee, v248
    v_fmamk_f32 v169, v149, 0x3e0293ee, v248
    v_fmamk_f32 v170, v150, 0x3e0293ee, v248
    v_fmamk_f32 v171, v151, 0x3e0293ee, v248
    s_setprio 1
    s_nop 0
    v_cvt_pk_bf16_f32 v164, v172, v173
    v_cvt_pk_bf16_f32 v165, v174, v175
    v_exp_f32 v168, v168
    v_exp_f32 v169, v169
    v_exp_f32 v170, v170
    v_exp_f32 v171, v171
    v_fmamk_f32 v172, v156, 0x3e0293ee, v249
    v_fmamk_f32 v173, v157, 0x3e0293ee, v249
    v_fmamk_f32 v174, v158, 0x3e0293ee, v249
    v_fmamk_f32 v175, v159, 0x3e0293ee, v249
    v_cvt_pk_bf16_f32 v162, v168, v169
    v_cvt_pk_bf16_f32 v163, v170, v171
    v_exp_f32 v172, v172
    v_exp_f32 v173, v173
    v_exp_f32 v174, v174
    v_exp_f32 v175, v175
    v_cvt_pk_bf16_f32 v166, v172, v173
    v_cvt_pk_bf16_f32 v167, v174, v175
    ds_read_b128 v[176:179], v224 offset:16384
    ds_read_b128 v[180:183], v225 offset:16384
    ds_read_b128 v[184:187], v226 offset:16384
    ds_read_b128 v[188:191], v227 offset:16384
    s_waitcnt vmcnt(0)
    v_mfma_f32_16x16x32_bf16 v[208:211], v[216:219], v[160:163], v[200:203]
    v_mfma_f32_16x16x32_bf16 v[212:215], v[216:219], v[164:167], v[204:207]
    s_waitcnt lgkmcnt(3)
    v_mfma_f32_16x16x32_bf16 v[128:131], v[176:179], v[64:67], 0
    s_setprio 3
    ds_read_b128 v[192:195], v224 offset:20480
    v_mfma_f32_16x16x32_bf16 v[136:139], v[176:179], v[80:83], 0
    s_add_u32 m0, s37, 0x8000
    s_xor_b32 s38, s36, 0x4000
    buffer_load_dwordx4 v245, s[16:19], s38 offen offset:0 nt lds
    s_waitcnt lgkmcnt(3)
    v_mfma_f32_16x16x32_bf16 v[136:139], v[180:183], v[84:87], v[136:139]
    ds_read_b128 v[196:199], v225 offset:20480
    v_mfma_f32_16x16x32_bf16 v[128:131], v[180:183], v[68:71], v[128:131]
    s_waitcnt lgkmcnt(3)
    v_mfma_f32_16x16x32_bf16 v[128:131], v[184:187], v[72:75], v[128:131]
    ds_read_b128 v[176:179], v226 offset:20480
    v_mfma_f32_16x16x32_bf16 v[136:139], v[184:187], v[88:91], v[136:139]
    v_max_f32_e64 v250, v208, v212
    v_cmp_nle_f32_e64 s[42:43], v250, s40
    s_add_u32 m0, s37, 0x14000
    s_xor_b32 s38, s36, 0x2000
    buffer_load_dwordx4 v246, s[20:23], s38 offen offset:0 nt lds
    s_waitcnt lgkmcnt(3)
    v_mfma_f32_16x16x32_bf16 v[136:139], v[188:191], v[92:95], v[136:139]
    ds_read_b128 v[180:183], v227 offset:20480
    v_mfma_f32_16x16x32_bf16 v[128:131], v[188:191], v[76:79], v[128:131]
    s_cmp_lg_u64 s[42:43], 0
    s_cbranch_scc1 L_stublag0
L_retlag0:
    s_waitcnt lgkmcnt(3)
    v_mfma_f32_16x16x32_bf16 v[132:135], v[192:195], v[64:67], 0
    ds_read_b64_tr_b16 v[184:185], v228 offset:8192
    v_mfma_f32_16x16x32_bf16 v[140:143], v[192:195], v[80:83], 0
    ds_read_b64_tr_b16 v[186:187], v228 offset:12288
    s_add_u32 m0, s58, 0x400
    s_nop 0
    buffer_load_dwordx4 v241, s[12:15], s30 offen offset:0 nt lds
    s_waitcnt lgkmcnt(4)
    v_mfma_f32_16x16x32_bf16 v[140:143], v[196:199], v[84:87], v[140:143]
    ds_read_b64_tr_b16 v[188:189], v229 offset:8192
    v_mfma_f32_16x16x32_bf16 v[132:135], v[196:199], v[68:71], v[132:135]
    ds_read_b64_tr_b16 v[190:191], v229 offset:12288
    s_waitcnt lgkmcnt(5)
    v_mfma_f32_16x16x32_bf16 v[132:135], v[176:179], v[72:75], v[132:135]
    ds_read_b64_tr_b16 v[192:193], v230 offset:8192
    v_mfma_f32_16x16x32_bf16 v[140:143], v[176:179], v[88:91], v[140:143]
    ds_read_b64_tr_b16 v[194:195], v230 offset:12288
    s_waitcnt lgkmcnt(6)
    v_mfma_f32_16x16x32_bf16 v[140:143], v[180:183], v[92:95], v[140:143]
    ds_read_b64_tr_b16 v[176:177], v231 offset:8192
    v_mfma_f32_16x16x32_bf16 v[132:135], v[180:183], v[76:79], v[132:135]
    ds_read_b64_tr_b16 v[178:179], v231 offset:12288
    s_waitcnt lgkmcnt(6)
    v_mfma_f32_16x16x32_bf16 v[0:3], v[184:187], v[160:163], v[0:3]
    ds_read_b64_tr_b16 v[180:181], v232 offset:8192
    v_mfma_f32_16x16x32_bf16 v[32:35], v[184:187], v[164:167], v[32:35]
    ds_read_b64_tr_b16 v[182:183], v232 offset:12288
    s_waitcnt lgkmcnt(6)
    v_mfma_f32_16x16x32_bf16 v[36:39], v[188:191], v[164:167], v[36:39]
    ds_read_b64_tr_b16 v[184:185], v233 offset:8192
    v_mfma_f32_16x16x32_bf16 v[4:7], v[188:191], v[160:163], v[4:7]
    ds_read_b64_tr_b16 v[186:187], v233 offset:12288
    s_waitcnt lgkmcnt(6)
    v_mfma_f32_16x16x32_bf16 v[8:11], v[192:195], v[160:163], v[8:11]
    ds_read_b64_tr_b16 v[196:197], v234 offset:8192
    v_mfma_f32_16x16x32_bf16 v[40:43], v[192:195], v[164:167], v[40:43]
    ds_read_b64_tr_b16 v[198:199], v234 offset:12288
    s_waitcnt lgkmcnt(6)
    v_mfma_f32_16x16x32_bf16 v[44:47], v[176:179], v[164:167], v[44:47]
    ds_read_b64_tr_b16 v[192:193], v235 offset:8192
    v_mfma_f32_16x16x32_bf16 v[12:15], v[176:179], v[160:163], v[12:15]
    ds_read_b64_tr_b16 v[194:195], v235 offset:12288
    s_waitcnt lgkmcnt(6)
    v_mfma_f32_16x16x32_bf16 v[16:19], v[180:183], v[160:163], v[16:19]
    v_mfma_f32_16x16x32_bf16 v[48:51], v[180:183], v[164:167], v[48:51]
    s_waitcnt lgkmcnt(4)
    v_mfma_f32_16x16x32_bf16 v[52:55], v[184:187], v[164:167], v[52:55]
    v_mfma_f32_16x16x32_bf16 v[20:23], v[184:187], v[160:163], v[20:23]
    s_waitcnt lgkmcnt(2)
    v_mfma_f32_16x16x32_bf16 v[24:27], v[196:199], v[160:163], v[24:27]
    v_mfma_f32_16x16x32_bf16 v[56:59], v[196:199], v[164:167], v[56:59]
    s_waitcnt lgkmcnt(0)
    s_waitcnt vmcnt(1)
    s_barrier
    v_mfma_f32_16x16x32_bf16 v[60:63], v[192:195], v[164:167], v[60:63]
    ds_read_b128 v[176:179], v224 offset:24576
    v_mfma_f32_16x16x32_bf16 v[28:31], v[192:195], v[160:163], v[28:31]
    ds_read_b128 v[180:183], v225 offset:24576
    ds_read_b128 v[184:187], v226 offset:24576
    ds_read_b128 v[188:191], v227 offset:24576
    s_setprio 0
.p2align 3
    v_fmamk_f32 v168, v128, 0x3e0293ee, v248
    v_fmamk_f32 v169, v129, 0x3e0293ee, v248
    v_fmamk_f32 v170, v130, 0x3e0293ee, v248
    v_fmamk_f32 v171, v131, 0x3e0293ee, v248
    v_exp_f32 v168, v168
    v_exp_f32 v169, v169
    v_exp_f32 v170, v170
    v_exp_f32 v171, v171
    v_fmamk_f32 v172, v136, 0x3e0293ee, v249
    v_fmamk_f32 v173, v137, 0x3e0293ee, v249
    v_fmamk_f32 v174, v138, 0x3e0293ee, v249
    v_fmamk_f32 v175, v139, 0x3e0293ee, v249
    v_cvt_pk_bf16_f32 v160, v168, v169
    v_cvt_pk_bf16_f32 v161, v170, v171
    v_exp_f32 v172, v172
    v_exp_f32 v173, v173
    v_exp_f32 v174, v174
    v_exp_f32 v175, v175
    v_fmamk_f32 v168, v132, 0x3e0293ee, v248
    v_fmamk_f32 v169, v133, 0x3e0293ee, v248
    v_fmamk_f32 v170, v134, 0x3e0293ee, v248
    v_fmamk_f32 v171, v135, 0x3e0293ee, v248
    s_setprio 1
    s_nop 0
    v_cvt_pk_bf16_f32 v164, v172, v173
    v_cvt_pk_bf16_f32 v165, v174, v175
    v_exp_f32 v168, v168
    v_exp_f32 v169, v169
    v_exp_f32 v170, v170
    v_exp_f32 v171, v171
    v_fmamk_f32 v172, v140, 0x3e0293ee, v249
    v_fmamk_f32 v173, v141, 0x3e0293ee, v249
    v_fmamk_f32 v174, v142, 0x3e0293ee, v249
    v_fmamk_f32 v175, v143, 0x3e0293ee, v249
    v_cvt_pk_bf16_f32 v162, v168, v169
    v_cvt_pk_bf16_f32 v163, v170, v171
    v_exp_f32 v172, v172
    v_exp_f32 v173, v173
    v_exp_f32 v174, v174
    v_exp_f32 v175, v175
    v_cvt_pk_bf16_f32 v166, v172, v173
    v_cvt_pk_bf16_f32 v167, v174, v175
    s_waitcnt vmcnt(0)
    v_mfma_f32_16x16x32_bf16 v[200:203], v[216:219], v[160:163], v[208:211]
    v_mfma_f32_16x16x32_bf16 v[204:207], v[216:219], v[164:167], v[212:215]
    s_waitcnt lgkmcnt(3)
    v_mfma_f32_16x16x32_bf16 v[144:147], v[176:179], v[64:67], 0
    s_setprio 3
    ds_read_b128 v[192:195], v224 offset:28672
    v_mfma_f32_16x16x32_bf16 v[152:155], v[176:179], v[80:83], 0
    s_add_u32 m0, s37, 0xa000
    s_xor_b32 s38, s36, 0x5000
    buffer_load_dwordx4 v245, s[16:19], s38 offen offset:0 nt lds
    s_add_u32 m0, s37, 0x16000
    s_xor_b32 s38, s36, 0x3000
    buffer_load_dwordx4 v246, s[20:23], s38 offen offset:0 nt lds
    s_waitcnt lgkmcnt(3)
    v_mfma_f32_16x16x32_bf16 v[152:155], v[180:183], v[84:87], v[152:155]
    ds_read_b128 v[196:199], v225 offset:28672
    v_mfma_f32_16x16x32_bf16 v[144:147], v[180:183], v[68:71], v[144:147]
    s_waitcnt lgkmcnt(3)
    v_mfma_f32_16x16x32_bf16 v[144:147], v[184:187], v[72:75], v[144:147]
    ds_read_b128 v[176:179], v226 offset:28672
    v_mfma_f32_16x16x32_bf16 v[152:155], v[184:187], v[88:91], v[152:155]
    v_max_f32_e64 v250, v200, v204
    v_cmp_nle_f32_e64 s[42:43], v250, s40
    s_add_u32 m0, s37, 0xc000
    s_xor_b32 s38, s36, 0x6000
    buffer_load_dwordx4 v245, s[16:19], s38 offen offset:0 nt lds
    s_waitcnt lgkmcnt(3)
    v_mfma_f32_16x16x32_bf16 v[152:155], v[188:191], v[92:95], v[152:155]
    ds_read_b128 v[180:183], v227 offset:28672
    v_mfma_f32_16x16x32_bf16 v[144:147], v[188:191], v[76:79], v[144:147]
    s_cmp_lg_u64 s[42:43], 0
    s_cbranch_scc1 L_stublag1
L_retlag1:
    s_waitcnt lgkmcnt(3)
    v_mfma_f32_16x16x32_bf16 v[148:151], v[192:195], v[64:67], 0
    ds_read_b64_tr_b16 v[184:185], v228 offset:16384
    v_mfma_f32_16x16x32_bf16 v[156:159], v[192:195], v[80:83], 0
    ds_read_b64_tr_b16 v[186:187], v228 offset:20480
    s_add_u32 m0, s37, 0x18000
    s_xor_b32 s38, s36, 0x4000
    buffer_load_dwordx4 v246, s[20:23], s38 offen offset:0 nt lds
    s_waitcnt lgkmcnt(4)
    v_mfma_f32_16x16x32_bf16 v[156:159], v[196:199], v[84:87], v[156:159]
    ds_read_b64_tr_b16 v[188:189], v229 offset:16384
    v_mfma_f32_16x16x32_bf16 v[148:151], v[196:199], v[68:71], v[148:151]
    ds_read_b64_tr_b16 v[190:191], v229 offset:20480
    s_waitcnt lgkmcnt(5)
    v_mfma_f32_16x16x32_bf16 v[148:151], v[176:179], v[72:75], v[148:151]
    ds_read_b64_tr_b16 v[192:193], v230 offset:16384
    v_mfma_f32_16x16x32_bf16 v[156:159], v[176:179], v[88:91], v[156:159]
    ds_read_b64_tr_b16 v[194:195], v230 offset:20480
    s_waitcnt lgkmcnt(6)
    v_mfma_f32_16x16x32_bf16 v[156:159], v[180:183], v[92:95], v[156:159]
    ds_read_b64_tr_b16 v[176:177], v231 offset:16384
    v_mfma_f32_16x16x32_bf16 v[148:151], v[180:183], v[76:79], v[148:151]
    ds_read_b64_tr_b16 v[178:179], v231 offset:20480
    s_waitcnt lgkmcnt(6)
    v_mfma_f32_16x16x32_bf16 v[0:3], v[184:187], v[160:163], v[0:3]
    ds_read_b64_tr_b16 v[180:181], v232 offset:16384
    v_mfma_f32_16x16x32_bf16 v[32:35], v[184:187], v[164:167], v[32:35]
    ds_read_b64_tr_b16 v[182:183], v232 offset:20480
    s_waitcnt lgkmcnt(6)
    v_mfma_f32_16x16x32_bf16 v[36:39], v[188:191], v[164:167], v[36:39]
    ds_read_b64_tr_b16 v[184:185], v233 offset:16384
    v_mfma_f32_16x16x32_bf16 v[4:7], v[188:191], v[160:163], v[4:7]
    ds_read_b64_tr_b16 v[186:187], v233 offset:20480
    s_waitcnt lgkmcnt(6)
    v_mfma_f32_16x16x32_bf16 v[8:11], v[192:195], v[160:163], v[8:11]
    ds_read_b64_tr_b16 v[196:197], v234 offset:16384
    v_mfma_f32_16x16x32_bf16 v[40:43], v[192:195], v[164:167], v[40:43]
    ds_read_b64_tr_b16 v[198:199], v234 offset:20480
    s_waitcnt lgkmcnt(6)
    v_mfma_f32_16x16x32_bf16 v[44:47], v[176:179], v[164:167], v[44:47]
    ds_read_b64_tr_b16 v[192:193], v235 offset:16384
    v_mfma_f32_16x16x32_bf16 v[12:15], v[176:179], v[160:163], v[12:15]
    ds_read_b64_tr_b16 v[194:195], v235 offset:20480
    s_waitcnt lgkmcnt(6)
    v_mfma_f32_16x16x32_bf16 v[16:19], v[180:183], v[160:163], v[16:19]
    v_mfma_f32_16x16x32_bf16 v[48:51], v[180:183], v[164:167], v[48:51]
    s_waitcnt lgkmcnt(4)
    v_mfma_f32_16x16x32_bf16 v[52:55], v[184:187], v[164:167], v[52:55]
    v_mfma_f32_16x16x32_bf16 v[20:23], v[184:187], v[160:163], v[20:23]
    s_waitcnt lgkmcnt(2)
    v_mfma_f32_16x16x32_bf16 v[24:27], v[196:199], v[160:163], v[24:27]
    v_mfma_f32_16x16x32_bf16 v[56:59], v[196:199], v[164:167], v[56:59]
    s_waitcnt lgkmcnt(0)
    s_waitcnt vmcnt(2)
    s_barrier
    v_mfma_f32_16x16x32_bf16 v[60:63], v[192:195], v[164:167], v[60:63]
    ds_read_b128 v[176:179], v224 offset:32768
    v_mfma_f32_16x16x32_bf16 v[28:31], v[192:195], v[160:163], v[28:31]
    ds_read_b128 v[180:183], v225 offset:32768
    ds_read_b128 v[184:187], v226 offset:32768
    ds_read_b128 v[188:191], v227 offset:32768
    s_setprio 0
.p2align 3
    v_fmamk_f32 v168, v144, 0x3e0293ee, v248
    v_fmamk_f32 v169, v145, 0x3e0293ee, v248
    v_fmamk_f32 v170, v146, 0x3e0293ee, v248
    v_fmamk_f32 v171, v147, 0x3e0293ee, v248
    v_exp_f32 v168, v168
    v_exp_f32 v169, v169
    v_exp_f32 v170, v170
    v_exp_f32 v171, v171
    v_fmamk_f32 v172, v152, 0x3e0293ee, v249
    v_fmamk_f32 v173, v153, 0x3e0293ee, v249
    v_fmamk_f32 v174, v154, 0x3e0293ee, v249
    v_fmamk_f32 v175, v155, 0x3e0293ee, v249
    v_cvt_pk_bf16_f32 v160, v168, v169
    v_cvt_pk_bf16_f32 v161, v170, v171
    v_exp_f32 v172, v172
    v_exp_f32 v173, v173
    v_exp_f32 v174, v174
    v_exp_f32 v175, v175
    v_fmamk_f32 v168, v148, 0x3e0293ee, v248
    v_fmamk_f32 v169, v149, 0x3e0293ee, v248
    v_fmamk_f32 v170, v150, 0x3e0293ee, v248
    v_fmamk_f32 v171, v151, 0x3e0293ee, v248
    s_setprio 1
    s_nop 0
    v_cvt_pk_bf16_f32 v164, v172, v173
    v_cvt_pk_bf16_f32 v165, v174, v175
    v_exp_f32 v168, v168
    v_exp_f32 v169, v169
    v_exp_f32 v170, v170
    v_exp_f32 v171, v171
    v_fmamk_f32 v172, v156, 0x3e0293ee, v249
    v_fmamk_f32 v173, v157, 0x3e0293ee, v249
    v_fmamk_f32 v174, v158, 0x3e0293ee, v249
    v_fmamk_f32 v175, v159, 0x3e0293ee, v249
    v_cvt_pk_bf16_f32 v162, v168, v169
    v_cvt_pk_bf16_f32 v163, v170, v171
    v_exp_f32 v172, v172
    v_exp_f32 v173, v173
    v_exp_f32 v174, v174
    v_exp_f32 v175, v175
    v_cvt_pk_bf16_f32 v166, v172, v173
    v_cvt_pk_bf16_f32 v167, v174, v175
    s_waitcnt vmcnt(0)
    v_mfma_f32_16x16x32_bf16 v[208:211], v[216:219], v[160:163], v[200:203]
    v_mfma_f32_16x16x32_bf16 v[212:215], v[216:219], v[164:167], v[204:207]
    s_waitcnt lgkmcnt(3)
    v_mfma_f32_16x16x32_bf16 v[128:131], v[176:179], v[64:67], 0
    s_setprio 3
    ds_read_b128 v[192:195], v224 offset:36864
    v_mfma_f32_16x16x32_bf16 v[136:139], v[176:179], v[80:83], 0
    s_add_u32 m0, s58, 0x800
    s_nop 0
    buffer_load_dwordx4 v242, s[12:15], s30 offen offset:0 nt lds
    s_add_u32 m0, s58, 0xc00
    s_nop 0
    buffer_load_dwordx4 v243, s[12:15], s30 offen offset:0 nt lds
    s_waitcnt lgkmcnt(3)
    v_mfma_f32_16x16x32_bf16 v[136:139], v[180:183], v[84:87], v[136:139]
    ds_read_b128 v[196:199], v225 offset:36864
    v_mfma_f32_16x16x32_bf16 v[128:131], v[180:183], v[68:71], v[128:131]
    s_waitcnt lgkmcnt(3)
    v_mfma_f32_16x16x32_bf16 v[128:131], v[184:187], v[72:75], v[128:131]
    ds_read_b128 v[176:179], v226 offset:36864
    v_mfma_f32_16x16x32_bf16 v[136:139], v[184:187], v[88:91], v[136:139]
    v_max_f32_e64 v250, v208, v212
    v_cmp_nle_f32_e64 s[42:43], v250, s40
    s_add_u32 m0, s37, 0xe000
    s_xor_b32 s38, s36, 0x7000
    buffer_load_dwordx4 v245, s[16:19], s38 offen offset:0 nt lds
    s_waitcnt lgkmcnt(3)
    v_mfma_f32_16x16x32_bf16 v[136:139], v[188:191], v[92:95], v[136:139]
    ds_read_b128 v[180:183], v227 offset:36864
    v_mfma_f32_16x16x32_bf16 v[128:131], v[188:191], v[76:79], v[128:131]
    s_cmp_lg_u64 s[42:43], 0
    s_cbranch_scc1 L_stublag2
L_retlag2:
    s_waitcnt lgkmcnt(3)
    v_mfma_f32_16x16x32_bf16 v[132:135], v[192:195], v[64:67], 0
    ds_read_b64_tr_b16 v[184:185], v228 offset:24576
    v_mfma_f32_16x16x32_bf16 v[140:143], v[192:195], v[80:83], 0
    ds_read_b64_tr_b16 v[186:187], v228 offset:28672
    s_add_u32 m0, s37, 0x1a000
    s_xor_b32 s38, s36, 0x5000
    buffer_load_dwordx4 v246, s[20:23], s38 offen offset:0 nt lds
    s_waitcnt lgkmcnt(4)
    v_mfma_f32_16x16x32_bf16 v[140:143], v[196:199], v[84:87], v[140:143]
    ds_read_b64_tr_b16 v[188:189], v229 offset:24576
    v_mfma_f32_16x16x32_bf16 v[132:135], v[196:199], v[68:71], v[132:135]
    ds_read_b64_tr_b16 v[190:191], v229 offset:28672
    s_waitcnt lgkmcnt(5)
    v_mfma_f32_16x16x32_bf16 v[132:135], v[176:179], v[72:75], v[132:135]
    ds_read_b64_tr_b16 v[192:193], v230 offset:24576
    v_mfma_f32_16x16x32_bf16 v[140:143], v[176:179], v[88:91], v[140:143]
    ds_read_b64_tr_b16 v[194:195], v230 offset:28672
    s_waitcnt lgkmcnt(6)
    v_mfma_f32_16x16x32_bf16 v[140:143], v[180:183], v[92:95], v[140:143]
    ds_read_b64_tr_b16 v[176:177], v231 offset:24576
    v_mfma_f32_16x16x32_bf16 v[132:135], v[180:183], v[76:79], v[132:135]
    ds_read_b64_tr_b16 v[178:179], v231 offset:28672
    s_waitcnt lgkmcnt(6)
    v_mfma_f32_16x16x32_bf16 v[0:3], v[184:187], v[160:163], v[0:3]
    ds_read_b64_tr_b16 v[180:181], v232 offset:24576
    v_mfma_f32_16x16x32_bf16 v[32:35], v[184:187], v[164:167], v[32:35]
    ds_read_b64_tr_b16 v[182:183], v232 offset:28672
    s_waitcnt lgkmcnt(6)
    v_mfma_f32_16x16x32_bf16 v[36:39], v[188:191], v[164:167], v[36:39]
    ds_read_b64_tr_b16 v[184:185], v233 offset:24576
    v_mfma_f32_16x16x32_bf16 v[4:7], v[188:191], v[160:163], v[4:7]
    ds_read_b64_tr_b16 v[186:187], v233 offset:28672
    s_waitcnt lgkmcnt(6)
    v_mfma_f32_16x16x32_bf16 v[8:11], v[192:195], v[160:163], v[8:11]
    ds_read_b64_tr_b16 v[196:197], v234 offset:24576
    v_mfma_f32_16x16x32_bf16 v[40:43], v[192:195], v[164:167], v[40:43]
    ds_read_b64_tr_b16 v[198:199], v234 offset:28672
    s_waitcnt lgkmcnt(6)
    v_mfma_f32_16x16x32_bf16 v[44:47], v[176:179], v[164:167], v[44:47]
    ds_read_b64_tr_b16 v[192:193], v235 offset:24576
    v_mfma_f32_16x16x32_bf16 v[12:15], v[176:179], v[160:163], v[12:15]
    ds_read_b64_tr_b16 v[194:195], v235 offset:28672
    s_waitcnt lgkmcnt(6)
    v_mfma_f32_16x16x32_bf16 v[16:19], v[180:183], v[160:163], v[16:19]
    v_mfma_f32_16x16x32_bf16 v[48:51], v[180:183], v[164:167], v[48:51]
    s_waitcnt lgkmcnt(4)
    v_mfma_f32_16x16x32_bf16 v[52:55], v[184:187], v[164:167], v[52:55]
    v_mfma_f32_16x16x32_bf16 v[20:23], v[184:187], v[160:163], v[20:23]
    s_waitcnt lgkmcnt(2)
    v_mfma_f32_16x16x32_bf16 v[24:27], v[196:199], v[160:163], v[24:27]
    v_mfma_f32_16x16x32_bf16 v[56:59], v[196:199], v[164:167], v[56:59]
    s_waitcnt lgkmcnt(0)
    s_waitcnt vmcnt(4)
    s_barrier
    v_mfma_f32_16x16x32_bf16 v[60:63], v[192:195], v[164:167], v[60:63]
    ds_read_b128 v[176:179], v224 offset:40960
    v_mfma_f32_16x16x32_bf16 v[28:31], v[192:195], v[160:163], v[28:31]
    ds_read_b128 v[180:183], v225 offset:40960
    ds_read_b128 v[184:187], v226 offset:40960
    ds_read_b128 v[188:191], v227 offset:40960
    s_setprio 0
.p2align 3
    v_fmamk_f32 v168, v128, 0x3e0293ee, v248
    v_fmamk_f32 v169, v129, 0x3e0293ee, v248
    v_fmamk_f32 v170, v130, 0x3e0293ee, v248
    v_fmamk_f32 v171, v131, 0x3e0293ee, v248
    v_exp_f32 v168, v168
    v_exp_f32 v169, v169
    v_exp_f32 v170, v170
    v_exp_f32 v171, v171
    v_fmamk_f32 v172, v136, 0x3e0293ee, v249
    v_fmamk_f32 v173, v137, 0x3e0293ee, v249
    v_fmamk_f32 v174, v138, 0x3e0293ee, v249
    v_fmamk_f32 v175, v139, 0x3e0293ee, v249
    v_cvt_pk_bf16_f32 v160, v168, v169
    v_cvt_pk_bf16_f32 v161, v170, v171
    v_exp_f32 v172, v172
    v_exp_f32 v173, v173
    v_exp_f32 v174, v174
    v_exp_f32 v175, v175
    v_fmamk_f32 v168, v132, 0x3e0293ee, v248
    v_fmamk_f32 v169, v133, 0x3e0293ee, v248
    v_fmamk_f32 v170, v134, 0x3e0293ee, v248
    v_fmamk_f32 v171, v135, 0x3e0293ee, v248
    s_setprio 1
    s_nop 0
    v_cvt_pk_bf16_f32 v164, v172, v173
    v_cvt_pk_bf16_f32 v165, v174, v175
    v_exp_f32 v168, v168
    v_exp_f32 v169, v169
    v_exp_f32 v170, v170
    v_exp_f32 v171, v171
    v_fmamk_f32 v172, v140, 0x3e0293ee, v249
    v_fmamk_f32 v173, v141, 0x3e0293ee, v249
    v_fmamk_f32 v174, v142, 0x3e0293ee, v249
    v_fmamk_f32 v175, v143, 0x3e0293ee, v249
    v_cvt_pk_bf16_f32 v162, v168, v169
    v_cvt_pk_bf16_f32 v163, v170, v171
    s_waitcnt vmcnt(2)
    s_nop 0
    ds_read_b128 v[96:99], v236 offset:0
    ds_read_b128 v[100:103], v237 offset:0
    ds_read_b128 v[104:107], v238 offset:0
    ds_read_b128 v[108:111], v239 offset:0
    v_exp_f32 v172, v172
    v_exp_f32 v173, v173
    v_exp_f32 v174, v174
    v_exp_f32 v175, v175
    v_cvt_pk_bf16_f32 v166, v172, v173
    v_cvt_pk_bf16_f32 v167, v174, v175
    s_waitcnt vmcnt(0)
    v_mfma_f32_16x16x32_bf16 v[200:203], v[216:219], v[160:163], v[208:211]
    v_mfma_f32_16x16x32_bf16 v[204:207], v[216:219], v[164:167], v[212:215]
    s_waitcnt lgkmcnt(7)
    v_mfma_f32_16x16x32_bf16 v[144:147], v[176:179], v[64:67], 0
    s_setprio 3
    ds_read_b128 v[192:195], v224 offset:45056
    v_mfma_f32_16x16x32_bf16 v[152:155], v[176:179], v[80:83], 0
    s_waitcnt lgkmcnt(7)
    v_mfma_f32_16x16x32_bf16 v[152:155], v[180:183], v[84:87], v[152:155]
    ds_read_b128 v[196:199], v225 offset:45056
    v_mfma_f32_16x16x32_bf16 v[144:147], v[180:183], v[68:71], v[144:147]
    s_waitcnt lgkmcnt(7)
    v_mfma_f32_16x16x32_bf16 v[144:147], v[184:187], v[72:75], v[144:147]
    ds_read_b128 v[176:179], v226 offset:45056
    v_mfma_f32_16x16x32_bf16 v[152:155], v[184:187], v[88:91], v[152:155]
    v_max_f32_e64 v250, v200, v204
    v_cmp_nle_f32_e64 s[42:43], v250, s40
    s_waitcnt lgkmcnt(3)
    s_add_u32 m0, s58, 0x0
    s_nop 0
    buffer_load_dwordx4 v240, s[12:15], s31 offen offset:0 nt lds
    v_mfma_f32_16x16x32_bf16 v[152:155], v[188:191], v[92:95], v[152:155]
    ds_read_b128 v[180:183], v227 offset:45056
    v_mfma_f32_16x16x32_bf16 v[144:147], v[188:191], v[76:79], v[144:147]
    s_cmp_lg_u64 s[42:43], 0
    s_cbranch_scc1 L_stublag3
L_retlag3:
    s_waitcnt lgkmcnt(3)
    v_mfma_f32_16x16x32_bf16 v[148:151], v[192:195], v[64:67], 0
    ds_read_b64_tr_b16 v[184:185], v228 offset:32768
    v_mfma_f32_16x16x32_bf16 v[156:159], v[192:195], v[80:83], 0
    ds_read_b64_tr_b16 v[186:187], v228 offset:36864
    s_add_u32 m0, s37, 0x1c000
    s_xor_b32 s38, s36, 0x6000
    buffer_load_dwordx4 v246, s[20:23], s38 offen offset:0 nt lds
    s_waitcnt lgkmcnt(4)
    v_mfma_f32_16x16x32_bf16 v[156:159], v[196:199], v[84:87], v[156:159]
    ds_read_b64_tr_b16 v[188:189], v229 offset:32768
    v_mfma_f32_16x16x32_bf16 v[148:151], v[196:199], v[68:71], v[148:151]
    ds_read_b64_tr_b16 v[190:191], v229 offset:36864
    s_waitcnt lgkmcnt(5)
    v_mfma_f32_16x16x32_bf16 v[148:151], v[176:179], v[72:75], v[148:151]
    ds_read_b64_tr_b16 v[192:193], v230 offset:32768
    v_mfma_f32_16x16x32_bf16 v[156:159], v[176:179], v[88:91], v[156:159]
    ds_read_b64_tr_b16 v[194:195], v230 offset:36864
    s_waitcnt lgkmcnt(6)
    v_mfma_f32_16x16x32_bf16 v[156:159], v[180:183], v[92:95], v[156:159]
    ds_read_b64_tr_b16 v[176:177], v231 offset:32768
    v_mfma_f32_16x16x32_bf16 v[148:151], v[180:183], v[76:79], v[148:151]
    ds_read_b64_tr_b16 v[178:179], v231 offset:36864
    s_waitcnt lgkmcnt(6)
    v_mfma_f32_16x16x32_bf16 v[0:3], v[184:187], v[160:163], v[0:3]
    ds_read_b64_tr_b16 v[180:181], v232 offset:32768
    v_mfma_f32_16x16x32_bf16 v[32:35], v[184:187], v[164:167], v[32:35]
    ds_read_b64_tr_b16 v[182:183], v232 offset:36864
    s_waitcnt lgkmcnt(6)
    v_mfma_f32_16x16x32_bf16 v[36:39], v[188:191], v[164:167], v[36:39]
    ds_read_b64_tr_b16 v[184:185], v233 offset:32768
    v_mfma_f32_16x16x32_bf16 v[4:7], v[188:191], v[160:163], v[4:7]
    ds_read_b64_tr_b16 v[186:187], v233 offset:36864
    s_waitcnt lgkmcnt(6)
    v_mfma_f32_16x16x32_bf16 v[8:11], v[192:195], v[160:163], v[8:11]
    ds_read_b64_tr_b16 v[196:197], v234 offset:32768
    v_mfma_f32_16x16x32_bf16 v[40:43], v[192:195], v[164:167], v[40:43]
    ds_read_b64_tr_b16 v[198:199], v234 offset:36864
    s_waitcnt lgkmcnt(6)
    v_mfma_f32_16x16x32_bf16 v[44:47], v[176:179], v[164:167], v[44:47]
    ds_read_b64_tr_b16 v[192:193], v235 offset:32768
    v_mfma_f32_16x16x32_bf16 v[12:15], v[176:179], v[160:163], v[12:15]
    ds_read_b64_tr_b16 v[194:195], v235 offset:36864
    s_waitcnt lgkmcnt(6)
    v_mfma_f32_16x16x32_bf16 v[16:19], v[180:183], v[160:163], v[16:19]
    v_mfma_f32_16x16x32_bf16 v[48:51], v[180:183], v[164:167], v[48:51]
    s_waitcnt lgkmcnt(4)
    v_mfma_f32_16x16x32_bf16 v[52:55], v[184:187], v[164:167], v[52:55]
    v_mfma_f32_16x16x32_bf16 v[20:23], v[184:187], v[160:163], v[20:23]
    s_waitcnt lgkmcnt(2)
    v_mfma_f32_16x16x32_bf16 v[24:27], v[196:199], v[160:163], v[24:27]
    v_mfma_f32_16x16x32_bf16 v[56:59], v[196:199], v[164:167], v[56:59]
    s_waitcnt lgkmcnt(0)
    s_waitcnt vmcnt(2)
    s_barrier
    v_mfma_f32_16x16x32_bf16 v[60:63], v[192:195], v[164:167], v[60:63]
    ds_read_b128 v[176:179], v224 offset:49152
    v_mfma_f32_16x16x32_bf16 v[28:31], v[192:195], v[160:163], v[28:31]
    ds_read_b128 v[180:183], v225 offset:49152
    ds_read_b128 v[184:187], v226 offset:49152
    ds_read_b128 v[188:191], v227 offset:49152
    s_setprio 0
.p2align 3
    v_fmamk_f32 v168, v144, 0x3e0293ee, v248
    v_fmamk_f32 v169, v145, 0x3e0293ee, v248
    v_fmamk_f32 v170, v146, 0x3e0293ee, v248
    v_fmamk_f32 v171, v147, 0x3e0293ee, v248
    v_exp_f32 v168, v168
    v_exp_f32 v169, v169
    v_exp_f32 v170, v170
    v_exp_f32 v171, v171
    v_fmamk_f32 v172, v152, 0x3e0293ee, v249
    v_fmamk_f32 v173, v153, 0x3e0293ee, v249
    v_fmamk_f32 v174, v154, 0x3e0293ee, v249
    v_fmamk_f32 v175, v155, 0x3e0293ee, v249
    v_cvt_pk_bf16_f32 v160, v168, v169
    v_cvt_pk_bf16_f32 v161, v170, v171
    v_exp_f32 v172, v172
    v_exp_f32 v173, v173
    v_exp_f32 v174, v174
    v_exp_f32 v175, v175
    v_fmamk_f32 v168, v148, 0x3e0293ee, v248
    v_fmamk_f32 v169, v149, 0x3e0293ee, v248
    v_fmamk_f32 v170, v150, 0x3e0293ee, v248
    v_fmamk_f32 v171, v151, 0x3e0293ee, v248
    s_setprio 1
    s_nop 0
    v_cvt_pk_bf16_f32 v164, v172, v173
    v_cvt_pk_bf16_f32 v165, v174, v175
    v_exp_f32 v168, v168
    v_exp_f32 v169, v169
    v_exp_f32 v170, v170
    v_exp_f32 v171, v171
    v_fmamk_f32 v172, v156, 0x3e0293ee, v249
    v_fmamk_f32 v173, v157, 0x3e0293ee, v249
    v_fmamk_f32 v174, v158, 0x3e0293ee, v249
    v_fmamk_f32 v175, v159, 0x3e0293ee, v249
    v_cvt_pk_bf16_f32 v162, v168, v169
    v_cvt_pk_bf16_f32 v163, v170, v171
    v_exp_f32 v172, v172
    v_exp_f32 v173, v173
    v_exp_f32 v174, v174
    v_exp_f32 v175, v175
    v_cvt_pk_bf16_f32 v166, v172, v173
    v_cvt_pk_bf16_f32 v167, v174, v175
    s_waitcnt vmcnt(0)
    v_mfma_f32_16x16x32_bf16 v[208:211], v[216:219], v[160:163], v[200:203]
    v_mfma_f32_16x16x32_bf16 v[212:215], v[216:219], v[164:167], v[204:207]
    s_waitcnt lgkmcnt(3)
    v_mfma_f32_16x16x32_bf16 v[128:131], v[176:179], v[64:67], 0
    s_setprio 3
    ds_read_b128 v[192:195], v224 offset:53248
    v_mfma_f32_16x16x32_bf16 v[136:139], v[176:179], v[80:83], 0
    s_add_u32 m0, s58, 0x400
    s_nop 0
    buffer_load_dwordx4 v241, s[12:15], s31 offen offset:0 nt lds
    s_waitcnt lgkmcnt(3)
    v_mfma_f32_16x16x32_bf16 v[136:139], v[180:183], v[84:87], v[136:139]
    ds_read_b128 v[196:199], v225 offset:53248
    v_mfma_f32_16x16x32_bf16 v[128:131], v[180:183], v[68:71], v[128:131]
    s_waitcnt lgkmcnt(3)
    v_mfma_f32_16x16x32_bf16 v[128:131], v[184:187], v[72:75], v[128:131]
    ds_read_b128 v[176:179], v226 offset:53248
    v_mfma_f32_16x16x32_bf16 v[136:139], v[184:187], v[88:91], v[136:139]
    v_max_f32_e64 v250, v208, v212
    v_cmp_nle_f32_e64 s[42:43], v250, s40
    s_add_u32 m0, s58, 0x800
    s_nop 0
    buffer_load_dwordx4 v242, s[12:15], s31 offen offset:0 nt lds
    s_waitcnt lgkmcnt(3)
    v_mfma_f32_16x16x32_bf16 v[136:139], v[188:191], v[92:95], v[136:139]
    ds_read_b128 v[180:183], v227 offset:53248
    v_mfma_f32_16x16x32_bf16 v[128:131], v[188:191], v[76:79], v[128:131]
    s_cmp_lg_u64 s[42:43], 0
    s_cbranch_scc1 L_stublag4
L_retlag4:
    s_waitcnt lgkmcnt(3)
    v_mfma_f32_16x16x32_bf16 v[132:135], v[192:195], v[64:67], 0
    ds_read_b64_tr_b16 v[184:185], v228 offset:40960
    v_mfma_f32_16x16x32_bf16 v[140:143], v[192:195], v[80:83], 0
    ds_read_b64_tr_b16 v[186:187], v228 offset:45056
    s_add_u32 m0, s37, 0x1e000
    s_xor_b32 s38, s36, 0x7000
    buffer_load_dwordx4 v246, s[20:23], s38 offen offset:0 nt lds
    s_waitcnt lgkmcnt(4)
    v_mfma_f32_16x16x32_bf16 v[140:143], v[196:199], v[84:87], v[140:143]
    ds_read_b64_tr_b16 v[188:189], v229 offset:40960
    v_mfma_f32_16x16x32_bf16 v[132:135], v[196:199], v[68:71], v[132:135]
    ds_read_b64_tr_b16 v[190:191], v229 offset:45056
    s_waitcnt lgkmcnt(5)
    v_mfma_f32_16x16x32_bf16 v[132:135], v[176:179], v[72:75], v[132:135]
    ds_read_b64_tr_b16 v[192:193], v230 offset:40960
    v_mfma_f32_16x16x32_bf16 v[140:143], v[176:179], v[88:91], v[140:143]
    ds_read_b64_tr_b16 v[194:195], v230 offset:45056
    s_waitcnt lgkmcnt(6)
    v_mfma_f32_16x16x32_bf16 v[140:143], v[180:183], v[92:95], v[140:143]
    ds_read_b64_tr_b16 v[176:177], v231 offset:40960
    v_mfma_f32_16x16x32_bf16 v[132:135], v[180:183], v[76:79], v[132:135]
    ds_read_b64_tr_b16 v[178:179], v231 offset:45056
    s_waitcnt lgkmcnt(6)
    v_mfma_f32_16x16x32_bf16 v[0:3], v[184:187], v[160:163], v[0:3]
    ds_read_b64_tr_b16 v[180:181], v232 offset:40960
    v_mfma_f32_16x16x32_bf16 v[32:35], v[184:187], v[164:167], v[32:35]
    ds_read_b64_tr_b16 v[182:183], v232 offset:45056
    s_waitcnt lgkmcnt(6)
    v_mfma_f32_16x16x32_bf16 v[36:39], v[188:191], v[164:167], v[36:39]
    ds_read_b64_tr_b16 v[184:185], v233 offset:40960
    v_mfma_f32_16x16x32_bf16 v[4:7], v[188:191], v[160:163], v[4:7]
    ds_read_b64_tr_b16 v[186:187], v233 offset:45056
    s_waitcnt lgkmcnt(6)
    v_mfma_f32_16x16x32_bf16 v[8:11], v[192:195], v[160:163], v[8:11]
    ds_read_b64_tr_b16 v[196:197], v234 offset:40960
    v_mfma_f32_16x16x32_bf16 v[40:43], v[192:195], v[164:167], v[40:43]
    ds_read_b64_tr_b16 v[198:199], v234 offset:45056
    s_waitcnt lgkmcnt(6)
    v_mfma_f32_16x16x32_bf16 v[44:47], v[176:179], v[164:167], v[44:47]
    ds_read_b64_tr_b16 v[192:193], v235 offset:40960
    v_mfma_f32_16x16x32_bf16 v[12:15], v[176:179], v[160:163], v[12:15]
    ds_read_b64_tr_b16 v[194:195], v235 offset:45056
    s_waitcnt lgkmcnt(6)
    v_mfma_f32_16x16x32_bf16 v[16:19], v[180:183], v[160:163], v[16:19]
    v_mfma_f32_16x16x32_bf16 v[48:51], v[180:183], v[164:167], v[48:51]
    s_waitcnt lgkmcnt(4)
    v_mfma_f32_16x16x32_bf16 v[52:55], v[184:187], v[164:167], v[52:55]
    v_mfma_f32_16x16x32_bf16 v[20:23], v[184:187], v[160:163], v[20:23]
    s_waitcnt lgkmcnt(2)
    v_mfma_f32_16x16x32_bf16 v[24:27], v[196:199], v[160:163], v[24:27]
    v_mfma_f32_16x16x32_bf16 v[56:59], v[196:199], v[164:167], v[56:59]
    s_waitcnt lgkmcnt(0)
    s_waitcnt vmcnt(3)
    s_barrier
    v_mfma_f32_16x16x32_bf16 v[60:63], v[192:195], v[164:167], v[60:63]
    ds_read_b128 v[176:179], v224 offset:57344
    v_mfma_f32_16x16x32_bf16 v[28:31], v[192:195], v[160:163], v[28:31]
    ds_read_b128 v[180:183], v225 offset:57344
    ds_read_b128 v[184:187], v226 offset:57344
    ds_read_b128 v[188:191], v227 offset:57344
    s_setprio 0
.p2align 3
    v_fmamk_f32 v168, v128, 0x3e0293ee, v248
    v_fmamk_f32 v169, v129, 0x3e0293ee, v248
    v_fmamk_f32 v170, v130, 0x3e0293ee, v248
    v_fmamk_f32 v171, v131, 0x3e0293ee, v248
    v_exp_f32 v168, v168
    v_exp_f32 v169, v169
    v_exp_f32 v170, v170
    v_exp_f32 v171, v171
    v_fmamk_f32 v172, v136, 0x3e0293ee, v249
    v_fmamk_f32 v173, v137, 0x3e0293ee, v249
    v_fmamk_f32 v174, v138, 0x3e0293ee, v249
    v_fmamk_f32 v175, v139, 0x3e0293ee, v249
    v_cvt_pk_bf16_f32 v160, v168, v169
    v_cvt_pk_bf16_f32 v161, v170, v171
    v_exp_f32 v172, v172
    v_exp_f32 v173, v173
    v_exp_f32 v174, v174
    v_exp_f32 v175, v175
    v_fmamk_f32 v168, v132, 0x3e0293ee, v248
    v_fmamk_f32 v169, v133, 0x3e0293ee, v248
    v_fmamk_f32 v170, v134, 0x3e0293ee, v248
    v_fmamk_f32 v171, v135, 0x3e0293ee, v248
    s_setprio 1
    s_nop 0
    v_cvt_pk_bf16_f32 v164, v172, v173
    v_cvt_pk_bf16_f32 v165, v174, v175
    v_exp_f32 v168, v168
    v_exp_f32 v169, v169
    v_exp_f32 v170, v170
    v_exp_f32 v171, v171
    v_fmamk_f32 v172, v140, 0x3e0293ee, v249
    v_fmamk_f32 v173, v141, 0x3e0293ee, v249
    v_fmamk_f32 v174, v142, 0x3e0293ee, v249
    v_fmamk_f32 v175, v143, 0x3e0293ee, v249
    v_cvt_pk_bf16_f32 v162, v168, v169
    v_cvt_pk_bf16_f32 v163, v170, v171
    v_exp_f32 v172, v172
    v_exp_f32 v173, v173
    v_exp_f32 v174, v174
    v_exp_f32 v175, v175
    v_cvt_pk_bf16_f32 v166, v172, v173
    v_cvt_pk_bf16_f32 v167, v174, v175
    s_waitcnt vmcnt(0)
    v_mfma_f32_16x16x32_bf16 v[200:203], v[216:219], v[160:163], v[208:211]
    v_mfma_f32_16x16x32_bf16 v[204:207], v[216:219], v[164:167], v[212:215]
    s_waitcnt lgkmcnt(3)
    v_mfma_f32_16x16x32_bf16 v[144:147], v[176:179], v[64:67], 0
    s_setprio 3
    ds_read_b128 v[192:195], v224 offset:61440
    v_mfma_f32_16x16x32_bf16 v[152:155], v[176:179], v[80:83], 0
    s_waitcnt lgkmcnt(3)
    v_mfma_f32_16x16x32_bf16 v[152:155], v[180:183], v[84:87], v[152:155]
    ds_read_b128 v[196:199], v225 offset:61440
    v_mfma_f32_16x16x32_bf16 v[144:147], v[180:183], v[68:71], v[144:147]
    s_waitcnt lgkmcnt(3)
    v_mfma_f32_16x16x32_bf16 v[144:147], v[184:187], v[72:75], v[144:147]
    ds_read_b128 v[176:179], v226 offset:61440
    v_mfma_f32_16x16x32_bf16 v[152:155], v[184:187], v[88:91], v[152:155]
    v_max_f32_e64 v250, v200, v204
    v_cmp_nle_f32_e64 s[42:43], v250, s40
    s_waitcnt lgkmcnt(3)
    v_mfma_f32_16x16x32_bf16 v[152:155], v[188:191], v[92:95], v[152:155]
    ds_read_b128 v[180:183], v227 offset:61440
    v_mfma_f32_16x16x32_bf16 v[144:147], v[188:191], v[76:79], v[144:147]
    s_cmp_lg_u64 s[42:43], 0
    s_cbranch_scc1 L_stublag5
L_retlag5:
    s_waitcnt lgkmcnt(3)
    v_mfma_f32_16x16x32_bf16 v[148:151], v[192:195], v[64:67], 0
    ds_read_b64_tr_b16 v[184:185], v228 offset:49152
    v_mfma_f32_16x16x32_bf16 v[156:159], v[192:195], v[80:83], 0
    ds_read_b64_tr_b16 v[186:187], v228 offset:53248
    s_add_u32 m0, s58, 0xc00
    s_nop 0
    buffer_load_dwordx4 v243, s[12:15], s31 offen offset:0 nt lds
    s_waitcnt lgkmcnt(4)
    v_mfma_f32_16x16x32_bf16 v[156:159], v[196:199], v[84:87], v[156:159]
    ds_read_b64_tr_b16 v[188:189], v229 offset:49152
    v_mfma_f32_16x16x32_bf16 v[148:151], v[196:199], v[68:71], v[148:151]
    ds_read_b64_tr_b16 v[190:191], v229 offset:53248
    s_waitcnt lgkmcnt(5)
    v_mfma_f32_16x16x32_bf16 v[148:151], v[176:179], v[72:75], v[148:151]
    ds_read_b64_tr_b16 v[192:193], v230 offset:49152
    v_mfma_f32_16x16x32_bf16 v[156:159], v[176:179], v[88:91], v[156:159]
    ds_read_b64_tr_b16 v[194:195], v230 offset:53248
    s_waitcnt lgkmcnt(6)
    v_mfma_f32_16x16x32_bf16 v[156:159], v[180:183], v[92:95], v[156:159]
    ds_read_b64_tr_b16 v[176:177], v231 offset:49152
    v_mfma_f32_16x16x32_bf16 v[148:151], v[180:183], v[76:79], v[148:151]
    ds_read_b64_tr_b16 v[178:179], v231 offset:53248
    s_waitcnt lgkmcnt(6)
    v_mfma_f32_16x16x32_bf16 v[0:3], v[184:187], v[160:163], v[0:3]
    ds_read_b64_tr_b16 v[180:181], v232 offset:49152
    v_mfma_f32_16x16x32_bf16 v[32:35], v[184:187], v[164:167], v[32:35]
    ds_read_b64_tr_b16 v[182:183], v232 offset:53248
    s_waitcnt lgkmcnt(6)
    v_mfma_f32_16x16x32_bf16 v[36:39], v[188:191], v[164:167], v[36:39]
    ds_read_b64_tr_b16 v[184:185], v233 offset:49152
    v_mfma_f32_16x16x32_bf16 v[4:7], v[188:191], v[160:163], v[4:7]
    ds_read_b64_tr_b16 v[186:187], v233 offset:53248
    s_waitcnt lgkmcnt(6)
    v_mfma_f32_16x16x32_bf16 v[8:11], v[192:195], v[160:163], v[8:11]
    ds_read_b64_tr_b16 v[196:197], v234 offset:49152
    v_mfma_f32_16x16x32_bf16 v[40:43], v[192:195], v[164:167], v[40:43]
    ds_read_b64_tr_b16 v[198:199], v234 offset:53248
    s_waitcnt lgkmcnt(6)
    v_mfma_f32_16x16x32_bf16 v[44:47], v[176:179], v[164:167], v[44:47]
    ds_read_b64_tr_b16 v[192:193], v235 offset:49152
    v_mfma_f32_16x16x32_bf16 v[12:15], v[176:179], v[160:163], v[12:15]
    ds_read_b64_tr_b16 v[194:195], v235 offset:53248
    s_waitcnt lgkmcnt(6)
    v_mfma_f32_16x16x32_bf16 v[16:19], v[180:183], v[160:163], v[16:19]
    v_mfma_f32_16x16x32_bf16 v[48:51], v[180:183], v[164:167], v[48:51]
    s_waitcnt lgkmcnt(4)
    v_mfma_f32_16x16x32_bf16 v[52:55], v[184:187], v[164:167], v[52:55]
    v_mfma_f32_16x16x32_bf16 v[20:23], v[184:187], v[160:163], v[20:23]
    s_waitcnt lgkmcnt(2)
    v_mfma_f32_16x16x32_bf16 v[24:27], v[196:199], v[160:163], v[24:27]
    v_mfma_f32_16x16x32_bf16 v[56:59], v[196:199], v[164:167], v[56:59]
    s_waitcnt lgkmcnt(0)
    s_waitcnt vmcnt(1)
    s_barrier
    v_mfma_f32_16x16x32_bf16 v[60:63], v[192:195], v[164:167], v[60:63]
    ds_read_b128 v[176:179], v224 offset:0
    v_mfma_f32_16x16x32_bf16 v[28:31], v[192:195], v[160:163], v[28:31]
    ds_read_b128 v[180:183], v225 offset:0
    ds_read_b128 v[184:187], v226 offset:0
    ds_read_b128 v[188:191], v227 offset:0
    s_setprio 0
.p2align 3
    v_fmamk_f32 v168, v144, 0x3e0293ee, v248
    v_fmamk_f32 v169, v145, 0x3e0293ee, v248
    v_fmamk_f32 v170, v146, 0x3e0293ee, v248
    v_fmamk_f32 v171, v147, 0x3e0293ee, v248
    v_exp_f32 v168, v168
    v_exp_f32 v169, v169
    v_exp_f32 v170, v170
    v_exp_f32 v171, v171
    v_fmamk_f32 v172, v152, 0x3e0293ee, v249
    v_fmamk_f32 v173, v153, 0x3e0293ee, v249
    v_fmamk_f32 v174, v154, 0x3e0293ee, v249
    v_fmamk_f32 v175, v155, 0x3e0293ee, v249
    v_cvt_pk_bf16_f32 v160, v168, v169
    v_cvt_pk_bf16_f32 v161, v170, v171
    v_exp_f32 v172, v172
    v_exp_f32 v173, v173
    v_exp_f32 v174, v174
    v_exp_f32 v175, v175
    v_fmamk_f32 v168, v148, 0x3e0293ee, v248
    v_fmamk_f32 v169, v149, 0x3e0293ee, v248
    v_fmamk_f32 v170, v150, 0x3e0293ee, v248
    v_fmamk_f32 v171, v151, 0x3e0293ee, v248
    s_setprio 1
    s_nop 0
    v_cvt_pk_bf16_f32 v164, v172, v173
    v_cvt_pk_bf16_f32 v165, v174, v175
    v_exp_f32 v168, v168
    v_exp_f32 v169, v169
    v_exp_f32 v170, v170
    v_exp_f32 v171, v171
    v_fmamk_f32 v172, v156, 0x3e0293ee, v249
    v_fmamk_f32 v173, v157, 0x3e0293ee, v249
    v_fmamk_f32 v174, v158, 0x3e0293ee, v249
    v_fmamk_f32 v175, v159, 0x3e0293ee, v249
    v_cvt_pk_bf16_f32 v162, v168, v169
    v_cvt_pk_bf16_f32 v163, v170, v171
    s_waitcnt vmcnt(0)
    s_nop 0
    ds_read_b128 v[112:115], v236 offset:0
    ds_read_b128 v[116:119], v237 offset:0
    ds_read_b128 v[120:123], v238 offset:0
    ds_read_b128 v[124:127], v239 offset:0
    v_exp_f32 v172, v172
    v_exp_f32 v173, v173
    v_exp_f32 v174, v174
    v_exp_f32 v175, v175
    v_cvt_pk_bf16_f32 v166, v172, v173
    v_cvt_pk_bf16_f32 v167, v174, v175
    s_waitcnt vmcnt(0)
    v_mfma_f32_16x16x32_bf16 v[208:211], v[216:219], v[160:163], v[200:203]
    v_mfma_f32_16x16x32_bf16 v[212:215], v[216:219], v[164:167], v[204:207]
    s_waitcnt lgkmcnt(7)
    v_mfma_f32_16x16x32_bf16 v[128:131], v[176:179], v[96:99], 0
    s_setprio 3
    ds_read_b128 v[192:195], v224 offset:4096
    s_waitcnt lgkmcnt(4)
    v_mfma_f32_16x16x32_bf16 v[136:139], v[176:179], v[112:115], 0
    s_waitcnt lgkmcnt(3)
    v_mfma_f32_16x16x32_bf16 v[136:139], v[180:183], v[116:119], v[136:139]
    ds_read_b128 v[196:199], v225 offset:4096
    v_mfma_f32_16x16x32_bf16 v[128:131], v[180:183], v[100:103], v[128:131]
    v_mfma_f32_16x16x32_bf16 v[128:131], v[184:187], v[104:107], v[128:131]
    ds_read_b128 v[176:179], v226 offset:4096
    s_waitcnt lgkmcnt(4)
    v_mfma_f32_16x16x32_bf16 v[136:139], v[184:187], v[120:123], v[136:139]
    v_max_f32_e64 v250, v208, v212
    v_cmp_nle_f32_e64 s[42:43], v250, s40
    s_waitcnt lgkmcnt(3)
    s_cmp_eq_u32 s29, 3
    s_cselect_b32 s14, 0, s14
    s_add_u32 m0, s58, 0x0
    s_add_u32 s38, s32, 0x2000000
    buffer_load_dwordx4 v240, s[12:15], s38 offen offset:0 nt lds
    v_mfma_f32_16x16x32_bf16 v[136:139], v[188:191], v[124:127], v[136:139]
    ds_read_b128 v[180:183], v227 offset:4096
    v_mfma_f32_16x16x32_bf16 v[128:131], v[188:191], v[108:111], v[128:131]
    s_cmp_lg_u64 s[42:43], 0
    s_cbranch_scc1 L_stublag6
L_retlag6:
    s_waitcnt lgkmcnt(3)
    v_mfma_f32_16x16x32_bf16 v[132:135], v[192:195], v[96:99], 0
    ds_read_b64_tr_b16 v[184:185], v228 offset:57344
    v_mfma_f32_16x16x32_bf16 v[140:143], v[192:195], v[112:115], 0
    ds_read_b64_tr_b16 v[186:187], v228 offset:61440
    s_add_u32 m0, s58, 0x400
    s_add_u32 s38, s32, 0x2000000
    buffer_load_dwordx4 v241, s[12:15], s38 offen offset:0 nt lds
    s_waitcnt lgkmcnt(4)
    v_mfma_f32_16x16x32_bf16 v[140:143], v[196:199], v[116:119], v[140:143]
    ds_read_b64_tr_b16 v[188:189], v229 offset:57344
    v_mfma_f32_16x16x32_bf16 v[132:135], v[196:199], v[100:103], v[132:135]
    ds_read_b64_tr_b16 v[190:191], v229 offset:61440
    s_waitcnt lgkmcnt(5)
    v_mfma_f32_16x16x32_bf16 v[132:135], v[176:179], v[104:107], v[132:135]
    ds_read_b64_tr_b16 v[192:193], v230 offset:57344
    v_mfma_f32_16x16x32_bf16 v[140:143], v[176:179], v[120:123], v[140:143]
    ds_read_b64_tr_b16 v[194:195], v230 offset:61440
    s_waitcnt lgkmcnt(6)
    v_mfma_f32_16x16x32_bf16 v[140:143], v[180:183], v[124:127], v[140:143]
    ds_read_b64_tr_b16 v[176:177], v231 offset:57344
    v_mfma_f32_16x16x32_bf16 v[132:135], v[180:183], v[108:111], v[132:135]
    ds_read_b64_tr_b16 v[178:179], v231 offset:61440
    s_waitcnt lgkmcnt(6)
    v_mfma_f32_16x16x32_bf16 v[0:3], v[184:187], v[160:163], v[0:3]
    ds_read_b64_tr_b16 v[180:181], v232 offset:57344
    v_mfma_f32_16x16x32_bf16 v[32:35], v[184:187], v[164:167], v[32:35]
    ds_read_b64_tr_b16 v[182:183], v232 offset:61440
    s_waitcnt lgkmcnt(6)
    v_mfma_f32_16x16x32_bf16 v[36:39], v[188:191], v[164:167], v[36:39]
    ds_read_b64_tr_b16 v[184:185], v233 offset:57344
    v_mfma_f32_16x16x32_bf16 v[4:7], v[188:191], v[160:163], v[4:7]
    ds_read_b64_tr_b16 v[186:187], v233 offset:61440
    s_waitcnt lgkmcnt(6)
    v_mfma_f32_16x16x32_bf16 v[8:11], v[192:195], v[160:163], v[8:11]
    ds_read_b64_tr_b16 v[196:197], v234 offset:57344
    v_mfma_f32_16x16x32_bf16 v[40:43], v[192:195], v[164:167], v[40:43]
    ds_read_b64_tr_b16 v[198:199], v234 offset:61440
    s_waitcnt lgkmcnt(6)
    v_mfma_f32_16x16x32_bf16 v[44:47], v[176:179], v[164:167], v[44:47]
    ds_read_b64_tr_b16 v[192:193], v235 offset:57344
    v_mfma_f32_16x16x32_bf16 v[12:15], v[176:179], v[160:163], v[12:15]
    ds_read_b64_tr_b16 v[194:195], v235 offset:61440
    s_waitcnt lgkmcnt(6)
    v_mfma_f32_16x16x32_bf16 v[16:19], v[180:183], v[160:163], v[16:19]
    v_mfma_f32_16x16x32_bf16 v[48:51], v[180:183], v[164:167], v[48:51]
    s_waitcnt lgkmcnt(4)
    v_mfma_f32_16x16x32_bf16 v[52:55], v[184:187], v[164:167], v[52:55]
    v_mfma_f32_16x16x32_bf16 v[20:23], v[184:187], v[160:163], v[20:23]
    s_waitcnt lgkmcnt(2)
    v_mfma_f32_16x16x32_bf16 v[24:27], v[196:199], v[160:163], v[24:27]
    v_mfma_f32_16x16x32_bf16 v[56:59], v[196:199], v[164:167], v[56:59]
    s_waitcnt lgkmcnt(0)
    s_barrier
    v_mfma_f32_16x16x32_bf16 v[60:63], v[192:195], v[164:167], v[60:63]
    ds_read_b128 v[176:179], v224 offset:8192
    v_mfma_f32_16x16x32_bf16 v[28:31], v[192:195], v[160:163], v[28:31]
    ds_read_b128 v[180:183], v225 offset:8192
    ds_read_b128 v[184:187], v226 offset:8192
    ds_read_b128 v[188:191], v227 offset:8192
L_looplag:
    s_mov_b32 s50, s35
    s_mov_b32 s34, s32
    s_mov_b32 s32, s30
    s_xor_b32 s30, s30, 0x4000
    s_add_u32 s30, s30, 0x2000000
    s_mov_b32 s35, s33
    s_mov_b32 s33, s31
    s_xor_b32 s31, s31, 0x4000
    s_add_u32 s31, s31, 0x2000000
    s_add_u32 s36, s36, 0x1000000
    s_setprio 0
.p2align 3
    v_rcp_f32 v208, v208
    v_rcp_f32 v212, v212
    buffer_store_dwordx4 v[220:223], v244, s[52:55], s50 offen offset:0 sc0 sc1
    v_max_f32_e64 v248, v128, v129
    v_max_f32_e64 v249, v136, v137
    v_max3_f32 v248, v248, v130, v131
    v_max3_f32 v249, v249, v138, v139
    v_max3_f32 v248, v248, v132, v133
    v_max3_f32 v249, v249, v140, v141
    v_max3_f32 v248, v248, v134, v135
    v_max3_f32 v249, v249, v142, v143
    s_nop 1
    v_permlane32_swap_b32 v248, v249
    v_max_f32 v248, v248, v249
    v_mov_b32 v249, v248
    s_nop 1
    v_permlane16_swap_b32 v248, v249
    v_max_f32 v248, v248, v249
    v_mul_f32 v248, 0xbe0293ee, v248
    v_mov_b32 v249, v248
    s_nop 1
    v_permlane32_swap_b32 v248, v249
.p2align 3
    v_fmamk_f32 v168, v128, 0x3e0293ee, v248
    v_fmamk_f32 v169, v129, 0x3e0293ee, v248
    v_fmamk_f32 v170, v130, 0x3e0293ee, v248
    v_fmamk_f32 v171, v131, 0x3e0293ee, v248
    v_exp_f32 v168, v168
    v_exp_f32 v169, v169
    v_exp_f32 v170, v170
    v_exp_f32 v171, v171
    v_fmamk_f32 v172, v136, 0x3e0293ee, v249
    v_fmamk_f32 v173, v137, 0x3e0293ee, v249
    v_fmamk_f32 v174, v138, 0x3e0293ee, v249
    v_fmamk_f32 v175, v139, 0x3e0293ee, v249
    s_setprio 2
    s_nop 0
    v_cvt_pk_bf16_f32 v160, v168, v169
    v_cvt_pk_bf16_f32 v161, v170, v171
    v_exp_f32 v172, v172
    v_exp_f32 v173, v173
    v_exp_f32 v174, v174
    v_exp_f32 v175, v175
    v_fmamk_f32 v168, v132, 0x3e0293ee, v248
    v_fmamk_f32 v169, v133, 0x3e0293ee, v248
    v_fmamk_f32 v170, v134, 0x3e0293ee, v248
    v_fmamk_f32 v171, v135, 0x3e0293ee, v248
    v_cvt_pk_bf16_f32 v164, v172, v173
    v_cvt_pk_bf16_f32 v165, v174, v175
    v_exp_f32 v168, v168
    v_exp_f32 v169, v169
    v_exp_f32 v170, v170
    v_exp_f32 v171, v171
    v_fmamk_f32 v172, v140, 0x3e0293ee, v249
    v_fmamk_f32 v173, v141, 0x3e0293ee, v249
    v_fmamk_f32 v174, v142, 0x3e0293ee, v249
    v_fmamk_f32 v175, v143, 0x3e0293ee, v249
    v_cvt_pk_bf16_f32 v162, v168, v169
    v_cvt_pk_bf16_f32 v163, v170, v171
    v_exp_f32 v172, v172
    v_exp_f32 v173, v173
    v_exp_f32 v174, v174
    v_exp_f32 v175, v175
    v_cvt_pk_bf16_f32 v166, v172, v173
    v_cvt_pk_bf16_f32 v167, v174, v175
    v_pk_mul_f32 v[0:1], v[0:1], v[208:209] op_sel_hi:[1,0]
    v_pk_mul_f32 v[2:3], v[2:3], v[208:209] op_sel_hi:[1,0]
    v_pk_mul_f32 v[4:5], v[4:5], v[208:209] op_sel_hi:[1,0]
    v_pk_mul_f32 v[6:7], v[6:7], v[208:209] op_sel_hi:[1,0]
    v_cvt_pk_bf16_f32 v64, v0, v1
    v_cvt_pk_bf16_f32 v65, v2, v3
    v_cvt_pk_bf16_f32 v66, v4, v5
    v_cvt_pk_bf16_f32 v67, v6, v7
    v_pk_mul_f32 v[8:9], v[8:9], v[208:209] op_sel_hi:[1,0]
    v_pk_mul_f32 v[10:11], v[10:11], v[208:209] op_sel_hi:[1,0]
    v_pk_mul_f32 v[12:13], v[12:13], v[208:209] op_sel_hi:[1,0]
    v_pk_mul_f32 v[14:15], v[14:15], v[208:209] op_sel_hi:[1,0]
    v_cvt_pk_bf16_f32 v68, v8, v9
    v_cvt_pk_bf16_f32 v69, v10, v11
    v_cvt_pk_bf16_f32 v70, v12, v13
    v_cvt_pk_bf16_f32 v71, v14, v15
    v_pk_mul_f32 v[16:17], v[16:17], v[208:209] op_sel_hi:[1,0]
    v_pk_mul_f32 v[18:19], v[18:19], v[208:209] op_sel_hi:[1,0]
    v_pk_mul_f32 v[20:21], v[20:21], v[208:209] op_sel_hi:[1,0]
    v_pk_mul_f32 v[22:23], v[22:23], v[208:209] op_sel_hi:[1,0]
    v_cvt_pk_bf16_f32 v72, v16, v17
    v_cvt_pk_bf16_f32 v73, v18, v19
    v_cvt_pk_bf16_f32 v74, v20, v21
    v_cvt_pk_bf16_f32 v75, v22, v23
    v_pk_mul_f32 v[24:25], v[24:25], v[208:209] op_sel_hi:[1,0]
    v_pk_mul_f32 v[26:27], v[26:27], v[208:209] op_sel_hi:[1,0]
    v_pk_mul_f32 v[28:29], v[28:29], v[208:209] op_sel_hi:[1,0]
    v_pk_mul_f32 v[30:31], v[30:31], v[208:209] op_sel_hi:[1,0]
    v_cvt_pk_bf16_f32 v76, v24, v25
    v_cvt_pk_bf16_f32 v77, v26, v27
    v_cvt_pk_bf16_f32 v78, v28, v29
    v_cvt_pk_bf16_f32 v79, v30, v31
    v_pk_mul_f32 v[32:33], v[32:33], v[212:213] op_sel_hi:[1,0]
    v_pk_mul_f32 v[34:35], v[34:35], v[212:213] op_sel_hi:[1,0]
    v_pk_mul_f32 v[36:37], v[36:37], v[212:213] op_sel_hi:[1,0]
    v_pk_mul_f32 v[38:39], v[38:39], v[212:213] op_sel_hi:[1,0]
    v_cvt_pk_bf16_f32 v80, v32, v33
    v_cvt_pk_bf16_f32 v81, v34, v35
    v_cvt_pk_bf16_f32 v82, v36, v37
    v_cvt_pk_bf16_f32 v83, v38, v39
    v_pk_mul_f32 v[40:41], v[40:41], v[212:213] op_sel_hi:[1,0]
    v_pk_mul_f32 v[42:43], v[42:43], v[212:213] op_sel_hi:[1,0]
    v_pk_mul_f32 v[44:45], v[44:45], v[212:213] op_sel_hi:[1,0]
    v_pk_mul_f32 v[46:47], v[46:47], v[212:213] op_sel_hi:[1,0]
    v_cvt_pk_bf16_f32 v84, v40, v41
    v_cvt_pk_bf16_f32 v85, v42, v43
    v_cvt_pk_bf16_f32 v86, v44, v45
    v_cvt_pk_bf16_f32 v87, v46, v47
    v_pk_mul_f32 v[48:49], v[48:49], v[212:213] op_sel_hi:[1,0]
    v_pk_mul_f32 v[50:51], v[50:51], v[212:213] op_sel_hi:[1,0]
    v_pk_mul_f32 v[52:53], v[52:53], v[212:213] op_sel_hi:[1,0]
    v_pk_mul_f32 v[54:55], v[54:55], v[212:213] op_sel_hi:[1,0]
    v_cvt_pk_bf16_f32 v88, v48, v49
    v_cvt_pk_bf16_f32 v89, v50, v51
    v_cvt_pk_bf16_f32 v90, v52, v53
    v_cvt_pk_bf16_f32 v91, v54, v55
    v_pk_mul_f32 v[56:57], v[56:57], v[212:213] op_sel_hi:[1,0]
    v_pk_mul_f32 v[58:59], v[58:59], v[212:213] op_sel_hi:[1,0]
    v_pk_mul_f32 v[60:61], v[60:61], v[212:213] op_sel_hi:[1,0]
    v_pk_mul_f32 v[62:63], v[62:63], v[212:213] op_sel_hi:[1,0]
    v_cvt_pk_bf16_f32 v92, v56, v57
    v_cvt_pk_bf16_f32 v93, v58, v59
    v_cvt_pk_bf16_f32 v94, v60, v61
    v_cvt_pk_bf16_f32 v95, v62, v63
    s_waitcnt vmcnt(1)
    v_mfma_f32_16x16x32_bf16 v[200:203], v[216:219], v[160:163], 0
    v_mfma_f32_16x16x32_bf16 v[204:207], v[216:219], v[164:167], 0
    s_waitcnt lgkmcnt(3)
    v_mfma_f32_16x16x32_bf16 v[144:147], v[176:179], v[96:99], 0
    s_setprio 3
    ds_read_b128 v[192:195], v224 offset:12288
    v_mfma_f32_16x16x32_bf16 v[152:155], v[176:179], v[112:115], 0
    s_waitcnt lgkmcnt(3)
    v_mfma_f32_16x16x32_bf16 v[152:155], v[180:183], v[116:119], v[152:155]
    ds_read_b128 v[196:199], v225 offset:12288
    v_mfma_f32_16x16x32_bf16 v[144:147], v[180:183], v[100:103], v[144:147]
    s_add_u32 m0, s58, 0x800
    s_nop 0
    buffer_load_dwordx4 v242, s[12:15], s30 offen offset:0 nt lds
    s_waitcnt lgkmcnt(3)
    v_mfma_f32_16x16x32_bf16 v[144:147], v[184:187], v[104:107], v[144:147]
    ds_read_b128 v[176:179], v226 offset:12288
    v_mfma_f32_16x16x32_bf16 v[152:155], v[184:187], v[120:123], v[152:155]
    s_waitcnt lgkmcnt(3)
    v_mfma_f32_16x16x32_bf16 v[152:155], v[188:191], v[124:127], v[152:155]
    ds_read_b128 v[180:183], v227 offset:12288
    v_mfma_f32_16x16x32_bf16 v[144:147], v[188:191], v[108:111], v[144:147]
    s_add_u32 m0, s37, 0x0
    s_xor_b32 s38, s36, 0x0
    buffer_load_dwordx4 v245, s[16:19], s38 offen offset:0 nt lds
    s_waitcnt lgkmcnt(3)
    v_mfma_f32_16x16x32_bf16 v[148:151], v[192:195], v[96:99], 0
    ds_read_b64_tr_b16 v[184:185], v228 offset:0
    v_mfma_f32_16x16x32_bf16 v[156:159], v[192:195], v[112:115], 0
    ds_read_b64_tr_b16 v[186:187], v228 offset:4096
    s_waitcnt lgkmcnt(4)
    v_mfma_f32_16x16x32_bf16 v[156:159], v[196:199], v[116:119], v[156:159]
    ds_read_b64_tr_b16 v[188:189], v229 offset:0
    v_mfma_f32_16x16x32_bf16 v[148:151], v[196:199], v[100:103], v[148:151]
    ds_read_b64_tr_b16 v[190:191], v229 offset:4096
    s_waitcnt lgkmcnt(5)
    v_mfma_f32_16x16x32_bf16 v[148:151], v[176:179], v[104:107], v[148:151]
    ds_read_b64_tr_b16 v[192:193], v230 offset:0
    v_mfma_f32_16x16x32_bf16 v[156:159], v[176:179], v[120:123], v[156:159]
    ds_read_b64_tr_b16 v[194:195], v230 offset:4096
    s_waitcnt lgkmcnt(6)
    v_mfma_f32_16x16x32_bf16 v[156:159], v[180:183], v[124:127], v[156:159]
    ds_read_b64_tr_b16 v[176:177], v231 offset:0
    v_mfma_f32_16x16x32_bf16 v[148:151], v[180:183], v[108:111], v[148:151]
    ds_read_b64_tr_b16 v[178:179], v231 offset:4096
    s_waitcnt lgkmcnt(6)
    v_mfma_f32_16x16x32_bf16 v[0:3], v[184:187], v[160:163], 0
    ds_read_b64_tr_b16 v[180:181], v232 offset:0
    v_mfma_f32_16x16x32_bf16 v[32:35], v[184:187], v[164:167], 0
    ds_read_b64_tr_b16 v[182:183], v232 offset:4096
    s_waitcnt lgkmcnt(6)
    v_mfma_f32_16x16x32_bf16 v[36:39], v[188:191], v[164:167], 0
    ds_read_b64_tr_b16 v[184:185], v233 offset:0
    v_mfma_f32_16x16x32_bf16 v[4:7], v[188:191], v[160:163], 0
    ds_read_b64_tr_b16 v[186:187], v233 offset:4096
    s_waitcnt lgkmcnt(6)
    v_mfma_f32_16x16x32_bf16 v[8:11], v[192:195], v[160:163], 0
    ds_read_b64_tr_b16 v[196:197], v234 offset:0
    v_mfma_f32_16x16x32_bf16 v[40:43], v[192:195], v[164:167], 0
    ds_read_b64_tr_b16 v[198:199], v234 offset:4096
    s_waitcnt lgkmcnt(6)
    v_mfma_f32_16x16x32_bf16 v[44:47], v[176:179], v[164:167], 0
    ds_read_b64_tr_b16 v[192:193], v235 offset:0
    v_mfma_f32_16x16x32_bf16 v[12:15], v[176:179], v[160:163], 0
    ds_read_b64_tr_b16 v[194:195], v235 offset:4096
    s_waitcnt lgkmcnt(6)
    v_mfma_f32_16x16x32_bf16 v[16:19], v[180:183], v[160:163], 0
    v_mfma_f32_16x16x32_bf16 v[48:51], v[180:183], v[164:167], 0
    s_waitcnt lgkmcnt(4)
    v_mfma_f32_16x16x32_bf16 v[52:55], v[184:187], v[164:167], 0
    v_mfma_f32_16x16x32_bf16 v[20:23], v[184:187], v[160:163], 0
    s_waitcnt lgkmcnt(2)
    v_mfma_f32_16x16x32_bf16 v[24:27], v[196:199], v[160:163], 0
    v_mfma_f32_16x16x32_bf16 v[56:59], v[196:199], v[164:167], 0
    s_waitcnt lgkmcnt(0)
    s_barrier
    v_mfma_f32_16x16x32_bf16 v[60:63], v[192:195], v[164:167], 0
    ds_read_b128 v[176:179], v224 offset:16384
    v_mfma_f32_16x16x32_bf16 v[28:31], v[192:195], v[160:163], 0
    ds_read_b128 v[180:183], v225 offset:16384
    ds_read_b128 v[184:187], v226 offset:16384
    ds_read_b128 v[188:191], v227 offset:16384
    s_setprio 0
.p2align 3
    v_fmamk_f32 v168, v144, 0x3e0293ee, v248
    v_fmamk_f32 v169, v145, 0x3e0293ee, v248
    v_permlane16_swap_b32 v64, v66
    v_permlane16_swap_b32 v65, v67
    v_fmamk_f32 v170, v146, 0x3e0293ee, v248
    v_fmamk_f32 v171, v147, 0x3e0293ee, v248
    v_exp_f32 v168, v168
    v_exp_f32 v169, v169
    v_permlane16_swap_b32 v68, v70
    v_permlane16_swap_b32 v69, v71
    v_exp_f32 v170, v170
    v_exp_f32 v171, v171
    v_fmamk_f32 v172, v152, 0x3e0293ee, v249
    v_fmamk_f32 v173, v153, 0x3e0293ee, v249
    v_cndmask_b32_dpp v220, v68, v64, vcc quad_perm:[1,0,3,2] row_mask:0xf bank_mask:0xf
    v_cndmask_b32_dpp v221, v69, v65, vcc quad_perm:[1,0,3,2] row_mask:0xf bank_mask:0xf
    v_fmamk_f32 v174, v154, 0x3e0293ee, v249
    v_fmamk_f32 v175, v155, 0x3e0293ee, v249
    v_cvt_pk_bf16_f32 v160, v168, v169
    v_cvt_pk_bf16_f32 v161, v170, v171
    v_cndmask_b32_dpp v222, v70, v66, vcc quad_perm:[1,0,3,2] row_mask:0xf bank_mask:0xf
    v_cndmask_b32_dpp v223, v71, v67, vcc quad_perm:[1,0,3,2] row_mask:0xf bank_mask:0xf
    s_not_b64 vcc, vcc
    s_nop 0
    v_exp_f32 v172, v172
    v_exp_f32 v173, v173
    v_exp_f32 v174, v174
    v_exp_f32 v175, v175
    v_cndmask_b32_dpp v68, v64, v68, vcc quad_perm:[1,0,3,2] row_mask:0xf bank_mask:0xf
    v_cndmask_b32_dpp v69, v65, v69, vcc quad_perm:[1,0,3,2] row_mask:0xf bank_mask:0xf
    v_fmamk_f32 v168, v148, 0x3e0293ee, v248
    v_fmamk_f32 v169, v149, 0x3e0293ee, v248
    v_fmamk_f32 v170, v150, 0x3e0293ee, v248
    v_fmamk_f32 v171, v151, 0x3e0293ee, v248
    s_setprio 1
    s_nop 0
    v_cndmask_b32_dpp v70, v66, v70, vcc quad_perm:[1,0,3,2] row_mask:0xf bank_mask:0xf
    v_cndmask_b32_dpp v71, v67, v71, vcc quad_perm:[1,0,3,2] row_mask:0xf bank_mask:0xf
    s_not_b64 vcc, vcc
    s_nop 0
    v_cvt_pk_bf16_f32 v164, v172, v173
    v_cvt_pk_bf16_f32 v165, v174, v175
    v_exp_f32 v168, v168
    v_exp_f32 v169, v169
    buffer_store_dwordx4 v[68:71], v244, s[24:27], s34 offen offset:256 sc0 sc1
    v_exp_f32 v170, v170
    v_exp_f32 v171, v171
    v_fmamk_f32 v172, v156, 0x3e0293ee, v249
    v_fmamk_f32 v173, v157, 0x3e0293ee, v249
    v_fmamk_f32 v174, v158, 0x3e0293ee, v249
    v_fmamk_f32 v175, v159, 0x3e0293ee, v249
    v_cvt_pk_bf16_f32 v162, v168, v169
    v_cvt_pk_bf16_f32 v163, v170, v171
    v_exp_f32 v172, v172
    v_exp_f32 v173, v173
    v_exp_f32 v174, v174
    v_exp_f32 v175, v175
    v_cvt_pk_bf16_f32 v166, v172, v173
    v_cvt_pk_bf16_f32 v167, v174, v175
    s_waitcnt vmcnt(1)
    v_mfma_f32_16x16x32_bf16 v[208:211], v[216:219], v[160:163], v[200:203]
    v_mfma_f32_16x16x32_bf16 v[212:215], v[216:219], v[164:167], v[204:207]
    s_waitcnt lgkmcnt(3)
    v_mfma_f32_16x16x32_bf16 v[128:131], v[176:179], v[96:99], 0
    s_setprio 3
    ds_read_b128 v[192:195], v224 offset:20480
    v_mfma_f32_16x16x32_bf16 v[136:139], v[176:179], v[112:115], 0
    s_waitcnt lgkmcnt(3)
    v_mfma_f32_16x16x32_bf16 v[136:139], v[180:183], v[116:119], v[136:139]
    ds_read_b128 v[196:199], v225 offset:20480
    v_mfma_f32_16x16x32_bf16 v[128:131], v[180:183], v[100:103], v[128:131]
    s_add_u32 m0, s37, 0x2000
    s_xor_b32 s38, s36, 0x1000
    buffer_load_dwordx4 v245, s[16:19], s38 offen offset:0 nt lds
    s_waitcnt lgkmcnt(3)
    v_mfma_f32_16x16x32_bf16 v[128:131], v[184:187], v[104:107], v[128:131]
    ds_read_b128 v[176:179], v226 offset:20480
    v_mfma_f32_16x16x32_bf16 v[136:139], v[184:187], v[120:123], v[136:139]
    v_max_f32_e64 v250, v208, v212
    v_cmp_nle_f32_e64 s[42:43], v250, s40
    s_waitcnt lgkmcnt(3)
    v_mfma_f32_16x16x32_bf16 v[136:139], v[188:191], v[124:127], v[136:139]
    ds_read_b128 v[180:183], v227 offset:20480
    v_mfma_f32_16x16x32_bf16 v[128:131], v[188:191], v[108:111], v[128:131]
    s_cmp_lg_u64 s[42:43], 0
    s_cbranch_scc1 L_stublag7
L_retlag7:
    s_add_u32 m0, s37, 0x10000
    s_xor_b32 s38, s36, 0x0
    buffer_load_dwordx4 v246, s[20:23], s38 offen offset:0 nt lds
    s_waitcnt lgkmcnt(3)
    v_mfma_f32_16x16x32_bf16 v[132:135], v[192:195], v[96:99], 0
    ds_read_b64_tr_b16 v[184:185], v228 offset:8192
    v_mfma_f32_16x16x32_bf16 v[140:143], v[192:195], v[112:115], 0
    ds_read_b64_tr_b16 v[186:187], v228 offset:12288
    s_waitcnt lgkmcnt(4)
    v_mfma_f32_16x16x32_bf16 v[140:143], v[196:199], v[116:119], v[140:143]
    ds_read_b64_tr_b16 v[188:189], v229 offset:8192
    v_mfma_f32_16x16x32_bf16 v[132:135], v[196:199], v[100:103], v[132:135]
    ds_read_b64_tr_b16 v[190:191], v229 offset:12288
    s_waitcnt lgkmcnt(5)
    v_mfma_f32_16x16x32_bf16 v[132:135], v[176:179], v[104:107], v[132:135]
    ds_read_b64_tr_b16 v[192:193], v230 offset:8192
    v_mfma_f32_16x16x32_bf16 v[140:143], v[176:179], v[120:123], v[140:143]
    ds_read_b64_tr_b16 v[194:195], v230 offset:12288
    s_waitcnt lgkmcnt(6)
    v_mfma_f32_16x16x32_bf16 v[140:143], v[180:183], v[124:127], v[140:143]
    ds_read_b64_tr_b16 v[176:177], v231 offset:8192
    v_mfma_f32_16x16x32_bf16 v[132:135], v[180:183], v[108:111], v[132:135]
    ds_read_b64_tr_b16 v[178:179], v231 offset:12288
    s_waitcnt lgkmcnt(6)
    v_mfma_f32_16x16x32_bf16 v[0:3], v[184:187], v[160:163], v[0:3]
    ds_read_b64_tr_b16 v[180:181], v232 offset:8192
    v_mfma_f32_16x16x32_bf16 v[32:35], v[184:187], v[164:167], v[32:35]
    ds_read_b64_tr_b16 v[182:183], v232 offset:12288
    s_waitcnt lgkmcnt(6)
    v_mfma_f32_16x16x32_bf16 v[36:39], v[188:191], v[164:167], v[36:39]
    ds_read_b64_tr_b16 v[184:185], v233 offset:8192
    v_mfma_f32_16x16x32_bf16 v[4:7], v[188:191], v[160:163], v[4:7]
    ds_read_b64_tr_b16 v[186:187], v233 offset:12288
    s_waitcnt lgkmcnt(6)
    v_mfma_f32_16x16x32_bf16 v[8:11], v[192:195], v[160:163], v[8:11]
    ds_read_b64_tr_b16 v[196:197], v234 offset:8192
    v_mfma_f32_16x16x32_bf16 v[40:43], v[192:195], v[164:167], v[40:43]
    ds_read_b64_tr_b16 v[198:199], v234 offset:12288
    s_waitcnt lgkmcnt(6)
    v_mfma_f32_16x16x32_bf16 v[44:47], v[176:179], v[164:167], v[44:47]
    ds_read_b64_tr_b16 v[192:193], v235 offset:8192
    v_mfma_f32_16x16x32_bf16 v[12:15], v[176:179], v[160:163], v[12:15]
    ds_read_b64_tr_b16 v[194:195], v235 offset:12288
    s_waitcnt lgkmcnt(6)
    v_mfma_f32_16x16x32_bf16 v[16:19], v[180:183], v[160:163], v[16:19]
    v_mfma_f32_16x16x32_bf16 v[48:51], v[180:183], v[164:167], v[48:51]
    s_waitcnt lgkmcnt(4)
    v_mfma_f32_16x16x32_bf16 v[52:55], v[184:187], v[164:167], v[52:55]
    v_mfma_f32_16x16x32_bf16 v[20:23], v[184:187], v[160:163], v[20:23]
    s_waitcnt lgkmcnt(2)
    v_mfma_f32_16x16x32_bf16 v[24:27], v[196:199], v[160:163], v[24:27]
    v_mfma_f32_16x16x32_bf16 v[56:59], v[196:199], v[164:167], v[56:59]
    s_waitcnt lgkmcnt(0)
    s_barrier
    v_mfma_f32_16x16x32_bf16 v[60:63], v[192:195], v[164:167], v[60:63]
    ds_read_b128 v[176:179], v224 offset:24576
    v_mfma_f32_16x16x32_bf16 v[28:31], v[192:195], v[160:163], v[28:31]
    ds_read_b128 v[180:183], v225 offset:24576
    ds_read_b128 v[184:187], v226 offset:24576
    ds_read_b128 v[188:191], v227 offset:24576
    s_setprio 0
.p2align 3
    v_fmamk_f32 v168, v128, 0x3e0293ee, v248
    v_fmamk_f32 v169, v129, 0x3e0293ee, v248
    v_permlane16_swap_b32 v72, v74
    v_permlane16_swap_b32 v73, v75
    v_fmamk_f32 v170, v130, 0x3e0293ee, v248
    v_fmamk_f32 v171, v131, 0x3e0293ee, v248
    v_exp_f32 v168, v168
    v_exp_f32 v169, v169
    v_permlane16_swap_b32 v76, v78
    v_permlane16_swap_b32 v77, v79
    v_exp_f32 v170, v170
    v_exp_f32 v171, v171
    v_fmamk_f32 v172, v136, 0x3e0293ee, v249
    v_fmamk_f32 v173, v137, 0x3e0293ee, v249
    v_cndmask_b32_dpp v64, v76, v72, vcc quad_perm:[1,0,3,2] row_mask:0xf bank_mask:0xf
    v_cndmask_b32_dpp v65, v77, v73, vcc quad_perm:[1,0,3,2] row_mask:0xf bank_mask:0xf
    v_fmamk_f32 v174, v138, 0x3e0293ee, v249
    v_fmamk_f32 v175, v139, 0x3e0293ee, v249
    v_cvt_pk_bf16_f32 v160, v168, v169
    v_cvt_pk_bf16_f32 v161, v170, v171
    v_cndmask_b32_dpp v66, v78, v74, vcc quad_perm:[1,0,3,2] row_mask:0xf bank_mask:0xf
    v_cndmask_b32_dpp v67, v79, v75, vcc quad_perm:[1,0,3,2] row_mask:0xf bank_mask:0xf
    s_not_b64 vcc, vcc
    s_nop 0
    v_exp_f32 v172, v172
    v_exp_f32 v173, v173
    v_exp_f32 v174, v174
    v_exp_f32 v175, v175
    v_cndmask_b32_dpp v76, v72, v76, vcc quad_perm:[1,0,3,2] row_mask:0xf bank_mask:0xf
    v_cndmask_b32_dpp v77, v73, v77, vcc quad_perm:[1,0,3,2] row_mask:0xf bank_mask:0xf
    v_fmamk_f32 v168, v132, 0x3e0293ee, v248
    v_fmamk_f32 v169, v133, 0x3e0293ee, v248
    v_fmamk_f32 v170, v134, 0x3e0293ee, v248
    v_fmamk_f32 v171, v135, 0x3e0293ee, v248
    s_setprio 1
    s_nop 0
    v_cndmask_b32_dpp v78, v74, v78, vcc quad_perm:[1,0,3,2] row_mask:0xf bank_mask:0xf
    v_cndmask_b32_dpp v79, v75, v79, vcc quad_perm:[1,0,3,2] row_mask:0xf bank_mask:0xf
    s_not_b64 vcc, vcc
    s_nop 0
    v_cvt_pk_bf16_f32 v164, v172, v173
    v_cvt_pk_bf16_f32 v165, v174, v175
    v_exp_f32 v168, v168
    v_exp_f32 v169, v169
    buffer_store_dwordx4 v[64:67], v244, s[24:27], s34 offen offset:128 sc0 sc1
    v_exp_f32 v170, v170
    v_exp_f32 v171, v171
    v_fmamk_f32 v172, v140, 0x3e0293ee, v249
    v_fmamk_f32 v173, v141, 0x3e0293ee, v249
    v_fmamk_f32 v174, v142, 0x3e0293ee, v249
    v_fmamk_f32 v175, v143, 0x3e0293ee, v249
    v_cvt_pk_bf16_f32 v162, v168, v169
    v_cvt_pk_bf16_f32 v163, v170, v171
    v_exp_f32 v172, v172
    v_exp_f32 v173, v173
    v_exp_f32 v174, v174
    v_exp_f32 v175, v175
    v_cvt_pk_bf16_f32 v166, v172, v173
    v_cvt_pk_bf16_f32 v167, v174, v175
    s_waitcnt vmcnt(1)
    v_mfma_f32_16x16x32_bf16 v[200:203], v[216:219], v[160:163], v[208:211]
    v_mfma_f32_16x16x32_bf16 v[204:207], v[216:219], v[164:167], v[212:215]
    s_waitcnt lgkmcnt(3)
    v_mfma_f32_16x16x32_bf16 v[144:147], v[176:179], v[96:99], 0
    s_setprio 3
    ds_read_b128 v[192:195], v224 offset:28672
    v_mfma_f32_16x16x32_bf16 v[152:155], v[176:179], v[112:115], 0
    s_waitcnt lgkmcnt(3)
    v_mfma_f32_16x16x32_bf16 v[152:155], v[180:183], v[116:119], v[152:155]
    ds_read_b128 v[196:199], v225 offset:28672
    v_mfma_f32_16x16x32_bf16 v[144:147], v[180:183], v[100:103], v[144:147]
    s_add_u32 m0, s58, 0xc00
    s_nop 0
    buffer_load_dwordx4 v243, s[12:15], s30 offen offset:0 nt lds
    s_waitcnt lgkmcnt(3)
    v_mfma_f32_16x16x32_bf16 v[144:147], v[184:187], v[104:107], v[144:147]
    ds_read_b128 v[176:179], v226 offset:28672
    v_mfma_f32_16x16x32_bf16 v[152:155], v[184:187], v[120:123], v[152:155]
    v_max_f32_e64 v250, v200, v204
    v_cmp_nle_f32_e64 s[42:43], v250, s40
    s_waitcnt lgkmcnt(3)
    v_mfma_f32_16x16x32_bf16 v[152:155], v[188:191], v[124:127], v[152:155]
    ds_read_b128 v[180:183], v227 offset:28672
    v_mfma_f32_16x16x32_bf16 v[144:147], v[188:191], v[108:111], v[144:147]
    s_cmp_lg_u64 s[42:43], 0
    s_cbranch_scc1 L_stublag8
L_retlag8:
    s_add_u32 m0, s37, 0x4000
    s_xor_b32 s38, s36, 0x2000
    buffer_load_dwordx4 v245, s[16:19], s38 offen offset:0 nt lds
    s_waitcnt lgkmcnt(3)
    v_mfma_f32_16x16x32_bf16 v[148:151], v[192:195], v[96:99], 0
    ds_read_b64_tr_b16 v[184:185], v228 offset:16384
    v_mfma_f32_16x16x32_bf16 v[156:159], v[192:195], v[112:115], 0
    ds_read_b64_tr_b16 v[186:187], v228 offset:20480
    s_waitcnt lgkmcnt(4)
    v_mfma_f32_16x16x32_bf16 v[156:159], v[196:199], v[116:119], v[156:159]
    ds_read_b64_tr_b16 v[188:189], v229 offset:16384
    v_mfma_f32_16x16x32_bf16 v[148:151], v[196:199], v[100:103], v[148:151]
    ds_read_b64_tr_b16 v[190:191], v229 offset:20480
    s_waitcnt lgkmcnt(5)
    v_mfma_f32_16x16x32_bf16 v[148:151], v[176:179], v[104:107], v[148:151]
    ds_read_b64_tr_b16 v[192:193], v230 offset:16384
    v_mfma_f32_16x16x32_bf16 v[156:159], v[176:179], v[120:123], v[156:159]
    ds_read_b64_tr_b16 v[194:195], v230 offset:20480
    s_waitcnt lgkmcnt(6)
    v_mfma_f32_16x16x32_bf16 v[156:159], v[180:183], v[124:127], v[156:159]
    ds_read_b64_tr_b16 v[176:177], v231 offset:16384
    v_mfma_f32_16x16x32_bf16 v[148:151], v[180:183], v[108:111], v[148:151]
    ds_read_b64_tr_b16 v[178:179], v231 offset:20480
    s_waitcnt lgkmcnt(6)
    v_mfma_f32_16x16x32_bf16 v[0:3], v[184:187], v[160:163], v[0:3]
    ds_read_b64_tr_b16 v[180:181], v232 offset:16384
    v_mfma_f32_16x16x32_bf16 v[32:35], v[184:187], v[164:167], v[32:35]
    ds_read_b64_tr_b16 v[182:183], v232 offset:20480
    s_waitcnt lgkmcnt(6)
    v_mfma_f32_16x16x32_bf16 v[36:39], v[188:191], v[164:167], v[36:39]
    ds_read_b64_tr_b16 v[184:185], v233 offset:16384
    v_mfma_f32_16x16x32_bf16 v[4:7], v[188:191], v[160:163], v[4:7]
    ds_read_b64_tr_b16 v[186:187], v233 offset:20480
    s_waitcnt lgkmcnt(6)
    v_mfma_f32_16x16x32_bf16 v[8:11], v[192:195], v[160:163], v[8:11]
    ds_read_b64_tr_b16 v[196:197], v234 offset:16384
    v_mfma_f32_16x16x32_bf16 v[40:43], v[192:195], v[164:167], v[40:43]
    ds_read_b64_tr_b16 v[198:199], v234 offset:20480
    s_waitcnt lgkmcnt(6)
    v_mfma_f32_16x16x32_bf16 v[44:47], v[176:179], v[164:167], v[44:47]
    ds_read_b64_tr_b16 v[192:193], v235 offset:16384
    v_mfma_f32_16x16x32_bf16 v[12:15], v[176:179], v[160:163], v[12:15]
    ds_read_b64_tr_b16 v[194:195], v235 offset:20480
    s_waitcnt lgkmcnt(6)
    v_mfma_f32_16x16x32_bf16 v[16:19], v[180:183], v[160:163], v[16:19]
    v_mfma_f32_16x16x32_bf16 v[48:51], v[180:183], v[164:167], v[48:51]
    s_waitcnt lgkmcnt(4)
    v_mfma_f32_16x16x32_bf16 v[52:55], v[184:187], v[164:167], v[52:55]
    v_mfma_f32_16x16x32_bf16 v[20:23], v[184:187], v[160:163], v[20:23]
    s_waitcnt lgkmcnt(2)
    v_mfma_f32_16x16x32_bf16 v[24:27], v[196:199], v[160:163], v[24:27]
    v_mfma_f32_16x16x32_bf16 v[56:59], v[196:199], v[164:167], v[56:59]
    s_waitcnt lgkmcnt(0)
    s_barrier
    v_mfma_f32_16x16x32_bf16 v[60:63], v[192:195], v[164:167], v[60:63]
    ds_read_b128 v[176:179], v224 offset:32768
    v_mfma_f32_16x16x32_bf16 v[28:31], v[192:195], v[160:163], v[28:31]
    ds_read_b128 v[180:183], v225 offset:32768
    ds_read_b128 v[184:187], v226 offset:32768
    ds_read_b128 v[188:191], v227 offset:32768
    s_setprio 0
.p2align 3
    v_fmamk_f32 v168, v144, 0x3e0293ee, v248
    v_fmamk_f32 v169, v145, 0x3e0293ee, v248
    buffer_store_dwordx4 v[76:79], v244, s[24:27], s34 offen offset:384 sc0 sc1
    v_fmamk_f32 v170, v146, 0x3e0293ee, v248
    v_fmamk_f32 v171, v147, 0x3e0293ee, v248
    v_exp_f32 v168, v168
    v_exp_f32 v169, v169
    v_exp_f32 v170, v170
    v_exp_f32 v171, v171
    v_fmamk_f32 v172, v152, 0x3e0293ee, v249
    v_fmamk_f32 v173, v153, 0x3e0293ee, v249
    v_fmamk_f32 v174, v154, 0x3e0293ee, v249
    v_fmamk_f32 v175, v155, 0x3e0293ee, v249
    v_cvt_pk_bf16_f32 v160, v168, v169
    v_cvt_pk_bf16_f32 v161, v170, v171
    v_exp_f32 v172, v172
    v_exp_f32 v173, v173
    v_exp_f32 v174, v174
    v_exp_f32 v175, v175
    v_fmamk_f32 v168, v148, 0x3e0293ee, v248
    v_fmamk_f32 v169, v149, 0x3e0293ee, v248
    v_fmamk_f32 v170, v150, 0x3e0293ee, v248
    v_fmamk_f32 v171, v151, 0x3e0293ee, v248
    s_setprio 1
    s_nop 0
    v_cvt_pk_bf16_f32 v164, v172, v173
    v_cvt_pk_bf16_f32 v165, v174, v175
    v_exp_f32 v168, v168
    v_exp_f32 v169, v169
    v_exp_f32 v170, v170
    v_exp_f32 v171, v171
    v_fmamk_f32 v172, v156, 0x3e0293ee, v249
    v_fmamk_f32 v173, v157, 0x3e0293ee, v249
    v_fmamk_f32 v174, v158, 0x3e0293ee, v249
    v_fmamk_f32 v175, v159, 0x3e0293ee, v249
    v_cvt_pk_bf16_f32 v162, v168, v169
    v_cvt_pk_bf16_f32 v163, v170, v171
    s_waitcnt vmcnt(2)
    s_nop 0
    ds_read_b128 v[64:67], v236 offset:0
    ds_read_b128 v[68:71], v237 offset:0
    ds_read_b128 v[72:75], v238 offset:0
    ds_read_b128 v[76:79], v239 offset:0
    v_exp_f32 v172, v172
    v_exp_f32 v173, v173
    v_exp_f32 v174, v174
    v_exp_f32 v175, v175
    v_cvt_pk_bf16_f32 v166, v172, v173
    v_cvt_pk_bf16_f32 v167, v174, v175
    s_waitcnt vmcnt(1)
    v_mfma_f32_16x16x32_bf16 v[208:211], v[216:219], v[160:163], v[200:203]
    v_mfma_f32_16x16x32_bf16 v[212:215], v[216:219], v[164:167], v[204:207]
    s_waitcnt lgkmcnt(7)
    v_mfma_f32_16x16x32_bf16 v[128:131], v[176:179], v[96:99], 0
    s_setprio 3
    ds_read_b128 v[192:195], v224 offset:36864
    v_mfma_f32_16x16x32_bf16 v[136:139], v[176:179], v[112:115], 0
    s_waitcnt lgkmcnt(7)
    v_mfma_f32_16x16x32_bf16 v[136:139], v[180:183], v[116:119], v[136:139]
    ds_read_b128 v[196:199], v225 offset:36864
    v_mfma_f32_16x16x32_bf16 v[128:131], v[180:183], v[100:103], v[128:131]
    s_add_u32 m0, s37, 0x12000
    s_xor_b32 s38, s36, 0x1000
    buffer_load_dwordx4 v246, s[20:23], s38 offen offset:0 nt lds
    s_waitcnt lgkmcnt(7)
    v_mfma_f32_16x16x32_bf16 v[128:131], v[184:187], v[104:107], v[128:131]
    ds_read_b128 v[176:179], v226 offset:36864
    v_mfma_f32_16x16x32_bf16 v[136:139], v[184:187], v[120:123], v[136:139]
    v_max_f32_e64 v250, v208, v212
    v_cmp_nle_f32_e64 s[42:43], v250, s40
    s_waitcnt lgkmcnt(7)
    v_mfma_f32_16x16x32_bf16 v[136:139], v[188:191], v[124:127], v[136:139]
    ds_read_b128 v[180:183], v227 offset:36864
    v_mfma_f32_16x16x32_bf16 v[128:131], v[188:191], v[108:111], v[128:131]
    s_cmp_lg_u64 s[42:43], 0
    s_cbranch_scc1 L_stublag9
L_retlag9:
    s_waitcnt lgkmcnt(4)
    s_add_u32 m0, s58, 0x0
    s_nop 0
    buffer_load_dwordx4 v240, s[12:15], s31 offen offset:0 nt lds
    s_waitcnt lgkmcnt(3)
    v_mfma_f32_16x16x32_bf16 v[132:135], v[192:195], v[96:99], 0
    ds_read_b64_tr_b16 v[184:185], v228 offset:24576
    v_mfma_f32_16x16x32_bf16 v[140:143], v[192:195], v[112:115], 0
    ds_read_b64_tr_b16 v[186:187], v228 offset:28672
    s_waitcnt lgkmcnt(4)
    v_mfma_f32_16x16x32_bf16 v[140:143], v[196:199], v[116:119], v[140:143]
    ds_read_b64_tr_b16 v[188:189], v229 offset:24576
    v_mfma_f32_16x16x32_bf16 v[132:135], v[196:199], v[100:103], v[132:135]
    ds_read_b64_tr_b16 v[190:191], v229 offset:28672
    s_waitcnt lgkmcnt(5)
    v_mfma_f32_16x16x32_bf16 v[132:135], v[176:179], v[104:107], v[132:135]
    ds_read_b64_tr_b16 v[192:193], v230 offset:24576
    v_mfma_f32_16x16x32_bf16 v[140:143], v[176:179], v[120:123], v[140:143]
    ds_read_b64_tr_b16 v[194:195], v230 offset:28672
    s_waitcnt lgkmcnt(6)
    v_mfma_f32_16x16x32_bf16 v[140:143], v[180:183], v[124:127], v[140:143]
    ds_read_b64_tr_b16 v[176:177], v231 offset:24576
    v_mfma_f32_16x16x32_bf16 v[132:135], v[180:183], v[108:111], v[132:135]
    ds_read_b64_tr_b16 v[178:179], v231 offset:28672
    s_waitcnt lgkmcnt(6)
    v_mfma_f32_16x16x32_bf16 v[0:3], v[184:187], v[160:163], v[0:3]
    ds_read_b64_tr_b16 v[180:181], v232 offset:24576
    v_mfma_f32_16x16x32_bf16 v[32:35], v[184:187], v[164:167], v[32:35]
    ds_read_b64_tr_b16 v[182:183], v232 offset:28672
    s_waitcnt lgkmcnt(6)
    v_mfma_f32_16x16x32_bf16 v[36:39], v[188:191], v[164:167], v[36:39]
    ds_read_b64_tr_b16 v[184:185], v233 offset:24576
    v_mfma_f32_16x16x32_bf16 v[4:7], v[188:191], v[160:163], v[4:7]
    ds_read_b64_tr_b16 v[186:187], v233 offset:28672
    s_waitcnt lgkmcnt(6)
    v_mfma_f32_16x16x32_bf16 v[8:11], v[192:195], v[160:163], v[8:11]
    ds_read_b64_tr_b16 v[196:197], v234 offset:24576
    v_mfma_f32_16x16x32_bf16 v[40:43], v[192:195], v[164:167], v[40:43]
    ds_read_b64_tr_b16 v[198:199], v234 offset:28672
    s_waitcnt lgkmcnt(6)
    v_mfma_f32_16x16x32_bf16 v[44:47], v[176:179], v[164:167], v[44:47]
    ds_read_b64_tr_b16 v[192:193], v235 offset:24576
    v_mfma_f32_16x16x32_bf16 v[12:15], v[176:179], v[160:163], v[12:15]
    ds_read_b64_tr_b16 v[194:195], v235 offset:28672
    s_waitcnt lgkmcnt(6)
    v_mfma_f32_16x16x32_bf16 v[16:19], v[180:183], v[160:163], v[16:19]
    v_mfma_f32_16x16x32_bf16 v[48:51], v[180:183], v[164:167], v[48:51]
    s_waitcnt lgkmcnt(4)
    v_mfma_f32_16x16x32_bf16 v[52:55], v[184:187], v[164:167], v[52:55]
    v_mfma_f32_16x16x32_bf16 v[20:23], v[184:187], v[160:163], v[20:23]
    s_waitcnt lgkmcnt(2)
    v_mfma_f32_16x16x32_bf16 v[24:27], v[196:199], v[160:163], v[24:27]
    v_mfma_f32_16x16x32_bf16 v[56:59], v[196:199], v[164:167], v[56:59]
    s_waitcnt lgkmcnt(0)
    s_barrier
    v_mfma_f32_16x16x32_bf16 v[60:63], v[192:195], v[164:167], v[60:63]
    ds_read_b128 v[176:179], v224 offset:40960
    v_mfma_f32_16x16x32_bf16 v[28:31], v[192:195], v[160:163], v[28:31]
    ds_read_b128 v[180:183], v225 offset:40960
    ds_read_b128 v[184:187], v226 offset:40960
    ds_read_b128 v[188:191], v227 offset:40960
    s_setprio 0
.p2align 3
    v_fmamk_f32 v168, v128, 0x3e0293ee, v248
    v_fmamk_f32 v169, v129, 0x3e0293ee, v248
    buffer_store_dwordx4 v[220:223], v244, s[24:27], s34 offen offset:0 sc0 sc1
    v_fmamk_f32 v170, v130, 0x3e0293ee, v248
    v_fmamk_f32 v171, v131, 0x3e0293ee, v248
    v_exp_f32 v168, v168
    v_exp_f32 v169, v169
    v_exp_f32 v170, v170
    v_exp_f32 v171, v171
    v_fmamk_f32 v172, v136, 0x3e0293ee, v249
    v_fmamk_f32 v173, v137, 0x3e0293ee, v249
    v_fmamk_f32 v174, v138, 0x3e0293ee, v249
    v_fmamk_f32 v175, v139, 0x3e0293ee, v249
    v_cvt_pk_bf16_f32 v160, v168, v169
    v_cvt_pk_bf16_f32 v161, v170, v171
    v_exp_f32 v172, v172
    v_exp_f32 v173, v173
    v_exp_f32 v174, v174
    v_exp_f32 v175, v175
    v_fmamk_f32 v168, v132, 0x3e0293ee, v248
    v_fmamk_f32 v169, v133, 0x3e0293ee, v248
    v_fmamk_f32 v170, v134, 0x3e0293ee, v248
    v_fmamk_f32 v171, v135, 0x3e0293ee, v248
    s_setprio 1
    s_nop 0
    v_cvt_pk_bf16_f32 v164, v172, v173
    v_cvt_pk_bf16_f32 v165, v174, v175
    v_exp_f32 v168, v168
    v_exp_f32 v169, v169
    v_exp_f32 v170, v170
    v_exp_f32 v171, v171
    v_fmamk_f32 v172, v140, 0x3e0293ee, v249
    v_fmamk_f32 v173, v141, 0x3e0293ee, v249
    v_fmamk_f32 v174, v142, 0x3e0293ee, v249
    v_fmamk_f32 v175, v143, 0x3e0293ee, v249
    v_cvt_pk_bf16_f32 v162, v168, v169
    v_cvt_pk_bf16_f32 v163, v170, v171
    v_exp_f32 v172, v172
    v_exp_f32 v173, v173
    v_exp_f32 v174, v174
    v_exp_f32 v175, v175
    v_cvt_pk_bf16_f32 v166, v172, v173
    v_cvt_pk_bf16_f32 v167, v174, v175
    s_waitcnt vmcnt(1)
    v_mfma_f32_16x16x32_bf16 v[200:203], v[216:219], v[160:163], v[208:211]
    v_mfma_f32_16x16x32_bf16 v[204:207], v[216:219], v[164:167], v[212:215]
    s_waitcnt lgkmcnt(3)
    v_mfma_f32_16x16x32_bf16 v[144:147], v[176:179], v[96:99], 0
    s_setprio 3
    ds_read_b128 v[192:195], v224 offset:45056
    v_mfma_f32_16x16x32_bf16 v[152:155], v[176:179], v[112:115], 0
    s_waitcnt lgkmcnt(3)
    v_mfma_f32_16x16x32_bf16 v[152:155], v[180:183], v[116:119], v[152:155]
    ds_read_b128 v[196:199], v225 offset:45056
    v_mfma_f32_16x16x32_bf16 v[144:147], v[180:183], v[100:103], v[144:147]
    s_add_u32 m0, s58, 0x400
    s_nop 0
    buffer_load_dwordx4 v241, s[12:15], s31 offen offset:0 nt lds
    s_waitcnt lgkmcnt(3)
    v_mfma_f32_16x16x32_bf16 v[144:147], v[184:187], v[104:107], v[144:147]
    ds_read_b128 v[176:179], v226 offset:45056
    v_mfma_f32_16x16x32_bf16 v[152:155], v[184:187], v[120:123], v[152:155]
    v_max_f32_e64 v250, v200, v204
    v_cmp_nle_f32_e64 s[42:43], v250, s40
    s_waitcnt lgkmcnt(3)
    v_mfma_f32_16x16x32_bf16 v[152:155], v[188:191], v[124:127], v[152:155]
    ds_read_b128 v[180:183], v227 offset:45056
    v_mfma_f32_16x16x32_bf16 v[144:147], v[188:191], v[108:111], v[144:147]
    s_cmp_lg_u64 s[42:43], 0
    s_cbranch_scc1 L_stublag10
L_retlag10:
    s_add_u32 m0, s37, 0x6000
    s_xor_b32 s38, s36, 0x3000
    buffer_load_dwordx4 v245, s[16:19], s38 offen offset:0 nt lds
    s_waitcnt lgkmcnt(3)
    v_mfma_f32_16x16x32_bf16 v[148:151], v[192:195], v[96:99], 0
    ds_read_b64_tr_b16 v[184:185], v228 offset:32768
    v_mfma_f32_16x16x32_bf16 v[156:159], v[192:195], v[112:115], 0
    ds_read_b64_tr_b16 v[186:187], v228 offset:36864
    s_waitcnt lgkmcnt(4)
    v_mfma_f32_16x16x32_bf16 v[156:159], v[196:199], v[116:119], v[156:159]
    ds_read_b64_tr_b16 v[188:189], v229 offset:32768
    v_mfma_f32_16x16x32_bf16 v[148:151], v[196:199], v[100:103], v[148:151]
    ds_read_b64_tr_b16 v[190:191], v229 offset:36864
    s_waitcnt lgkmcnt(5)
    v_mfma_f32_16x16x32_bf16 v[148:151], v[176:179], v[104:107], v[148:151]
    ds_read_b64_tr_b16 v[192:193], v230 offset:32768
    v_mfma_f32_16x16x32_bf16 v[156:159], v[176:179], v[120:123], v[156:159]
    ds_read_b64_tr_b16 v[194:195], v230 offset:36864
    s_waitcnt lgkmcnt(6)
    v_mfma_f32_16x16x32_bf16 v[156:159], v[180:183], v[124:127], v[156:159]
    ds_read_b64_tr_b16 v[176:177], v231 offset:32768
    v_mfma_f32_16x16x32_bf16 v[148:151], v[180:183], v[108:111], v[148:151]
    ds_read_b64_tr_b16 v[178:179], v231 offset:36864
    s_waitcnt lgkmcnt(6)
    v_mfma_f32_16x16x32_bf16 v[0:3], v[184:187], v[160:163], v[0:3]
    ds_read_b64_tr_b16 v[180:181], v232 offset:32768
    v_mfma_f32_16x16x32_bf16 v[32:35], v[184:187], v[164:167], v[32:35]
    ds_read_b64_tr_b16 v[182:183], v232 offset:36864
    s_waitcnt lgkmcnt(6)
    v_mfma_f32_16x16x32_bf16 v[36:39], v[188:191], v[164:167], v[36:39]
    ds_read_b64_tr_b16 v[184:185], v233 offset:32768
    v_mfma_f32_16x16x32_bf16 v[4:7], v[188:191], v[160:163], v[4:7]
    ds_read_b64_tr_b16 v[186:187], v233 offset:36864
    s_waitcnt lgkmcnt(6)
    v_mfma_f32_16x16x32_bf16 v[8:11], v[192:195], v[160:163], v[8:11]
    ds_read_b64_tr_b16 v[196:197], v234 offset:32768
    v_mfma_f32_16x16x32_bf16 v[40:43], v[192:195], v[164:167], v[40:43]
    ds_read_b64_tr_b16 v[198:199], v234 offset:36864
    s_waitcnt lgkmcnt(6)
    v_mfma_f32_16x16x32_bf16 v[44:47], v[176:179], v[164:167], v[44:47]
    ds_read_b64_tr_b16 v[192:193], v235 offset:32768
    v_mfma_f32_16x16x32_bf16 v[12:15], v[176:179], v[160:163], v[12:15]
    ds_read_b64_tr_b16 v[194:195], v235 offset:36864
    s_waitcnt lgkmcnt(6)
    v_mfma_f32_16x16x32_bf16 v[16:19], v[180:183], v[160:163], v[16:19]
    v_mfma_f32_16x16x32_bf16 v[48:51], v[180:183], v[164:167], v[48:51]
    s_waitcnt lgkmcnt(4)
    v_mfma_f32_16x16x32_bf16 v[52:55], v[184:187], v[164:167], v[52:55]
    v_mfma_f32_16x16x32_bf16 v[20:23], v[184:187], v[160:163], v[20:23]
    s_waitcnt lgkmcnt(2)
    v_mfma_f32_16x16x32_bf16 v[24:27], v[196:199], v[160:163], v[24:27]
    v_mfma_f32_16x16x32_bf16 v[56:59], v[196:199], v[164:167], v[56:59]
    s_waitcnt lgkmcnt(0)
    s_barrier
    v_mfma_f32_16x16x32_bf16 v[60:63], v[192:195], v[164:167], v[60:63]
    ds_read_b128 v[176:179], v224 offset:49152
    v_mfma_f32_16x16x32_bf16 v[28:31], v[192:195], v[160:163], v[28:31]
    ds_read_b128 v[180:183], v225 offset:49152
    ds_read_b128 v[184:187], v226 offset:49152
    ds_read_b128 v[188:191], v227 offset:49152
    s_setprio 0
.p2align 3
    v_fmamk_f32 v168, v144, 0x3e0293ee, v248
    v_fmamk_f32 v169, v145, 0x3e0293ee, v248
    v_permlane16_swap_b32 v80, v82
    v_permlane16_swap_b32 v81, v83
    v_fmamk_f32 v170, v146, 0x3e0293ee, v248
    v_fmamk_f32 v171, v147, 0x3e0293ee, v248
    v_exp_f32 v168, v168
    v_exp_f32 v169, v169
    v_permlane16_swap_b32 v84, v86
    v_permlane16_swap_b32 v85, v87
    v_exp_f32 v170, v170
    v_exp_f32 v171, v171
    v_fmamk_f32 v172, v152, 0x3e0293ee, v249
    v_fmamk_f32 v173, v153, 0x3e0293ee, v249
    v_cndmask_b32_dpp v220, v84, v80, vcc quad_perm:[1,0,3,2] row_mask:0xf bank_mask:0xf
    v_cndmask_b32_dpp v221, v85, v81, vcc quad_perm:[1,0,3,2] row_mask:0xf bank_mask:0xf
    v_fmamk_f32 v174, v154, 0x3e0293ee, v249
    v_fmamk_f32 v175, v155, 0x3e0293ee, v249
    v_cvt_pk_bf16_f32 v160, v168, v169
    v_cvt_pk_bf16_f32 v161, v170, v171
    v_cndmask_b32_dpp v222, v86, v82, vcc quad_perm:[1,0,3,2] row_mask:0xf bank_mask:0xf
    v_cndmask_b32_dpp v223, v87, v83, vcc quad_perm:[1,0,3,2] row_mask:0xf bank_mask:0xf
    s_not_b64 vcc, vcc
    s_nop 0
    v_exp_f32 v172, v172
    v_exp_f32 v173, v173
    v_exp_f32 v174, v174
    v_exp_f32 v175, v175
    v_cndmask_b32_dpp v84, v80, v84, vcc quad_perm:[1,0,3,2] row_mask:0xf bank_mask:0xf
    v_cndmask_b32_dpp v85, v81, v85, vcc quad_perm:[1,0,3,2] row_mask:0xf bank_mask:0xf
    v_fmamk_f32 v168, v148, 0x3e0293ee, v248
    v_fmamk_f32 v169, v149, 0x3e0293ee, v248
    v_fmamk_f32 v170, v150, 0x3e0293ee, v248
    v_fmamk_f32 v171, v151, 0x3e0293ee, v248
    s_setprio 1
    s_nop 0
    v_cndmask_b32_dpp v86, v82, v86, vcc quad_perm:[1,0,3,2] row_mask:0xf bank_mask:0xf
    v_cndmask_b32_dpp v87, v83, v87, vcc quad_perm:[1,0,3,2] row_mask:0xf bank_mask:0xf
    s_not_b64 vcc, vcc
    s_nop 0
    v_cvt_pk_bf16_f32 v164, v172, v173
    v_cvt_pk_bf16_f32 v165, v174, v175
    v_exp_f32 v168, v168
    v_exp_f32 v169, v169
    buffer_store_dwordx4 v[84:87], v244, s[24:27], s35 offen offset:256 sc0 sc1
    v_exp_f32 v170, v170
    v_exp_f32 v171, v171
    v_fmamk_f32 v172, v156, 0x3e0293ee, v249
    v_fmamk_f32 v173, v157, 0x3e0293ee, v249
    v_fmamk_f32 v174, v158, 0x3e0293ee, v249
    v_fmamk_f32 v175, v159, 0x3e0293ee, v249
    v_cvt_pk_bf16_f32 v162, v168, v169
    v_cvt_pk_bf16_f32 v163, v170, v171
    v_exp_f32 v172, v172
    v_exp_f32 v173, v173
    v_exp_f32 v174, v174
    v_exp_f32 v175, v175
    v_cvt_pk_bf16_f32 v166, v172, v173
    v_cvt_pk_bf16_f32 v167, v174, v175
    s_waitcnt vmcnt(1)
    v_mfma_f32_16x16x32_bf16 v[208:211], v[216:219], v[160:163], v[200:203]
    v_mfma_f32_16x16x32_bf16 v[212:215], v[216:219], v[164:167], v[204:207]
    s_waitcnt lgkmcnt(3)
    v_mfma_f32_16x16x32_bf16 v[128:131], v[176:179], v[96:99], 0
    s_setprio 3
    ds_read_b128 v[192:195], v224 offset:53248
    v_mfma_f32_16x16x32_bf16 v[136:139], v[176:179], v[112:115], 0
    s_waitcnt lgkmcnt(3)
    v_mfma_f32_16x16x32_bf16 v[136:139], v[180:183], v[116:119], v[136:139]
    ds_read_b128 v[196:199], v225 offset:53248
    v_mfma_f32_16x16x32_bf16 v[128:131], v[180:183], v[100:103], v[128:131]
    s_add_u32 m0, s58, 0x800
    s_nop 0
    buffer_load_dwordx4 v242, s[12:15], s31 offen offset:0 nt lds
    s_waitcnt lgkmcnt(3)
    v_mfma_f32_16x16x32_bf16 v[128:131], v[184:187], v[104:107], v[128:131]
    ds_read_b128 v[176:179], v226 offset:53248
    v_mfma_f32_16x16x32_bf16 v[136:139], v[184:187], v[120:123], v[136:139]
    v_max_f32_e64 v250, v208, v212
    v_cmp_nle_f32_e64 s[42:43], v250, s40
    s_waitcnt lgkmcnt(3)
    v_mfma_f32_16x16x32_bf16 v[136:139], v[188:191], v[124:127], v[136:139]
    ds_read_b128 v[180:183], v227 offset:53248
    v_mfma_f32_16x16x32_bf16 v[128:131], v[188:191], v[108:111], v[128:131]
    s_cmp_lg_u64 s[42:43], 0
    s_cbranch_scc1 L_stublag11
L_retlag11:
    s_add_u32 m0, s37, 0x14000
    s_xor_b32 s38, s36, 0x2000
    buffer_load_dwordx4 v246, s[20:23], s38 offen offset:0 nt lds
    s_waitcnt lgkmcnt(3)
    v_mfma_f32_16x16x32_bf16 v[132:135], v[192:195], v[96:99], 0
    ds_read_b64_tr_b16 v[184:185], v228 offset:40960
    v_mfma_f32_16x16x32_bf16 v[140:143], v[192:195], v[112:115], 0
    ds_read_b64_tr_b16 v[186:187], v228 offset:45056
    s_waitcnt lgkmcnt(4)
    v_mfma_f32_16x16x32_bf16 v[140:143], v[196:199], v[116:119], v[140:143]
    ds_read_b64_tr_b16 v[188:189], v229 offset:40960
    v_mfma_f32_16x16x32_bf16 v[132:135], v[196:199], v[100:103], v[132:135]
    ds_read_b64_tr_b16 v[190:191], v229 offset:45056
    s_waitcnt lgkmcnt(5)
    v_mfma_f32_16x16x32_bf16 v[132:135], v[176:179], v[104:107], v[132:135]
    ds_read_b64_tr_b16 v[192:193], v230 offset:40960
    v_mfma_f32_16x16x32_bf16 v[140:143], v[176:179], v[120:123], v[140:143]
    ds_read_b64_tr_b16 v[194:195], v230 offset:45056
    s_waitcnt lgkmcnt(6)
    v_mfma_f32_16x16x32_bf16 v[140:143], v[180:183], v[124:127], v[140:143]
    ds_read_b64_tr_b16 v[176:177], v231 offset:40960
    v_mfma_f32_16x16x32_bf16 v[132:135], v[180:183], v[108:111], v[132:135]
    ds_read_b64_tr_b16 v[178:179], v231 offset:45056
    s_waitcnt lgkmcnt(6)
    v_mfma_f32_16x16x32_bf16 v[0:3], v[184:187], v[160:163], v[0:3]
    ds_read_b64_tr_b16 v[180:181], v232 offset:40960
    v_mfma_f32_16x16x32_bf16 v[32:35], v[184:187], v[164:167], v[32:35]
    ds_read_b64_tr_b16 v[182:183], v232 offset:45056
    s_waitcnt lgkmcnt(6)
    v_mfma_f32_16x16x32_bf16 v[36:39], v[188:191], v[164:167], v[36:39]
    ds_read_b64_tr_b16 v[184:185], v233 offset:40960
    v_mfma_f32_16x16x32_bf16 v[4:7], v[188:191], v[160:163], v[4:7]
    ds_read_b64_tr_b16 v[186:187], v233 offset:45056
    s_waitcnt lgkmcnt(6)
    v_mfma_f32_16x16x32_bf16 v[8:11], v[192:195], v[160:163], v[8:11]
    ds_read_b64_tr_b16 v[196:197], v234 offset:40960
    v_mfma_f32_16x16x32_bf16 v[40:43], v[192:195], v[164:167], v[40:43]
    ds_read_b64_tr_b16 v[198:199], v234 offset:45056
    s_waitcnt lgkmcnt(6)
    v_mfma_f32_16x16x32_bf16 v[44:47], v[176:179], v[164:167], v[44:47]
    ds_read_b64_tr_b16 v[192:193], v235 offset:40960
    v_mfma_f32_16x16x32_bf16 v[12:15], v[176:179], v[160:163], v[12:15]
    ds_read_b64_tr_b16 v[194:195], v235 offset:45056
    s_waitcnt lgkmcnt(6)
    v_mfma_f32_16x16x32_bf16 v[16:19], v[180:183], v[160:163], v[16:19]
    v_mfma_f32_16x16x32_bf16 v[48:51], v[180:183], v[164:167], v[48:51]
    s_waitcnt lgkmcnt(4)
    v_mfma_f32_16x16x32_bf16 v[52:55], v[184:187], v[164:167], v[52:55]
    v_mfma_f32_16x16x32_bf16 v[20:23], v[184:187], v[160:163], v[20:23]
    s_waitcnt lgkmcnt(2)
    v_mfma_f32_16x16x32_bf16 v[24:27], v[196:199], v[160:163], v[24:27]
    v_mfma_f32_16x16x32_bf16 v[56:59], v[196:199], v[164:167], v[56:59]
    s_waitcnt lgkmcnt(0)
    s_waitcnt vmcnt(15)
    s_barrier
    v_mfma_f32_16x16x32_bf16 v[60:63], v[192:195], v[164:167], v[60:63]
    ds_read_b128 v[176:179], v224 offset:57344
    v_mfma_f32_16x16x32_bf16 v[28:31], v[192:195], v[160:163], v[28:31]
    ds_read_b128 v[180:183], v225 offset:57344
    ds_read_b128 v[184:187], v226 offset:57344
    ds_read_b128 v[188:191], v227 offset:57344
    s_setprio 0
.p2align 3
    v_fmamk_f32 v168, v128, 0x3e0293ee, v248
    v_fmamk_f32 v169, v129, 0x3e0293ee, v248
    v_permlane16_swap_b32 v88, v90
    v_permlane16_swap_b32 v89, v91
    v_fmamk_f32 v170, v130, 0x3e0293ee, v248
    v_fmamk_f32 v171, v131, 0x3e0293ee, v248
    v_exp_f32 v168, v168
    v_exp_f32 v169, v169
    v_permlane16_swap_b32 v92, v94
    v_permlane16_swap_b32 v93, v95
    v_exp_f32 v170, v170
    v_exp_f32 v171, v171
    v_fmamk_f32 v172, v136, 0x3e0293ee, v249
    v_fmamk_f32 v173, v137, 0x3e0293ee, v249
    v_cndmask_b32_dpp v80, v92, v88, vcc quad_perm:[1,0,3,2] row_mask:0xf bank_mask:0xf
    v_cndmask_b32_dpp v81, v93, v89, vcc quad_perm:[1,0,3,2] row_mask:0xf bank_mask:0xf
    v_fmamk_f32 v174, v138, 0x3e0293ee, v249
    v_fmamk_f32 v175, v139, 0x3e0293ee, v249
    v_cvt_pk_bf16_f32 v160, v168, v169
    v_cvt_pk_bf16_f32 v161, v170, v171
    v_cndmask_b32_dpp v82, v94, v90, vcc quad_perm:[1,0,3,2] row_mask:0xf bank_mask:0xf
    v_cndmask_b32_dpp v83, v95, v91, vcc quad_perm:[1,0,3,2] row_mask:0xf bank_mask:0xf
    s_not_b64 vcc, vcc
    s_nop 0
    v_exp_f32 v172, v172
    v_exp_f32 v173, v173
    v_exp_f32 v174, v174
    v_exp_f32 v175, v175
    v_cndmask_b32_dpp v92, v88, v92, vcc quad_perm:[1,0,3,2] row_mask:0xf bank_mask:0xf
    v_cndmask_b32_dpp v93, v89, v93, vcc quad_perm:[1,0,3,2] row_mask:0xf bank_mask:0xf
    v_fmamk_f32 v168, v132, 0x3e0293ee, v248
    v_fmamk_f32 v169, v133, 0x3e0293ee, v248
    v_fmamk_f32 v170, v134, 0x3e0293ee, v248
    v_fmamk_f32 v171, v135, 0x3e0293ee, v248
    s_setprio 1
    s_nop 0
    v_cndmask_b32_dpp v94, v90, v94, vcc quad_perm:[1,0,3,2] row_mask:0xf bank_mask:0xf
    v_cndmask_b32_dpp v95, v91, v95, vcc quad_perm:[1,0,3,2] row_mask:0xf bank_mask:0xf
    s_not_b64 vcc, vcc
    s_nop 0
    v_cvt_pk_bf16_f32 v164, v172, v173
    v_cvt_pk_bf16_f32 v165, v174, v175
    v_exp_f32 v168, v168
    v_exp_f32 v169, v169
    buffer_store_dwordx4 v[80:83], v244, s[24:27], s35 offen offset:128 sc0 sc1
    v_exp_f32 v170, v170
    v_exp_f32 v171, v171
    v_fmamk_f32 v172, v140, 0x3e0293ee, v249
    v_fmamk_f32 v173, v141, 0x3e0293ee, v249
    v_fmamk_f32 v174, v142, 0x3e0293ee, v249
    v_fmamk_f32 v175, v143, 0x3e0293ee, v249
    v_cvt_pk_bf16_f32 v162, v168, v169
    v_cvt_pk_bf16_f32 v163, v170, v171
    v_exp_f32 v172, v172
    v_exp_f32 v173, v173
    v_exp_f32 v174, v174
    v_exp_f32 v175, v175
    v_cvt_pk_bf16_f32 v166, v172, v173
    v_cvt_pk_bf16_f32 v167, v174, v175
    s_waitcnt vmcnt(1)
    v_mfma_f32_16x16x32_bf16 v[200:203], v[216:219], v[160:163], v[208:211]
    v_mfma_f32_16x16x32_bf16 v[204:207], v[216:219], v[164:167], v[212:215]
    s_waitcnt lgkmcnt(3)
    v_mfma_f32_16x16x32_bf16 v[144:147], v[176:179], v[96:99], 0
    s_setprio 3
    ds_read_b128 v[192:195], v224 offset:61440
    v_mfma_f32_16x16x32_bf16 v[152:155], v[176:179], v[112:115], 0
    s_waitcnt lgkmcnt(3)
    v_mfma_f32_16x16x32_bf16 v[152:155], v[180:183], v[116:119], v[152:155]
    ds_read_b128 v[196:199], v225 offset:61440
    v_mfma_f32_16x16x32_bf16 v[144:147], v[180:183], v[100:103], v[144:147]
    s_add_u32 m0, s58, 0xc00
    s_nop 0
    buffer_load_dwordx4 v243, s[12:15], s31 offen offset:0 nt lds
    s_waitcnt lgkmcnt(3)
    v_mfma_f32_16x16x32_bf16 v[144:147], v[184:187], v[104:107], v[144:147]
    ds_read_b128 v[176:179], v226 offset:61440
    v_mfma_f32_16x16x32_bf16 v[152:155], v[184:187], v[120:123], v[152:155]
    v_max_f32_e64 v250, v200, v204
    v_cmp_nle_f32_e64 s[42:43], v250, s40
    s_waitcnt lgkmcnt(3)
    v_mfma_f32_16x16x32_bf16 v[152:155], v[188:191], v[124:127], v[152:155]
    ds_read_b128 v[180:183], v227 offset:61440
    v_mfma_f32_16x16x32_bf16 v[144:147], v[188:191], v[108:111], v[144:147]
    s_cmp_lg_u64 s[42:43], 0
    s_cbranch_scc1 L_stublag12
L_retlag12:
    s_add_u32 m0, s37, 0x8000
    s_xor_b32 s38, s36, 0x4000
    buffer_load_dwordx4 v245, s[16:19], s38 offen offset:0 nt lds
    s_waitcnt lgkmcnt(3)
    v_mfma_f32_16x16x32_bf16 v[148:151], v[192:195], v[96:99], 0
    ds_read_b64_tr_b16 v[184:185], v228 offset:49152
    v_mfma_f32_16x16x32_bf16 v[156:159], v[192:195], v[112:115], 0
    ds_read_b64_tr_b16 v[186:187], v228 offset:53248
    s_waitcnt lgkmcnt(4)
    v_mfma_f32_16x16x32_bf16 v[156:159], v[196:199], v[116:119], v[156:159]
    ds_read_b64_tr_b16 v[188:189], v229 offset:49152
    v_mfma_f32_16x16x32_bf16 v[148:151], v[196:199], v[100:103], v[148:151]
    ds_read_b64_tr_b16 v[190:191], v229 offset:53248
    s_waitcnt lgkmcnt(5)
    v_mfma_f32_16x16x32_bf16 v[148:151], v[176:179], v[104:107], v[148:151]
    ds_read_b64_tr_b16 v[192:193], v230 offset:49152
    v_mfma_f32_16x16x32_bf16 v[156:159], v[176:179], v[120:123], v[156:159]
    ds_read_b64_tr_b16 v[194:195], v230 offset:53248
    s_waitcnt lgkmcnt(6)
    v_mfma_f32_16x16x32_bf16 v[156:159], v[180:183], v[124:127], v[156:159]
    ds_read_b64_tr_b16 v[176:177], v231 offset:49152
    v_mfma_f32_16x16x32_bf16 v[148:151], v[180:183], v[108:111], v[148:151]
    ds_read_b64_tr_b16 v[178:179], v231 offset:53248
    s_waitcnt lgkmcnt(6)
    v_mfma_f32_16x16x32_bf16 v[0:3], v[184:187], v[160:163], v[0:3]
    ds_read_b64_tr_b16 v[180:181], v232 offset:49152
    v_mfma_f32_16x16x32_bf16 v[32:35], v[184:187], v[164:167], v[32:35]
    ds_read_b64_tr_b16 v[182:183], v232 offset:53248
    s_waitcnt lgkmcnt(6)
    v_mfma_f32_16x16x32_bf16 v[36:39], v[188:191], v[164:167], v[36:39]
    ds_read_b64_tr_b16 v[184:185], v233 offset:49152
    v_mfma_f32_16x16x32_bf16 v[4:7], v[188:191], v[160:163], v[4:7]
    ds_read_b64_tr_b16 v[186:187], v233 offset:53248
    s_waitcnt lgkmcnt(6)
    v_mfma_f32_16x16x32_bf16 v[8:11], v[192:195], v[160:163], v[8:11]
    ds_read_b64_tr_b16 v[196:197], v234 offset:49152
    v_mfma_f32_16x16x32_bf16 v[40:43], v[192:195], v[164:167], v[40:43]
    ds_read_b64_tr_b16 v[198:199], v234 offset:53248
    s_waitcnt lgkmcnt(6)
    v_mfma_f32_16x16x32_bf16 v[44:47], v[176:179], v[164:167], v[44:47]
    ds_read_b64_tr_b16 v[192:193], v235 offset:49152
    v_mfma_f32_16x16x32_bf16 v[12:15], v[176:179], v[160:163], v[12:15]
    ds_read_b64_tr_b16 v[194:195], v235 offset:53248
    s_waitcnt lgkmcnt(6)
    v_mfma_f32_16x16x32_bf16 v[16:19], v[180:183], v[160:163], v[16:19]
    v_mfma_f32_16x16x32_bf16 v[48:51], v[180:183], v[164:167], v[48:51]
    s_waitcnt lgkmcnt(4)
    v_mfma_f32_16x16x32_bf16 v[52:55], v[184:187], v[164:167], v[52:55]
    v_mfma_f32_16x16x32_bf16 v[20:23], v[184:187], v[160:163], v[20:23]
    s_waitcnt lgkmcnt(2)
    v_mfma_f32_16x16x32_bf16 v[24:27], v[196:199], v[160:163], v[24:27]
    v_mfma_f32_16x16x32_bf16 v[56:59], v[196:199], v[164:167], v[56:59]
    s_waitcnt lgkmcnt(0)
    s_waitcnt vmcnt(16)
    s_barrier
    v_mfma_f32_16x16x32_bf16 v[60:63], v[192:195], v[164:167], v[60:63]
    ds_read_b128 v[176:179], v224 offset:0
    v_mfma_f32_16x16x32_bf16 v[28:31], v[192:195], v[160:163], v[28:31]
    ds_read_b128 v[180:183], v225 offset:0
    ds_read_b128 v[184:187], v226 offset:0
    ds_read_b128 v[188:191], v227 offset:0
    s_setprio 0
.p2align 3
    v_fmamk_f32 v168, v144, 0x3e0293ee, v248
    v_fmamk_f32 v169, v145, 0x3e0293ee, v248
    buffer_store_dwordx4 v[92:95], v244, s[24:27], s35 offen offset:384 sc0 sc1
    v_fmamk_f32 v170, v146, 0x3e0293ee, v248
    v_fmamk_f32 v171, v147, 0x3e0293ee, v248
    v_exp_f32 v168, v168
    v_exp_f32 v169, v169
    v_exp_f32 v170, v170
    v_exp_f32 v171, v171
    v_fmamk_f32 v172, v152, 0x3e0293ee, v249
    v_fmamk_f32 v173, v153, 0x3e0293ee, v249
    v_fmamk_f32 v174, v154, 0x3e0293ee, v249
    v_fmamk_f32 v175, v155, 0x3e0293ee, v249
    v_cvt_pk_bf16_f32 v160, v168, v169
    v_cvt_pk_bf16_f32 v161, v170, v171
    v_exp_f32 v172, v172
    v_exp_f32 v173, v173
    v_exp_f32 v174, v174
    v_exp_f32 v175, v175
    v_fmamk_f32 v168, v148, 0x3e0293ee, v248
    v_fmamk_f32 v169, v149, 0x3e0293ee, v248
    v_fmamk_f32 v170, v150, 0x3e0293ee, v248
    v_fmamk_f32 v171, v151, 0x3e0293ee, v248
    s_setprio 1
    s_nop 0
    v_cvt_pk_bf16_f32 v164, v172, v173
    v_cvt_pk_bf16_f32 v165, v174, v175
    v_exp_f32 v168, v168
    v_exp_f32 v169, v169
    v_exp_f32 v170, v170
    v_exp_f32 v171, v171
    v_fmamk_f32 v172, v156, 0x3e0293ee, v249
    v_fmamk_f32 v173, v157, 0x3e0293ee, v249
    v_fmamk_f32 v174, v158, 0x3e0293ee, v249
    v_fmamk_f32 v175, v159, 0x3e0293ee, v249
    v_cvt_pk_bf16_f32 v162, v168, v169
    v_cvt_pk_bf16_f32 v163, v170, v171
    s_waitcnt vmcnt(2)
    s_nop 0
    ds_read_b128 v[80:83], v236 offset:0
    ds_read_b128 v[84:87], v237 offset:0
    ds_read_b128 v[88:91], v238 offset:0
    ds_read_b128 v[92:95], v239 offset:0
    v_exp_f32 v172, v172
    v_exp_f32 v173, v173
    v_exp_f32 v174, v174
    v_exp_f32 v175, v175
    v_cvt_pk_bf16_f32 v166, v172, v173
    v_cvt_pk_bf16_f32 v167, v174, v175
    s_waitcnt vmcnt(1)
    v_mfma_f32_16x16x32_bf16 v[208:211], v[216:219], v[160:163], v[200:203]
    v_mfma_f32_16x16x32_bf16 v[212:215], v[216:219], v[164:167], v[204:207]
    s_waitcnt lgkmcnt(7)
    v_mfma_f32_16x16x32_bf16 v[128:131], v[176:179], v[64:67], 0
    s_setprio 3
    ds_read_b128 v[192:195], v224 offset:4096
    s_waitcnt lgkmcnt(4)
    v_mfma_f32_16x16x32_bf16 v[136:139], v[176:179], v[80:83], 0
    s_waitcnt lgkmcnt(3)
    v_mfma_f32_16x16x32_bf16 v[136:139], v[180:183], v[84:87], v[136:139]
    ds_read_b128 v[196:199], v225 offset:4096
    v_mfma_f32_16x16x32_bf16 v[128:131], v[180:183], v[68:71], v[128:131]
    s_add_u32 m0, s37, 0xa000
    s_xor_b32 s38, s36, 0x5000
    buffer_load_dwordx4 v245, s[16:19], s38 offen offset:0 nt lds
    v_mfma_f32_16x16x32_bf16 v[128:131], v[184:187], v[72:75], v[128:131]
    ds_read_b128 v[176:179], v226 offset:4096
    s_waitcnt lgkmcnt(4)
    v_mfma_f32_16x16x32_bf16 v[136:139], v[184:187], v[88:91], v[136:139]
    v_max_f32_e64 v250, v208, v212
    v_cmp_nle_f32_e64 s[42:43], v250, s40
    s_waitcnt lgkmcnt(3)
    v_mfma_f32_16x16x32_bf16 v[136:139], v[188:191], v[92:95], v[136:139]
    ds_read_b128 v[180:183], v227 offset:4096
    v_mfma_f32_16x16x32_bf16 v[128:131], v[188:191], v[76:79], v[128:131]
    s_cmp_lg_u64 s[42:43], 0
    s_cbranch_scc1 L_stublag13
L_retlag13:
    s_add_u32 m0, s58, 0x0
    s_add_u32 s38, s32, 0x2000000
    buffer_load_dwordx4 v240, s[12:15], s38 offen offset:0 nt lds
    s_waitcnt lgkmcnt(3)
    v_mfma_f32_16x16x32_bf16 v[132:135], v[192:195], v[64:67], 0
    ds_read_b64_tr_b16 v[184:185], v228 offset:57344
    v_mfma_f32_16x16x32_bf16 v[140:143], v[192:195], v[80:83], 0
    ds_read_b64_tr_b16 v[186:187], v228 offset:61440
    s_waitcnt lgkmcnt(4)
    v_mfma_f32_16x16x32_bf16 v[140:143], v[196:199], v[84:87], v[140:143]
    ds_read_b64_tr_b16 v[188:189], v229 offset:57344
    v_mfma_f32_16x16x32_bf16 v[132:135], v[196:199], v[68:71], v[132:135]
    ds_read_b64_tr_b16 v[190:191], v229 offset:61440
    s_waitcnt lgkmcnt(5)
    v_mfma_f32_16x16x32_bf16 v[132:135], v[176:179], v[72:75], v[132:135]
    ds_read_b64_tr_b16 v[192:193], v230 offset:57344
    v_mfma_f32_16x16x32_bf16 v[140:143], v[176:179], v[88:91], v[140:143]
    ds_read_b64_tr_b16 v[194:195], v230 offset:61440
    s_waitcnt lgkmcnt(6)
    v_mfma_f32_16x16x32_bf16 v[140:143], v[180:183], v[92:95], v[140:143]
    ds_read_b64_tr_b16 v[176:177], v231 offset:57344
    v_mfma_f32_16x16x32_bf16 v[132:135], v[180:183], v[76:79], v[132:135]
    ds_read_b64_tr_b16 v[178:179], v231 offset:61440
    s_waitcnt lgkmcnt(6)
    v_mfma_f32_16x16x32_bf16 v[0:3], v[184:187], v[160:163], v[0:3]
    ds_read_b64_tr_b16 v[180:181], v232 offset:57344
    v_mfma_f32_16x16x32_bf16 v[32:35], v[184:187], v[164:167], v[32:35]
    ds_read_b64_tr_b16 v[182:183], v232 offset:61440
    s_waitcnt lgkmcnt(6)
    v_mfma_f32_16x16x32_bf16 v[36:39], v[188:191], v[164:167], v[36:39]
    ds_read_b64_tr_b16 v[184:185], v233 offset:57344
    v_mfma_f32_16x16x32_bf16 v[4:7], v[188:191], v[160:163], v[4:7]
    ds_read_b64_tr_b16 v[186:187], v233 offset:61440
    s_waitcnt lgkmcnt(6)
    v_mfma_f32_16x16x32_bf16 v[8:11], v[192:195], v[160:163], v[8:11]
    ds_read_b64_tr_b16 v[196:197], v234 offset:57344
    v_mfma_f32_16x16x32_bf16 v[40:43], v[192:195], v[164:167], v[40:43]
    ds_read_b64_tr_b16 v[198:199], v234 offset:61440
    s_waitcnt lgkmcnt(6)
    v_mfma_f32_16x16x32_bf16 v[44:47], v[176:179], v[164:167], v[44:47]
    ds_read_b64_tr_b16 v[192:193], v235 offset:57344
    v_mfma_f32_16x16x32_bf16 v[12:15], v[176:179], v[160:163], v[12:15]
    ds_read_b64_tr_b16 v[194:195], v235 offset:61440
    s_waitcnt lgkmcnt(6)
    v_mfma_f32_16x16x32_bf16 v[16:19], v[180:183], v[160:163], v[16:19]
    v_mfma_f32_16x16x32_bf16 v[48:51], v[180:183], v[164:167], v[48:51]
    s_waitcnt lgkmcnt(4)
    v_mfma_f32_16x16x32_bf16 v[52:55], v[184:187], v[164:167], v[52:55]
    v_mfma_f32_16x16x32_bf16 v[20:23], v[184:187], v[160:163], v[20:23]
    s_waitcnt lgkmcnt(2)
    v_mfma_f32_16x16x32_bf16 v[24:27], v[196:199], v[160:163], v[24:27]
    v_mfma_f32_16x16x32_bf16 v[56:59], v[196:199], v[164:167], v[56:59]
    s_waitcnt lgkmcnt(0)
    s_waitcnt vmcnt(15)
    s_barrier
    v_mfma_f32_16x16x32_bf16 v[60:63], v[192:195], v[164:167], v[60:63]
    ds_read_b128 v[176:179], v224 offset:8192
    v_mfma_f32_16x16x32_bf16 v[28:31], v[192:195], v[160:163], v[28:31]
    ds_read_b128 v[180:183], v225 offset:8192
    ds_read_b128 v[184:187], v226 offset:8192
    ds_read_b128 v[188:191], v227 offset:8192
    s_add_u32 s29, s29, 1
    s_mov_b32 s50, s35
    s_mov_b32 s54, s26
    s_mov_b32 s34, s32
    s_mov_b32 s32, s30
    s_xor_b32 s30, s30, 0x4000
    s_mov_b32 s35, s33
    s_mov_b32 s33, s31
    s_xor_b32 s31, s31, 0x4000
    s_setprio 0
.p2align 3
    v_rcp_f32 v208, v208
    v_rcp_f32 v212, v212
    buffer_store_dwordx4 v[220:223], v244, s[52:55], s50 offen offset:0 sc0 sc1
    v_max_f32_e64 v248, v128, v129
    v_max_f32_e64 v249, v136, v137
    v_max3_f32 v248, v248, v130, v131
    v_max3_f32 v249, v249, v138, v139
    v_max3_f32 v248, v248, v132, v133
    v_max3_f32 v249, v249, v140, v141
    v_max3_f32 v248, v248, v134, v135
    v_max3_f32 v249, v249, v142, v143
    s_nop 1
    v_permlane32_swap_b32 v248, v249
    v_max_f32 v248, v248, v249
    v_mov_b32 v249, v248
    s_nop 1
    v_permlane16_swap_b32 v248, v249
    v_max_f32 v248, v248, v249
    v_mul_f32 v248, 0xbe0293ee, v248
    v_mov_b32 v249, v248
    s_nop 1
    v_permlane32_swap_b32 v248, v249
.p2align 3
    v_fmamk_f32 v168, v128, 0x3e0293ee, v248
    v_fmamk_f32 v169, v129, 0x3e0293ee, v248
    v_fmamk_f32 v170, v130, 0x3e0293ee, v248
    v_fmamk_f32 v171, v131, 0x3e0293ee, v248
    v_exp_f32 v168, v168
    v_exp_f32 v169, v169
    v_exp_f32 v170, v170
    v_exp_f32 v171, v171
    v_fmamk_f32 v172, v136, 0x3e0293ee, v249
    v_fmamk_f32 v173, v137, 0x3e0293ee, v249
    v_fmamk_f32 v174, v138, 0x3e0293ee, v249
    v_fmamk_f32 v175, v139, 0x3e0293ee, v249
    s_setprio 2
    s_nop 0
    v_cvt_pk_bf16_f32 v160, v168, v169
    v_cvt_pk_bf16_f32 v161, v170, v171
    v_exp_f32 v172, v172
    v_exp_f32 v173, v173
    v_exp_f32 v174, v174
    v_exp_f32 v175, v175
    v_fmamk_f32 v168, v132, 0x3e0293ee, v248
    v_fmamk_f32 v169, v133, 0x3e0293ee, v248
    v_fmamk_f32 v170, v134, 0x3e0293ee, v248
    v_fmamk_f32 v171, v135, 0x3e0293ee, v248
    v_cvt_pk_bf16_f32 v164, v172, v173
    v_cvt_pk_bf16_f32 v165, v174, v175
    v_exp_f32 v168, v168
    v_exp_f32 v169, v169
    v_exp_f32 v170, v170
    v_exp_f32 v171, v171
    v_fmamk_f32 v172, v140, 0x3e0293ee, v249
    v_fmamk_f32 v173, v141, 0x3e0293ee, v249
    v_fmamk_f32 v174, v142, 0x3e0293ee, v249
    v_fmamk_f32 v175, v143, 0x3e0293ee, v249
    v_cvt_pk_bf16_f32 v162, v168, v169
    v_cvt_pk_bf16_f32 v163, v170, v171
    v_exp_f32 v172, v172
    v_exp_f32 v173, v173
    v_exp_f32 v174, v174
    v_exp_f32 v175, v175
    v_cvt_pk_bf16_f32 v166, v172, v173
    v_cvt_pk_bf16_f32 v167, v174, v175
    v_pk_mul_f32 v[0:1], v[0:1], v[208:209] op_sel_hi:[1,0]
    v_pk_mul_f32 v[2:3], v[2:3], v[208:209] op_sel_hi:[1,0]
    v_pk_mul_f32 v[4:5], v[4:5], v[208:209] op_sel_hi:[1,0]
    v_pk_mul_f32 v[6:7], v[6:7], v[208:209] op_sel_hi:[1,0]
    v_cvt_pk_bf16_f32 v96, v0, v1
    v_cvt_pk_bf16_f32 v97, v2, v3
    v_cvt_pk_bf16_f32 v98, v4, v5
    v_cvt_pk_bf16_f32 v99, v6, v7
    v_pk_mul_f32 v[8:9], v[8:9], v[208:209] op_sel_hi:[1,0]
    v_pk_mul_f32 v[10:11], v[10:11], v[208:209] op_sel_hi:[1,0]
    v_pk_mul_f32 v[12:13], v[12:13], v[208:209] op_sel_hi:[1,0]
    v_pk_mul_f32 v[14:15], v[14:15], v[208:209] op_sel_hi:[1,0]
    v_cvt_pk_bf16_f32 v100, v8, v9
    v_cvt_pk_bf16_f32 v101, v10, v11
    v_cvt_pk_bf16_f32 v102, v12, v13
    v_cvt_pk_bf16_f32 v103, v14, v15
    v_pk_mul_f32 v[16:17], v[16:17], v[208:209] op_sel_hi:[1,0]
    v_pk_mul_f32 v[18:19], v[18:19], v[208:209] op_sel_hi:[1,0]
    v_pk_mul_f32 v[20:21], v[20:21], v[208:209] op_sel_hi:[1,0]
    v_pk_mul_f32 v[22:23], v[22:23], v[208:209] op_sel_hi:[1,0]
    v_cvt_pk_bf16_f32 v104, v16, v17
    v_cvt_pk_bf16_f32 v105, v18, v19
    v_cvt_pk_bf16_f32 v106, v20, v21
    v_cvt_pk_bf16_f32 v107, v22, v23
    v_pk_mul_f32 v[24:25], v[24:25], v[208:209] op_sel_hi:[1,0]
    v_pk_mul_f32 v[26:27], v[26:27], v[208:209] op_sel_hi:[1,0]
    v_pk_mul_f32 v[28:29], v[28:29], v[208:209] op_sel_hi:[1,0]
    v_pk_mul_f32 v[30:31], v[30:31], v[208:209] op_sel_hi:[1,0]
    v_cvt_pk_bf16_f32 v108, v24, v25
    v_cvt_pk_bf16_f32 v109, v26, v27
    v_cvt_pk_bf16_f32 v110, v28, v29
    v_cvt_pk_bf16_f32 v111, v30, v31
    v_pk_mul_f32 v[32:33], v[32:33], v[212:213] op_sel_hi:[1,0]
    v_pk_mul_f32 v[34:35], v[34:35], v[212:213] op_sel_hi:[1,0]
    v_pk_mul_f32 v[36:37], v[36:37], v[212:213] op_sel_hi:[1,0]
    v_pk_mul_f32 v[38:39], v[38:39], v[212:213] op_sel_hi:[1,0]
    v_cvt_pk_bf16_f32 v112, v32, v33
    v_cvt_pk_bf16_f32 v113, v34, v35
    v_cvt_pk_bf16_f32 v114, v36, v37
    v_cvt_pk_bf16_f32 v115, v38, v39
    v_pk_mul_f32 v[40:41], v[40:41], v[212:213] op_sel_hi:[1,0]
    v_pk_mul_f32 v[42:43], v[42:43], v[212:213] op_sel_hi:[1,0]
    v_pk_mul_f32 v[44:45], v[44:45], v[212:213] op_sel_hi:[1,0]
    v_pk_mul_f32 v[46:47], v[46:47], v[212:213] op_sel_hi:[1,0]
    v_cvt_pk_bf16_f32 v116, v40, v41
    v_cvt_pk_bf16_f32 v117, v42, v43
    v_cvt_pk_bf16_f32 v118, v44, v45
    v_cvt_pk_bf16_f32 v119, v46, v47
    v_pk_mul_f32 v[48:49], v[48:49], v[212:213] op_sel_hi:[1,0]
    v_pk_mul_f32 v[50:51], v[50:51], v[212:213] op_sel_hi:[1,0]
    v_pk_mul_f32 v[52:53], v[52:53], v[212:213] op_sel_hi:[1,0]
    v_pk_mul_f32 v[54:55], v[54:55], v[212:213] op_sel_hi:[1,0]
    v_cvt_pk_bf16_f32 v120, v48, v49
    v_cvt_pk_bf16_f32 v121, v50, v51
    v_cvt_pk_bf16_f32 v122, v52, v53
    v_cvt_pk_bf16_f32 v123, v54, v55
    v_pk_mul_f32 v[56:57], v[56:57], v[212:213] op_sel_hi:[1,0]
    v_pk_mul_f32 v[58:59], v[58:59], v[212:213] op_sel_hi:[1,0]
    v_pk_mul_f32 v[60:61], v[60:61], v[212:213] op_sel_hi:[1,0]
    v_pk_mul_f32 v[62:63], v[62:63], v[212:213] op_sel_hi:[1,0]
    v_cvt_pk_bf16_f32 v124, v56, v57
    v_cvt_pk_bf16_f32 v125, v58, v59
    v_cvt_pk_bf16_f32 v126, v60, v61
    v_cvt_pk_bf16_f32 v127, v62, v63
    s_waitcnt vmcnt(1)
    v_mfma_f32_16x16x32_bf16 v[200:203], v[216:219], v[160:163], 0
    v_mfma_f32_16x16x32_bf16 v[204:207], v[216:219], v[164:167], 0
    s_waitcnt lgkmcnt(3)
    v_mfma_f32_16x16x32_bf16 v[144:147], v[176:179], v[64:67], 0
    s_setprio 3
    ds_read_b128 v[192:195], v224 offset:12288
    v_mfma_f32_16x16x32_bf16 v[152:155], v[176:179], v[80:83], 0
    s_waitcnt lgkmcnt(3)
    v_mfma_f32_16x16x32_bf16 v[152:155], v[180:183], v[84:87], v[152:155]
    ds_read_b128 v[196:199], v225 offset:12288
    v_mfma_f32_16x16x32_bf16 v[144:147], v[180:183], v[68:71], v[144:147]
    s_add_u32 m0, s58, 0x400
    s_nop 0
    buffer_load_dwordx4 v241, s[12:15], s30 offen offset:0 nt lds
    s_waitcnt lgkmcnt(3)
    v_mfma_f32_16x16x32_bf16 v[144:147], v[184:187], v[72:75], v[144:147]
    ds_read_b128 v[176:179], v226 offset:12288
    v_mfma_f32_16x16x32_bf16 v[152:155], v[184:187], v[88:91], v[152:155]
    s_waitcnt lgkmcnt(3)
    v_mfma_f32_16x16x32_bf16 v[152:155], v[188:191], v[92:95], v[152:155]
    ds_read_b128 v[180:183], v227 offset:12288
    v_mfma_f32_16x16x32_bf16 v[144:147], v[188:191], v[76:79], v[144:147]
    s_add_u32 m0, s37, 0x16000
    s_xor_b32 s38, s36, 0x3000
    buffer_load_dwordx4 v246, s[20:23], s38 offen offset:0 nt lds
    s_waitcnt lgkmcnt(3)
    v_mfma_f32_16x16x32_bf16 v[148:151], v[192:195], v[64:67], 0
    ds_read_b64_tr_b16 v[184:185], v228 offset:0
    v_mfma_f32_16x16x32_bf16 v[156:159], v[192:195], v[80:83], 0
    ds_read_b64_tr_b16 v[186:187], v228 offset:4096
    s_waitcnt lgkmcnt(4)
    v_mfma_f32_16x16x32_bf16 v[156:159], v[196:199], v[84:87], v[156:159]
    ds_read_b64_tr_b16 v[188:189], v229 offset:0
    v_mfma_f32_16x16x32_bf16 v[148:151], v[196:199], v[68:71], v[148:151]
    ds_read_b64_tr_b16 v[190:191], v229 offset:4096
    s_waitcnt lgkmcnt(5)
    v_mfma_f32_16x16x32_bf16 v[148:151], v[176:179], v[72:75], v[148:151]
    ds_read_b64_tr_b16 v[192:193], v230 offset:0
    v_mfma_f32_16x16x32_bf16 v[156:159], v[176:179], v[88:91], v[156:159]
    ds_read_b64_tr_b16 v[194:195], v230 offset:4096
    s_waitcnt lgkmcnt(6)
    v_mfma_f32_16x16x32_bf16 v[156:159], v[180:183], v[92:95], v[156:159]
    ds_read_b64_tr_b16 v[176:177], v231 offset:0
    v_mfma_f32_16x16x32_bf16 v[148:151], v[180:183], v[76:79], v[148:151]
    ds_read_b64_tr_b16 v[178:179], v231 offset:4096
    s_waitcnt lgkmcnt(6)
    v_mfma_f32_16x16x32_bf16 v[0:3], v[184:187], v[160:163], 0
    ds_read_b64_tr_b16 v[180:181], v232 offset:0
    v_mfma_f32_16x16x32_bf16 v[32:35], v[184:187], v[164:167], 0
    ds_read_b64_tr_b16 v[182:183], v232 offset:4096
    s_waitcnt lgkmcnt(6)
    v_mfma_f32_16x16x32_bf16 v[36:39], v[188:191], v[164:167], 0
    ds_read_b64_tr_b16 v[184:185], v233 offset:0
    v_mfma_f32_16x16x32_bf16 v[4:7], v[188:191], v[160:163], 0
    ds_read_b64_tr_b16 v[186:187], v233 offset:4096
    s_waitcnt lgkmcnt(6)
    v_mfma_f32_16x16x32_bf16 v[8:11], v[192:195], v[160:163], 0
    ds_read_b64_tr_b16 v[196:197], v234 offset:0
    v_mfma_f32_16x16x32_bf16 v[40:43], v[192:195], v[164:167], 0
    ds_read_b64_tr_b16 v[198:199], v234 offset:4096
    s_waitcnt lgkmcnt(6)
    v_mfma_f32_16x16x32_bf16 v[44:47], v[176:179], v[164:167], 0
    ds_read_b64_tr_b16 v[192:193], v235 offset:0
    v_mfma_f32_16x16x32_bf16 v[12:15], v[176:179], v[160:163], 0
    ds_read_b64_tr_b16 v[194:195], v235 offset:4096
    s_waitcnt lgkmcnt(6)
    v_mfma_f32_16x16x32_bf16 v[16:19], v[180:183], v[160:163], 0
    v_mfma_f32_16x16x32_bf16 v[48:51], v[180:183], v[164:167], 0
    s_waitcnt lgkmcnt(4)
    v_mfma_f32_16x16x32_bf16 v[52:55], v[184:187], v[164:167], 0
    v_mfma_f32_16x16x32_bf16 v[20:23], v[184:187], v[160:163], 0
    s_waitcnt lgkmcnt(2)
    v_mfma_f32_16x16x32_bf16 v[24:27], v[196:199], v[160:163], 0
    v_mfma_f32_16x16x32_bf16 v[56:59], v[196:199], v[164:167], 0
    s_waitcnt lgkmcnt(0)
    s_waitcnt vmcnt(12)
    s_barrier
    v_mfma_f32_16x16x32_bf16 v[60:63], v[192:195], v[164:167], 0
    ds_read_b128 v[176:179], v224 offset:16384
    v_mfma_f32_16x16x32_bf16 v[28:31], v[192:195], v[160:163], 0
    ds_read_b128 v[180:183], v225 offset:16384
    ds_read_b128 v[184:187], v226 offset:16384
    ds_read_b128 v[188:191], v227 offset:16384
    s_setprio 0
.p2align 3
    v_fmamk_f32 v168, v144, 0x3e0293ee, v248
    v_fmamk_f32 v169, v145, 0x3e0293ee, v248
    v_permlane16_swap_b32 v96, v98
    v_permlane16_swap_b32 v97, v99
    v_fmamk_f32 v170, v146, 0x3e0293ee, v248
    v_fmamk_f32 v171, v147, 0x3e0293ee, v248
    v_exp_f32 v168, v168
    v_exp_f32 v169, v169
    v_permlane16_swap_b32 v100, v102
    v_permlane16_swap_b32 v101, v103
    v_exp_f32 v170, v170
    v_exp_f32 v171, v171
    v_fmamk_f32 v172, v152, 0x3e0293ee, v249
    v_fmamk_f32 v173, v153, 0x3e0293ee, v249
    v_cndmask_b32_dpp v220, v100, v96, vcc quad_perm:[1,0,3,2] row_mask:0xf bank_mask:0xf
    v_cndmask_b32_dpp v221, v101, v97, vcc quad_perm:[1,0,3,2] row_mask:0xf bank_mask:0xf
    v_fmamk_f32 v174, v154, 0x3e0293ee, v249
    v_fmamk_f32 v175, v155, 0x3e0293ee, v249
    v_cvt_pk_bf16_f32 v160, v168, v169
    v_cvt_pk_bf16_f32 v161, v170, v171
    v_cndmask_b32_dpp v222, v102, v98, vcc quad_perm:[1,0,3,2] row_mask:0xf bank_mask:0xf
    v_cndmask_b32_dpp v223, v103, v99, vcc quad_perm:[1,0,3,2] row_mask:0xf bank_mask:0xf
    s_not_b64 vcc, vcc
    s_nop 0
    v_exp_f32 v172, v172
    v_exp_f32 v173, v173
    v_exp_f32 v174, v174
    v_exp_f32 v175, v175
    v_cndmask_b32_dpp v100, v96, v100, vcc quad_perm:[1,0,3,2] row_mask:0xf bank_mask:0xf
    v_cndmask_b32_dpp v101, v97, v101, vcc quad_perm:[1,0,3,2] row_mask:0xf bank_mask:0xf
    v_fmamk_f32 v168, v148, 0x3e0293ee, v248
    v_fmamk_f32 v169, v149, 0x3e0293ee, v248
    v_fmamk_f32 v170, v150, 0x3e0293ee, v248
    v_fmamk_f32 v171, v151, 0x3e0293ee, v248
    s_setprio 1
    s_nop 0
    v_cndmask_b32_dpp v102, v98, v102, vcc quad_perm:[1,0,3,2] row_mask:0xf bank_mask:0xf
    v_cndmask_b32_dpp v103, v99, v103, vcc quad_perm:[1,0,3,2] row_mask:0xf bank_mask:0xf
    s_not_b64 vcc, vcc
    s_nop 0
    v_cvt_pk_bf16_f32 v164, v172, v173
    v_cvt_pk_bf16_f32 v165, v174, v175
    v_exp_f32 v168, v168
    v_exp_f32 v169, v169
    buffer_store_dwordx4 v[100:103], v244, s[24:27], s34 offen offset:256 sc0 sc1
    v_exp_f32 v170, v170
    v_exp_f32 v171, v171
    v_fmamk_f32 v172, v156, 0x3e0293ee, v249
    v_fmamk_f32 v173, v157, 0x3e0293ee, v249
    v_fmamk_f32 v174, v158, 0x3e0293ee, v249
    v_fmamk_f32 v175, v159, 0x3e0293ee, v249
    v_cvt_pk_bf16_f32 v162, v168, v169
    v_cvt_pk_bf16_f32 v163, v170, v171
    v_exp_f32 v172, v172
    v_exp_f32 v173, v173
    v_exp_f32 v174, v174
    v_exp_f32 v175, v175
    v_cvt_pk_bf16_f32 v166, v172, v173
    v_cvt_pk_bf16_f32 v167, v174, v175
    s_waitcnt vmcnt(1)
    v_mfma_f32_16x16x32_bf16 v[208:211], v[216:219], v[160:163], v[200:203]
    v_mfma_f32_16x16x32_bf16 v[212:215], v[216:219], v[164:167], v[204:207]
    s_waitcnt lgkmcnt(3)
    v_mfma_f32_16x16x32_bf16 v[128:131], v[176:179], v[64:67], 0
    s_setprio 3
    ds_read_b128 v[192:195], v224 offset:20480
    v_mfma_f32_16x16x32_bf16 v[136:139], v[176:179], v[80:83], 0
    s_waitcnt lgkmcnt(3)
    v_mfma_f32_16x16x32_bf16 v[136:139], v[180:183], v[84:87], v[136:139]
    ds_read_b128 v[196:199], v225 offset:20480
    v_mfma_f32_16x16x32_bf16 v[128:131], v[180:183], v[68:71], v[128:131]
    s_add_u32 m0, s58, 0x800
    s_nop 0
    buffer_load_dwordx4 v242, s[12:15], s30 offen offset:0 nt lds
    s_waitcnt lgkmcnt(3)
    v_mfma_f32_16x16x32_bf16 v[128:131], v[184:187], v[72:75], v[128:131]
    ds_read_b128 v[176:179], v226 offset:20480
    v_mfma_f32_16x16x32_bf16 v[136:139], v[184:187], v[88:91], v[136:139]
    v_max_f32_e64 v250, v208, v212
    v_cmp_nle_f32_e64 s[42:43], v250, s40
    s_waitcnt lgkmcnt(3)
    v_mfma_f32_16x16x32_bf16 v[136:139], v[188:191], v[92:95], v[136:139]
    ds_read_b128 v[180:183], v227 offset:20480
    v_mfma_f32_16x16x32_bf16 v[128:131], v[188:191], v[76:79], v[128:131]
    s_cmp_lg_u64 s[42:43], 0
    s_cbranch_scc1 L_stublag14
L_retlag14:
    s_add_u32 m0, s37, 0xc000
    s_xor_b32 s38, s36, 0x6000
    buffer_load_dwordx4 v245, s[16:19], s38 offen offset:0 nt lds
    s_waitcnt lgkmcnt(3)
    v_mfma_f32_16x16x32_bf16 v[132:135], v[192:195], v[64:67], 0
    ds_read_b64_tr_b16 v[184:185], v228 offset:8192
    v_mfma_f32_16x16x32_bf16 v[140:143], v[192:195], v[80:83], 0
    ds_read_b64_tr_b16 v[186:187], v228 offset:12288
    s_waitcnt lgkmcnt(4)
    v_mfma_f32_16x16x32_bf16 v[140:143], v[196:199], v[84:87], v[140:143]
    ds_read_b64_tr_b16 v[188:189], v229 offset:8192
    v_mfma_f32_16x16x32_bf16 v[132:135], v[196:199], v[68:71], v[132:135]
    ds_read_b64_tr_b16 v[190:191], v229 offset:12288
    s_waitcnt lgkmcnt(5)
    v_mfma_f32_16x16x32_bf16 v[132:135], v[176:179], v[72:75], v[132:135]
    ds_read_b64_tr_b16 v[192:193], v230 offset:8192
    v_mfma_f32_16x16x32_bf16 v[140:143], v[176:179], v[88:91], v[140:143]
    ds_read_b64_tr_b16 v[194:195], v230 offset:12288
    s_waitcnt lgkmcnt(6)
    v_mfma_f32_16x16x32_bf16 v[140:143], v[180:183], v[92:95], v[140:143]
    ds_read_b64_tr_b16 v[176:177], v231 offset:8192
    v_mfma_f32_16x16x32_bf16 v[132:135], v[180:183], v[76:79], v[132:135]
    ds_read_b64_tr_b16 v[178:179], v231 offset:12288
    s_waitcnt lgkmcnt(6)
    v_mfma_f32_16x16x32_bf16 v[0:3], v[184:187], v[160:163], v[0:3]
    ds_read_b64_tr_b16 v[180:181], v232 offset:8192
    v_mfma_f32_16x16x32_bf16 v[32:35], v[184:187], v[164:167], v[32:35]
    ds_read_b64_tr_b16 v[182:183], v232 offset:12288
    s_waitcnt lgkmcnt(6)
    v_mfma_f32_16x16x32_bf16 v[36:39], v[188:191], v[164:167], v[36:39]
    ds_read_b64_tr_b16 v[184:185], v233 offset:8192
    v_mfma_f32_16x16x32_bf16 v[4:7], v[188:191], v[160:163], v[4:7]
    ds_read_b64_tr_b16 v[186:187], v233 offset:12288
    s_waitcnt lgkmcnt(6)
    v_mfma_f32_16x16x32_bf16 v[8:11], v[192:195], v[160:163], v[8:11]
    ds_read_b64_tr_b16 v[196:197], v234 offset:8192
    v_mfma_f32_16x16x32_bf16 v[40:43], v[192:195], v[164:167], v[40:43]
    ds_read_b64_tr_b16 v[198:199], v234 offset:12288
    s_waitcnt lgkmcnt(6)
    v_mfma_f32_16x16x32_bf16 v[44:47], v[176:179], v[164:167], v[44:47]
    ds_read_b64_tr_b16 v[192:193], v235 offset:8192
    v_mfma_f32_16x16x32_bf16 v[12:15], v[176:179], v[160:163], v[12:15]
    ds_read_b64_tr_b16 v[194:195], v235 offset:12288
    s_waitcnt lgkmcnt(6)
    v_mfma_f32_16x16x32_bf16 v[16:19], v[180:183], v[160:163], v[16:19]
    v_mfma_f32_16x16x32_bf16 v[48:51], v[180:183], v[164:167], v[48:51]
    s_waitcnt lgkmcnt(4)
    v_mfma_f32_16x16x32_bf16 v[52:55], v[184:187], v[164:167], v[52:55]
    v_mfma_f32_16x16x32_bf16 v[20:23], v[184:187], v[160:163], v[20:23]
    s_waitcnt lgkmcnt(2)
    v_mfma_f32_16x16x32_bf16 v[24:27], v[196:199], v[160:163], v[24:27]
    v_mfma_f32_16x16x32_bf16 v[56:59], v[196:199], v[164:167], v[56:59]
    s_waitcnt lgkmcnt(0)
    s_waitcnt vmcnt(9)
    s_barrier
    v_mfma_f32_16x16x32_bf16 v[60:63], v[192:195], v[164:167], v[60:63]
    ds_read_b128 v[176:179], v224 offset:24576
    v_mfma_f32_16x16x32_bf16 v[28:31], v[192:195], v[160:163], v[28:31]
    ds_read_b128 v[180:183], v225 offset:24576
    ds_read_b128 v[184:187], v226 offset:24576
    ds_read_b128 v[188:191], v227 offset:24576
    s_setprio 0
.p2align 3
    v_fmamk_f32 v168, v128, 0x3e0293ee, v248
    v_fmamk_f32 v169, v129, 0x3e0293ee, v248
    v_permlane16_swap_b32 v104, v106
    v_permlane16_swap_b32 v105, v107
    v_fmamk_f32 v170, v130, 0x3e0293ee, v248
    v_fmamk_f32 v171, v131, 0x3e0293ee, v248
    v_exp_f32 v168, v168
    v_exp_f32 v169, v169
    v_permlane16_swap_b32 v108, v110
    v_permlane16_swap_b32 v109, v111
    v_exp_f32 v170, v170
    v_exp_f32 v171, v171
    v_fmamk_f32 v172, v136, 0x3e0293ee, v249
    v_fmamk_f32 v173, v137, 0x3e0293ee, v249
    v_cndmask_b32_dpp v96, v108, v104, vcc quad_perm:[1,0,3,2] row_mask:0xf bank_mask:0xf
    v_cndmask_b32_dpp v97, v109, v105, vcc quad_perm:[1,0,3,2] row_mask:0xf bank_mask:0xf
    v_fmamk_f32 v174, v138, 0x3e0293ee, v249
    v_fmamk_f32 v175, v139, 0x3e0293ee, v249
    v_cvt_pk_bf16_f32 v160, v168, v169
    v_cvt_pk_bf16_f32 v161, v170, v171
    v_cndmask_b32_dpp v98, v110, v106, vcc quad_perm:[1,0,3,2] row_mask:0xf bank_mask:0xf
    v_cndmask_b32_dpp v99, v111, v107, vcc quad_perm:[1,0,3,2] row_mask:0xf bank_mask:0xf
    s_not_b64 vcc, vcc
    s_nop 0
    v_exp_f32 v172, v172
    v_exp_f32 v173, v173
    v_exp_f32 v174, v174
    v_exp_f32 v175, v175
    v_cndmask_b32_dpp v108, v104, v108, vcc quad_perm:[1,0,3,2] row_mask:0xf bank_mask:0xf
    v_cndmask_b32_dpp v109, v105, v109, vcc quad_perm:[1,0,3,2] row_mask:0xf bank_mask:0xf
    v_fmamk_f32 v168, v132, 0x3e0293ee, v248
    v_fmamk_f32 v169, v133, 0x3e0293ee, v248
    v_fmamk_f32 v170, v134, 0x3e0293ee, v248
    v_fmamk_f32 v171, v135, 0x3e0293ee, v248
    s_setprio 1
    s_nop 0
    v_cndmask_b32_dpp v110, v106, v110, vcc quad_perm:[1,0,3,2] row_mask:0xf bank_mask:0xf
    v_cndmask_b32_dpp v111, v107, v111, vcc quad_perm:[1,0,3,2] row_mask:0xf bank_mask:0xf
    s_not_b64 vcc, vcc
    s_nop 0
    v_cvt_pk_bf16_f32 v164, v172, v173
    v_cvt_pk_bf16_f32 v165, v174, v175
    v_exp_f32 v168, v168
    v_exp_f32 v169, v169
    buffer_store_dwordx4 v[96:99], v244, s[24:27], s34 offen offset:128 sc0 sc1
    v_exp_f32 v170, v170
    v_exp_f32 v171, v171
    v_fmamk_f32 v172, v140, 0x3e0293ee, v249
    v_fmamk_f32 v173, v141, 0x3e0293ee, v249
    v_fmamk_f32 v174, v142, 0x3e0293ee, v249
    v_fmamk_f32 v175, v143, 0x3e0293ee, v249
    v_cvt_pk_bf16_f32 v162, v168, v169
    v_cvt_pk_bf16_f32 v163, v170, v171
    v_exp_f32 v172, v172
    v_exp_f32 v173, v173
    v_exp_f32 v174, v174
    v_exp_f32 v175, v175
    v_cvt_pk_bf16_f32 v166, v172, v173
    v_cvt_pk_bf16_f32 v167, v174, v175
    s_waitcnt vmcnt(1)
    v_mfma_f32_16x16x32_bf16 v[200:203], v[216:219], v[160:163], v[208:211]
    v_mfma_f32_16x16x32_bf16 v[204:207], v[216:219], v[164:167], v[212:215]
    s_waitcnt lgkmcnt(3)
    v_mfma_f32_16x16x32_bf16 v[144:147], v[176:179], v[64:67], 0
    s_setprio 3
    ds_read_b128 v[192:195], v224 offset:28672
    v_mfma_f32_16x16x32_bf16 v[152:155], v[176:179], v[80:83], 0
    s_waitcnt lgkmcnt(3)
    v_mfma_f32_16x16x32_bf16 v[152:155], v[180:183], v[84:87], v[152:155]
    ds_read_b128 v[196:199], v225 offset:28672
    v_mfma_f32_16x16x32_bf16 v[144:147], v[180:183], v[68:71], v[144:147]
    s_add_u32 m0, s58, 0xc00
    s_nop 0
    buffer_load_dwordx4 v243, s[12:15], s30 offen offset:0 nt lds
    s_waitcnt lgkmcnt(3)
    v_mfma_f32_16x16x32_bf16 v[144:147], v[184:187], v[72:75], v[144:147]
    ds_read_b128 v[176:179], v226 offset:28672
    v_mfma_f32_16x16x32_bf16 v[152:155], v[184:187], v[88:91], v[152:155]
    v_max_f32_e64 v250, v200, v204
    v_cmp_nle_f32_e64 s[42:43], v250, s40
    s_waitcnt lgkmcnt(3)
    v_mfma_f32_16x16x32_bf16 v[152:155], v[188:191], v[92:95], v[152:155]
    ds_read_b128 v[180:183], v227 offset:28672
    v_mfma_f32_16x16x32_bf16 v[144:147], v[188:191], v[76:79], v[144:147]
    s_cmp_lg_u64 s[42:43], 0
    s_cbranch_scc1 L_stublag15
L_retlag15:
    s_add_u32 m0, s37, 0x18000
    s_xor_b32 s38, s36, 0x4000
    buffer_load_dwordx4 v246, s[20:23], s38 offen offset:0 nt lds
    s_waitcnt lgkmcnt(3)
    v_mfma_f32_16x16x32_bf16 v[148:151], v[192:195], v[64:67], 0
    ds_read_b64_tr_b16 v[184:185], v228 offset:16384
    v_mfma_f32_16x16x32_bf16 v[156:159], v[192:195], v[80:83], 0
    ds_read_b64_tr_b16 v[186:187], v228 offset:20480
    s_waitcnt lgkmcnt(4)
    v_mfma_f32_16x16x32_bf16 v[156:159], v[196:199], v[84:87], v[156:159]
    ds_read_b64_tr_b16 v[188:189], v229 offset:16384
    v_mfma_f32_16x16x32_bf16 v[148:151], v[196:199], v[68:71], v[148:151]
    ds_read_b64_tr_b16 v[190:191], v229 offset:20480
    s_waitcnt lgkmcnt(5)
    v_mfma_f32_16x16x32_bf16 v[148:151], v[176:179], v[72:75], v[148:151]
    ds_read_b64_tr_b16 v[192:193], v230 offset:16384
    v_mfma_f32_16x16x32_bf16 v[156:159], v[176:179], v[88:91], v[156:159]
    ds_read_b64_tr_b16 v[194:195], v230 offset:20480
    s_waitcnt lgkmcnt(6)
    v_mfma_f32_16x16x32_bf16 v[156:159], v[180:183], v[92:95], v[156:159]
    ds_read_b64_tr_b16 v[176:177], v231 offset:16384
    v_mfma_f32_16x16x32_bf16 v[148:151], v[180:183], v[76:79], v[148:151]
    ds_read_b64_tr_b16 v[178:179], v231 offset:20480
    s_waitcnt lgkmcnt(6)
    v_mfma_f32_16x16x32_bf16 v[0:3], v[184:187], v[160:163], v[0:3]
    ds_read_b64_tr_b16 v[180:181], v232 offset:16384
    v_mfma_f32_16x16x32_bf16 v[32:35], v[184:187], v[164:167], v[32:35]
    ds_read_b64_tr_b16 v[182:183], v232 offset:20480
    s_waitcnt lgkmcnt(6)
    v_mfma_f32_16x16x32_bf16 v[36:39], v[188:191], v[164:167], v[36:39]
    ds_read_b64_tr_b16 v[184:185], v233 offset:16384
    v_mfma_f32_16x16x32_bf16 v[4:7], v[188:191], v[160:163], v[4:7]
    ds_read_b64_tr_b16 v[186:187], v233 offset:20480
    s_waitcnt lgkmcnt(6)
    v_mfma_f32_16x16x32_bf16 v[8:11], v[192:195], v[160:163], v[8:11]
    ds_read_b64_tr_b16 v[196:197], v234 offset:16384
    v_mfma_f32_16x16x32_bf16 v[40:43], v[192:195], v[164:167], v[40:43]
    ds_read_b64_tr_b16 v[198:199], v234 offset:20480
    s_waitcnt lgkmcnt(6)
    v_mfma_f32_16x16x32_bf16 v[44:47], v[176:179], v[164:167], v[44:47]
    ds_read_b64_tr_b16 v[192:193], v235 offset:16384
    v_mfma_f32_16x16x32_bf16 v[12:15], v[176:179], v[160:163], v[12:15]
    ds_read_b64_tr_b16 v[194:195], v235 offset:20480
    s_waitcnt lgkmcnt(6)
    v_mfma_f32_16x16x32_bf16 v[16:19], v[180:183], v[160:163], v[16:19]
    v_mfma_f32_16x16x32_bf16 v[48:51], v[180:183], v[164:167], v[48:51]
    s_waitcnt lgkmcnt(4)
    v_mfma_f32_16x16x32_bf16 v[52:55], v[184:187], v[164:167], v[52:55]
    v_mfma_f32_16x16x32_bf16 v[20:23], v[184:187], v[160:163], v[20:23]
    s_waitcnt lgkmcnt(2)
    v_mfma_f32_16x16x32_bf16 v[24:27], v[196:199], v[160:163], v[24:27]
    v_mfma_f32_16x16x32_bf16 v[56:59], v[196:199], v[164:167], v[56:59]
    s_waitcnt lgkmcnt(0)
    s_waitcnt vmcnt(6)
    s_barrier
    v_mfma_f32_16x16x32_bf16 v[60:63], v[192:195], v[164:167], v[60:63]
    ds_read_b128 v[176:179], v224 offset:32768
    v_mfma_f32_16x16x32_bf16 v[28:31], v[192:195], v[160:163], v[28:31]
    ds_read_b128 v[180:183], v225 offset:32768
    ds_read_b128 v[184:187], v226 offset:32768
    ds_read_b128 v[188:191], v227 offset:32768
    s_setprio 0
.p2align 3
    v_fmamk_f32 v168, v144, 0x3e0293ee, v248
    v_fmamk_f32 v169, v145, 0x3e0293ee, v248
    buffer_store_dwordx4 v[108:111], v244, s[24:27], s34 offen offset:384 sc0 sc1
    v_fmamk_f32 v170, v146, 0x3e0293ee, v248
    v_fmamk_f32 v171, v147, 0x3e0293ee, v248
    v_exp_f32 v168, v168
    v_exp_f32 v169, v169
    v_exp_f32 v170, v170
    v_exp_f32 v171, v171
    v_fmamk_f32 v172, v152, 0x3e0293ee, v249
    v_fmamk_f32 v173, v153, 0x3e0293ee, v249
    v_fmamk_f32 v174, v154, 0x3e0293ee, v249
    v_fmamk_f32 v175, v155, 0x3e0293ee, v249
    v_cvt_pk_bf16_f32 v160, v168, v169
    v_cvt_pk_bf16_f32 v161, v170, v171
    v_exp_f32 v172, v172
    v_exp_f32 v173, v173
    v_exp_f32 v174, v174
    v_exp_f32 v175, v175
    v_fmamk_f32 v168, v148, 0x3e0293ee, v248
    v_fmamk_f32 v169, v149, 0x3e0293ee, v248
    v_fmamk_f32 v170, v150, 0x3e0293ee, v248
    v_fmamk_f32 v171, v151, 0x3e0293ee, v248
    s_setprio 1
    s_nop 0
    v_cvt_pk_bf16_f32 v164, v172, v173
    v_cvt_pk_bf16_f32 v165, v174, v175
    v_exp_f32 v168, v168
    v_exp_f32 v169, v169
    v_exp_f32 v170, v170
    v_exp_f32 v171, v171
    v_fmamk_f32 v172, v156, 0x3e0293ee, v249
    v_fmamk_f32 v173, v157, 0x3e0293ee, v249
    v_fmamk_f32 v174, v158, 0x3e0293ee, v249
    v_fmamk_f32 v175, v159, 0x3e0293ee, v249
    v_cvt_pk_bf16_f32 v162, v168, v169
    v_cvt_pk_bf16_f32 v163, v170, v171
    s_waitcnt vmcnt(2)
    s_nop 0
    ds_read_b128 v[96:99], v236 offset:0
    ds_read_b128 v[100:103], v237 offset:0
    ds_read_b128 v[104:107], v238 offset:0
    ds_read_b128 v[108:111], v239 offset:0
    v_exp_f32 v172, v172
    v_exp_f32 v173, v173
    v_exp_f32 v174, v174
    v_exp_f32 v175, v175
    v_cvt_pk_bf16_f32 v166, v172, v173
    v_cvt_pk_bf16_f32 v167, v174, v175
    s_waitcnt vmcnt(1)
    v_mfma_f32_16x16x32_bf16 v[208:211], v[216:219], v[160:163], v[200:203]
    v_mfma_f32_16x16x32_bf16 v[212:215], v[216:219], v[164:167], v[204:207]
    s_waitcnt lgkmcnt(7)
    v_mfma_f32_16x16x32_bf16 v[128:131], v[176:179], v[64:67], 0
    s_setprio 3
    ds_read_b128 v[192:195], v224 offset:36864
    v_mfma_f32_16x16x32_bf16 v[136:139], v[176:179], v[80:83], 0
    s_waitcnt lgkmcnt(7)
    v_mfma_f32_16x16x32_bf16 v[136:139], v[180:183], v[84:87], v[136:139]
    ds_read_b128 v[196:199], v225 offset:36864
    v_mfma_f32_16x16x32_bf16 v[128:131], v[180:183], v[68:71], v[128:131]
    s_add_u32 m0, s37, 0xe000
    s_xor_b32 s38, s36, 0x7000
    buffer_load_dwordx4 v245, s[16:19], s38 offen offset:0 nt lds
    s_waitcnt lgkmcnt(7)
    v_mfma_f32_16x16x32_bf16 v[128:131], v[184:187], v[72:75], v[128:131]
    ds_read_b128 v[176:179], v226 offset:36864
    v_mfma_f32_16x16x32_bf16 v[136:139], v[184:187], v[88:91], v[136:139]
    v_max_f32_e64 v250, v208, v212
    v_cmp_nle_f32_e64 s[42:43], v250, s40
    s_waitcnt lgkmcnt(7)
    v_mfma_f32_16x16x32_bf16 v[136:139], v[188:191], v[92:95], v[136:139]
    ds_read_b128 v[180:183], v227 offset:36864
    v_mfma_f32_16x16x32_bf16 v[128:131], v[188:191], v[76:79], v[128:131]
    s_cmp_lg_u64 s[42:43], 0
    s_cbranch_scc1 L_stublag16
L_retlag16:
    s_add_u32 m0, s37, 0x1a000
    s_xor_b32 s38, s36, 0x5000
    buffer_load_dwordx4 v246, s[20:23], s38 offen offset:0 nt lds
    s_waitcnt lgkmcnt(3)
    v_mfma_f32_16x16x32_bf16 v[132:135], v[192:195], v[64:67], 0
    ds_read_b64_tr_b16 v[184:185], v228 offset:24576
    v_mfma_f32_16x16x32_bf16 v[140:143], v[192:195], v[80:83], 0
    ds_read_b64_tr_b16 v[186:187], v228 offset:28672
    s_waitcnt lgkmcnt(4)
    v_mfma_f32_16x16x32_bf16 v[140:143], v[196:199], v[84:87], v[140:143]
    ds_read_b64_tr_b16 v[188:189], v229 offset:24576
    v_mfma_f32_16x16x32_bf16 v[132:135], v[196:199], v[68:71], v[132:135]
    ds_read_b64_tr_b16 v[190:191], v229 offset:28672
    s_waitcnt lgkmcnt(5)
    v_mfma_f32_16x16x32_bf16 v[132:135], v[176:179], v[72:75], v[132:135]
    ds_read_b64_tr_b16 v[192:193], v230 offset:24576
    v_mfma_f32_16x16x32_bf16 v[140:143], v[176:179], v[88:91], v[140:143]
    ds_read_b64_tr_b16 v[194:195], v230 offset:28672
    s_waitcnt lgkmcnt(6)
    v_mfma_f32_16x16x32_bf16 v[140:143], v[180:183], v[92:95], v[140:143]
    ds_read_b64_tr_b16 v[176:177], v231 offset:24576
    v_mfma_f32_16x16x32_bf16 v[132:135], v[180:183], v[76:79], v[132:135]
    ds_read_b64_tr_b16 v[178:179], v231 offset:28672
    s_waitcnt lgkmcnt(6)
    v_mfma_f32_16x16x32_bf16 v[0:3], v[184:187], v[160:163], v[0:3]
    ds_read_b64_tr_b16 v[180:181], v232 offset:24576
    v_mfma_f32_16x16x32_bf16 v[32:35], v[184:187], v[164:167], v[32:35]
    ds_read_b64_tr_b16 v[182:183], v232 offset:28672
    s_waitcnt lgkmcnt(6)
    v_mfma_f32_16x16x32_bf16 v[36:39], v[188:191], v[164:167], v[36:39]
    ds_read_b64_tr_b16 v[184:185], v233 offset:24576
    v_mfma_f32_16x16x32_bf16 v[4:7], v[188:191], v[160:163], v[4:7]
    ds_read_b64_tr_b16 v[186:187], v233 offset:28672
    s_waitcnt lgkmcnt(6)
    v_mfma_f32_16x16x32_bf16 v[8:11], v[192:195], v[160:163], v[8:11]
    ds_read_b64_tr_b16 v[196:197], v234 offset:24576
    v_mfma_f32_16x16x32_bf16 v[40:43], v[192:195], v[164:167], v[40:43]
    ds_read_b64_tr_b16 v[198:199], v234 offset:28672
    s_waitcnt lgkmcnt(6)
    v_mfma_f32_16x16x32_bf16 v[44:47], v[176:179], v[164:167], v[44:47]
    ds_read_b64_tr_b16 v[192:193], v235 offset:24576
    v_mfma_f32_16x16x32_bf16 v[12:15], v[176:179], v[160:163], v[12:15]
    ds_read_b64_tr_b16 v[194:195], v235 offset:28672
    s_waitcnt lgkmcnt(6)
    v_mfma_f32_16x16x32_bf16 v[16:19], v[180:183], v[160:163], v[16:19]
    v_mfma_f32_16x16x32_bf16 v[48:51], v[180:183], v[164:167], v[48:51]
    s_waitcnt lgkmcnt(4)
    v_mfma_f32_16x16x32_bf16 v[52:55], v[184:187], v[164:167], v[52:55]
    v_mfma_f32_16x16x32_bf16 v[20:23], v[184:187], v[160:163], v[20:23]
    s_waitcnt lgkmcnt(2)
    v_mfma_f32_16x16x32_bf16 v[24:27], v[196:199], v[160:163], v[24:27]
    v_mfma_f32_16x16x32_bf16 v[56:59], v[196:199], v[164:167], v[56:59]
    s_waitcnt lgkmcnt(0)
    s_waitcnt vmcnt(3)
    s_barrier
    v_mfma_f32_16x16x32_bf16 v[60:63], v[192:195], v[164:167], v[60:63]
    ds_read_b128 v[176:179], v224 offset:40960
    v_mfma_f32_16x16x32_bf16 v[28:31], v[192:195], v[160:163], v[28:31]
    ds_read_b128 v[180:183], v225 offset:40960
    ds_read_b128 v[184:187], v226 offset:40960
    ds_read_b128 v[188:191], v227 offset:40960
    s_setprio 0
.p2align 3
    v_fmamk_f32 v168, v128, 0x3e0293ee, v248
    v_fmamk_f32 v169, v129, 0x3e0293ee, v248
    buffer_store_dwordx4 v[220:223], v244, s[24:27], s34 offen offset:0 sc0 sc1
    v_fmamk_f32 v170, v130, 0x3e0293ee, v248
    v_fmamk_f32 v171, v131, 0x3e0293ee, v248
    v_exp_f32 v168, v168
    v_exp_f32 v169, v169
    v_exp_f32 v170, v170
    v_exp_f32 v171, v171
    v_fmamk_f32 v172, v136, 0x3e0293ee, v249
    v_fmamk_f32 v173, v137, 0x3e0293ee, v249
    v_fmamk_f32 v174, v138, 0x3e0293ee, v249
    v_fmamk_f32 v175, v139, 0x3e0293ee, v249
    v_cvt_pk_bf16_f32 v160, v168, v169
    v_cvt_pk_bf16_f32 v161, v170, v171
    v_exp_f32 v172, v172
    v_exp_f32 v173, v173
    v_exp_f32 v174, v174
    v_exp_f32 v175, v175
    v_fmamk_f32 v168, v132, 0x3e0293ee, v248
    v_fmamk_f32 v169, v133, 0x3e0293ee, v248
    v_fmamk_f32 v170, v134, 0x3e0293ee, v248
    v_fmamk_f32 v171, v135, 0x3e0293ee, v248
    s_setprio 1
    s_nop 0
    v_cvt_pk_bf16_f32 v164, v172, v173
    v_cvt_pk_bf16_f32 v165, v174, v175
    v_exp_f32 v168, v168
    v_exp_f32 v169, v169
    v_exp_f32 v170, v170
    v_exp_f32 v171, v171
    v_fmamk_f32 v172, v140, 0x3e0293ee, v249
    v_fmamk_f32 v173, v141, 0x3e0293ee, v249
    v_fmamk_f32 v174, v142, 0x3e0293ee, v249
    v_fmamk_f32 v175, v143, 0x3e0293ee, v249
    v_cvt_pk_bf16_f32 v162, v168, v169
    v_cvt_pk_bf16_f32 v163, v170, v171
    v_exp_f32 v172, v172
    v_exp_f32 v173, v173
    v_exp_f32 v174, v174
    v_exp_f32 v175, v175
    v_cvt_pk_bf16_f32 v166, v172, v173
    v_cvt_pk_bf16_f32 v167, v174, v175
    s_waitcnt vmcnt(1)
    v_mfma_f32_16x16x32_bf16 v[200:203], v[216:219], v[160:163], v[208:211]
    v_mfma_f32_16x16x32_bf16 v[204:207], v[216:219], v[164:167], v[212:215]
    s_waitcnt lgkmcnt(3)
    v_mfma_f32_16x16x32_bf16 v[144:147], v[176:179], v[64:67], 0
    s_setprio 3
    ds_read_b128 v[192:195], v224 offset:45056
    v_mfma_f32_16x16x32_bf16 v[152:155], v[176:179], v[80:83], 0
    s_waitcnt lgkmcnt(3)
    v_mfma_f32_16x16x32_bf16 v[152:155], v[180:183], v[84:87], v[152:155]
    ds_read_b128 v[196:199], v225 offset:45056
    v_mfma_f32_16x16x32_bf16 v[144:147], v[180:183], v[68:71], v[144:147]
    s_add_u32 m0, s58, 0x0
    s_nop 0
    buffer_load_dwordx4 v240, s[12:15], s31 offen offset:0 nt lds
    s_waitcnt lgkmcnt(3)
    v_mfma_f32_16x16x32_bf16 v[144:147], v[184:187], v[72:75], v[144:147]
    ds_read_b128 v[176:179], v226 offset:45056
    v_mfma_f32_16x16x32_bf16 v[152:155], v[184:187], v[88:91], v[152:155]
    v_max_f32_e64 v250, v200, v204
    v_cmp_nle_f32_e64 s[42:43], v250, s40
    s_waitcnt lgkmcnt(3)
    v_mfma_f32_16x16x32_bf16 v[152:155], v[188:191], v[92:95], v[152:155]
    ds_read_b128 v[180:183], v227 offset:45056
    v_mfma_f32_16x16x32_bf16 v[144:147], v[188:191], v[76:79], v[144:147]
    s_cmp_lg_u64 s[42:43], 0
    s_cbranch_scc1 L_stublag17
L_retlag17:
    s_add_u32 m0, s37, 0x1c000
    s_xor_b32 s38, s36, 0x6000
    buffer_load_dwordx4 v246, s[20:23], s38 offen offset:0 nt lds
    s_waitcnt lgkmcnt(3)
    v_mfma_f32_16x16x32_bf16 v[148:151], v[192:195], v[64:67], 0
    ds_read_b64_tr_b16 v[184:185], v228 offset:32768
    v_mfma_f32_16x16x32_bf16 v[156:159], v[192:195], v[80:83], 0
    ds_read_b64_tr_b16 v[186:187], v228 offset:36864
    s_waitcnt lgkmcnt(4)
    v_mfma_f32_16x16x32_bf16 v[156:159], v[196:199], v[84:87], v[156:159]
    ds_read_b64_tr_b16 v[188:189], v229 offset:32768
    v_mfma_f32_16x16x32_bf16 v[148:151], v[196:199], v[68:71], v[148:151]
    ds_read_b64_tr_b16 v[190:191], v229 offset:36864
    s_waitcnt lgkmcnt(5)
    v_mfma_f32_16x16x32_bf16 v[148:151], v[176:179], v[72:75], v[148:151]
    ds_read_b64_tr_b16 v[192:193], v230 offset:32768
    v_mfma_f32_16x16x32_bf16 v[156:159], v[176:179], v[88:91], v[156:159]
    ds_read_b64_tr_b16 v[194:195], v230 offset:36864
    s_waitcnt lgkmcnt(6)
    v_mfma_f32_16x16x32_bf16 v[156:159], v[180:183], v[92:95], v[156:159]
    ds_read_b64_tr_b16 v[176:177], v231 offset:32768
    v_mfma_f32_16x16x32_bf16 v[148:151], v[180:183], v[76:79], v[148:151]
    ds_read_b64_tr_b16 v[178:179], v231 offset:36864
    s_waitcnt lgkmcnt(6)
    v_mfma_f32_16x16x32_bf16 v[0:3], v[184:187], v[160:163], v[0:3]
    ds_read_b64_tr_b16 v[180:181], v232 offset:32768
    v_mfma_f32_16x16x32_bf16 v[32:35], v[184:187], v[164:167], v[32:35]
    ds_read_b64_tr_b16 v[182:183], v232 offset:36864
    s_waitcnt lgkmcnt(6)
    v_mfma_f32_16x16x32_bf16 v[36:39], v[188:191], v[164:167], v[36:39]
    ds_read_b64_tr_b16 v[184:185], v233 offset:32768
    v_mfma_f32_16x16x32_bf16 v[4:7], v[188:191], v[160:163], v[4:7]
    ds_read_b64_tr_b16 v[186:187], v233 offset:36864
    s_waitcnt lgkmcnt(6)
    v_mfma_f32_16x16x32_bf16 v[8:11], v[192:195], v[160:163], v[8:11]
    ds_read_b64_tr_b16 v[196:197], v234 offset:32768
    v_mfma_f32_16x16x32_bf16 v[40:43], v[192:195], v[164:167], v[40:43]
    ds_read_b64_tr_b16 v[198:199], v234 offset:36864
    s_waitcnt lgkmcnt(6)
    v_mfma_f32_16x16x32_bf16 v[44:47], v[176:179], v[164:167], v[44:47]
    ds_read_b64_tr_b16 v[192:193], v235 offset:32768
    v_mfma_f32_16x16x32_bf16 v[12:15], v[176:179], v[160:163], v[12:15]
    ds_read_b64_tr_b16 v[194:195], v235 offset:36864
    s_waitcnt lgkmcnt(6)
    v_mfma_f32_16x16x32_bf16 v[16:19], v[180:183], v[160:163], v[16:19]
    v_mfma_f32_16x16x32_bf16 v[48:51], v[180:183], v[164:167], v[48:51]
    s_waitcnt lgkmcnt(4)
    v_mfma_f32_16x16x32_bf16 v[52:55], v[184:187], v[164:167], v[52:55]
    v_mfma_f32_16x16x32_bf16 v[20:23], v[184:187], v[160:163], v[20:23]
    s_waitcnt lgkmcnt(2)
    v_mfma_f32_16x16x32_bf16 v[24:27], v[196:199], v[160:163], v[24:27]
    v_mfma_f32_16x16x32_bf16 v[56:59], v[196:199], v[164:167], v[56:59]
    s_waitcnt lgkmcnt(0)
    s_waitcnt vmcnt(3)
    s_barrier
    v_mfma_f32_16x16x32_bf16 v[60:63], v[192:195], v[164:167], v[60:63]
    ds_read_b128 v[176:179], v224 offset:49152
    v_mfma_f32_16x16x32_bf16 v[28:31], v[192:195], v[160:163], v[28:31]
    ds_read_b128 v[180:183], v225 offset:49152
    ds_read_b128 v[184:187], v226 offset:49152
    ds_read_b128 v[188:191], v227 offset:49152
    s_setprio 0
.p2align 3
    v_fmamk_f32 v168, v144, 0x3e0293ee, v248
    v_fmamk_f32 v169, v145, 0x3e0293ee, v248
    v_permlane16_swap_b32 v112, v114
    v_permlane16_swap_b32 v113, v115
    v_fmamk_f32 v170, v146, 0x3e0293ee, v248
    v_fmamk_f32 v171, v147, 0x3e0293ee, v248
    v_exp_f32 v168, v168
    v_exp_f32 v169, v169
    v_permlane16_swap_b32 v116, v118
    v_permlane16_swap_b32 v117, v119
    v_exp_f32 v170, v170
    v_exp_f32 v171, v171
    v_fmamk_f32 v172, v152, 0x3e0293ee, v249
    v_fmamk_f32 v173, v153, 0x3e0293ee, v249
    v_cndmask_b32_dpp v220, v116, v112, vcc quad_perm:[1,0,3,2] row_mask:0xf bank_mask:0xf
    v_cndmask_b32_dpp v221, v117, v113, vcc quad_perm:[1,0,3,2] row_mask:0xf bank_mask:0xf
    v_fmamk_f32 v174, v154, 0x3e0293ee, v249
    v_fmamk_f32 v175, v155, 0x3e0293ee, v249
    v_cvt_pk_bf16_f32 v160, v168, v169
    v_cvt_pk_bf16_f32 v161, v170, v171
    v_cndmask_b32_dpp v222, v118, v114, vcc quad_perm:[1,0,3,2] row_mask:0xf bank_mask:0xf
    v_cndmask_b32_dpp v223, v119, v115, vcc quad_perm:[1,0,3,2] row_mask:0xf bank_mask:0xf
    s_not_b64 vcc, vcc
    s_nop 0
    v_exp_f32 v172, v172
    v_exp_f32 v173, v173
    v_exp_f32 v174, v174
    v_exp_f32 v175, v175
    v_cndmask_b32_dpp v116, v112, v116, vcc quad_perm:[1,0,3,2] row_mask:0xf bank_mask:0xf
    v_cndmask_b32_dpp v117, v113, v117, vcc quad_perm:[1,0,3,2] row_mask:0xf bank_mask:0xf
    v_fmamk_f32 v168, v148, 0x3e0293ee, v248
    v_fmamk_f32 v169, v149, 0x3e0293ee, v248
    v_fmamk_f32 v170, v150, 0x3e0293ee, v248
    v_fmamk_f32 v171, v151, 0x3e0293ee, v248
    s_setprio 1
    s_nop 0
    v_cndmask_b32_dpp v118, v114, v118, vcc quad_perm:[1,0,3,2] row_mask:0xf bank_mask:0xf
    v_cndmask_b32_dpp v119, v115, v119, vcc quad_perm:[1,0,3,2] row_mask:0xf bank_mask:0xf
    s_not_b64 vcc, vcc
    s_nop 0
    v_cvt_pk_bf16_f32 v164, v172, v173
    v_cvt_pk_bf16_f32 v165, v174, v175
    v_exp_f32 v168, v168
    v_exp_f32 v169, v169
    buffer_store_dwordx4 v[116:119], v244, s[24:27], s35 offen offset:256 sc0 sc1
    v_exp_f32 v170, v170
    v_exp_f32 v171, v171
    v_fmamk_f32 v172, v156, 0x3e0293ee, v249
    v_fmamk_f32 v173, v157, 0x3e0293ee, v249
    v_fmamk_f32 v174, v158, 0x3e0293ee, v249
    v_fmamk_f32 v175, v159, 0x3e0293ee, v249
    v_cvt_pk_bf16_f32 v162, v168, v169
    v_cvt_pk_bf16_f32 v163, v170, v171
    v_exp_f32 v172, v172
    v_exp_f32 v173, v173
    v_exp_f32 v174, v174
    v_exp_f32 v175, v175
    v_cvt_pk_bf16_f32 v166, v172, v173
    v_cvt_pk_bf16_f32 v167, v174, v175
    s_waitcnt vmcnt(1)
    v_mfma_f32_16x16x32_bf16 v[208:211], v[216:219], v[160:163], v[200:203]
    v_mfma_f32_16x16x32_bf16 v[212:215], v[216:219], v[164:167], v[204:207]
    s_waitcnt lgkmcnt(3)
    v_mfma_f32_16x16x32_bf16 v[128:131], v[176:179], v[64:67], 0
    s_setprio 3
    ds_read_b128 v[192:195], v224 offset:53248
    v_mfma_f32_16x16x32_bf16 v[136:139], v[176:179], v[80:83], 0
    s_waitcnt lgkmcnt(3)
    v_mfma_f32_16x16x32_bf16 v[136:139], v[180:183], v[84:87], v[136:139]
    ds_read_b128 v[196:199], v225 offset:53248
    v_mfma_f32_16x16x32_bf16 v[128:131], v[180:183], v[68:71], v[128:131]
    s_add_u32 m0, s58, 0x400
    s_nop 0
    buffer_load_dwordx4 v241, s[12:15], s31 offen offset:0 nt lds
    s_waitcnt lgkmcnt(3)
    v_mfma_f32_16x16x32_bf16 v[128:131], v[184:187], v[72:75], v[128:131]
    ds_read_b128 v[176:179], v226 offset:53248
    v_mfma_f32_16x16x32_bf16 v[136:139], v[184:187], v[88:91], v[136:139]
    v_max_f32_e64 v250, v208, v212
    v_cmp_nle_f32_e64 s[42:43], v250, s40
    s_waitcnt lgkmcnt(3)
    v_mfma_f32_16x16x32_bf16 v[136:139], v[188:191], v[92:95], v[136:139]
    ds_read_b128 v[180:183], v227 offset:53248
    v_mfma_f32_16x16x32_bf16 v[128:131], v[188:191], v[76:79], v[128:131]
    s_cmp_lg_u64 s[42:43], 0
    s_cbranch_scc1 L_stublag18
L_retlag18:
    s_add_u32 m0, s37, 0x1e000
    s_xor_b32 s38, s36, 0x7000
    buffer_load_dwordx4 v246, s[20:23], s38 offen offset:0 nt lds
    s_waitcnt lgkmcnt(3)
    v_mfma_f32_16x16x32_bf16 v[132:135], v[192:195], v[64:67], 0
    ds_read_b64_tr_b16 v[184:185], v228 offset:40960
    v_mfma_f32_16x16x32_bf16 v[140:143], v[192:195], v[80:83], 0
    ds_read_b64_tr_b16 v[186:187], v228 offset:45056
    s_waitcnt lgkmcnt(4)
    v_mfma_f32_16x16x32_bf16 v[140:143], v[196:199], v[84:87], v[140:143]
    ds_read_b64_tr_b16 v[188:189], v229 offset:40960
    v_mfma_f32_16x16x32_bf16 v[132:135], v[196:199], v[68:71], v[132:135]
    ds_read_b64_tr_b16 v[190:191], v229 offset:45056
    s_waitcnt lgkmcnt(5)
    v_mfma_f32_16x16x32_bf16 v[132:135], v[176:179], v[72:75], v[132:135]
    ds_read_b64_tr_b16 v[192:193], v230 offset:40960
    v_mfma_f32_16x16x32_bf16 v[140:143], v[176:179], v[88:91], v[140:143]
    ds_read_b64_tr_b16 v[194:195], v230 offset:45056
    s_waitcnt lgkmcnt(6)
    v_mfma_f32_16x16x32_bf16 v[140:143], v[180:183], v[92:95], v[140:143]
    ds_read_b64_tr_b16 v[176:177], v231 offset:40960
    v_mfma_f32_16x16x32_bf16 v[132:135], v[180:183], v[76:79], v[132:135]
    ds_read_b64_tr_b16 v[178:179], v231 offset:45056
    s_waitcnt lgkmcnt(6)
    v_mfma_f32_16x16x32_bf16 v[0:3], v[184:187], v[160:163], v[0:3]
    ds_read_b64_tr_b16 v[180:181], v232 offset:40960
    v_mfma_f32_16x16x32_bf16 v[32:35], v[184:187], v[164:167], v[32:35]
    ds_read_b64_tr_b16 v[182:183], v232 offset:45056
    s_waitcnt lgkmcnt(6)
    v_mfma_f32_16x16x32_bf16 v[36:39], v[188:191], v[164:167], v[36:39]
    ds_read_b64_tr_b16 v[184:185], v233 offset:40960
    v_mfma_f32_16x16x32_bf16 v[4:7], v[188:191], v[160:163], v[4:7]
    ds_read_b64_tr_b16 v[186:187], v233 offset:45056
    s_waitcnt lgkmcnt(6)
    v_mfma_f32_16x16x32_bf16 v[8:11], v[192:195], v[160:163], v[8:11]
    ds_read_b64_tr_b16 v[196:197], v234 offset:40960
    v_mfma_f32_16x16x32_bf16 v[40:43], v[192:195], v[164:167], v[40:43]
    ds_read_b64_tr_b16 v[198:199], v234 offset:45056
    s_waitcnt lgkmcnt(6)
    v_mfma_f32_16x16x32_bf16 v[44:47], v[176:179], v[164:167], v[44:47]
    ds_read_b64_tr_b16 v[192:193], v235 offset:40960
    v_mfma_f32_16x16x32_bf16 v[12:15], v[176:179], v[160:163], v[12:15]
    ds_read_b64_tr_b16 v[194:195], v235 offset:45056
    s_waitcnt lgkmcnt(6)
    v_mfma_f32_16x16x32_bf16 v[16:19], v[180:183], v[160:163], v[16:19]
    v_mfma_f32_16x16x32_bf16 v[48:51], v[180:183], v[164:167], v[48:51]
    s_waitcnt lgkmcnt(4)
    v_mfma_f32_16x16x32_bf16 v[52:55], v[184:187], v[164:167], v[52:55]
    v_mfma_f32_16x16x32_bf16 v[20:23], v[184:187], v[160:163], v[20:23]
    s_waitcnt lgkmcnt(2)
    v_mfma_f32_16x16x32_bf16 v[24:27], v[196:199], v[160:163], v[24:27]
    v_mfma_f32_16x16x32_bf16 v[56:59], v[196:199], v[164:167], v[56:59]
    s_waitcnt lgkmcnt(0)
    s_waitcnt vmcnt(3)
    s_barrier
    v_mfma_f32_16x16x32_bf16 v[60:63], v[192:195], v[164:167], v[60:63]
    ds_read_b128 v[176:179], v224 offset:57344
    v_mfma_f32_16x16x32_bf16 v[28:31], v[192:195], v[160:163], v[28:31]
    ds_read_b128 v[180:183], v225 offset:57344
    ds_read_b128 v[184:187], v226 offset:57344
    ds_read_b128 v[188:191], v227 offset:57344
    s_setprio 0
.p2align 3
    v_fmamk_f32 v168, v128, 0x3e0293ee, v248
    v_fmamk_f32 v169, v129, 0x3e0293ee, v248
    v_permlane16_swap_b32 v120, v122
    v_permlane16_swap_b32 v121, v123
    v_fmamk_f32 v170, v130, 0x3e0293ee, v248
    v_fmamk_f32 v171, v131, 0x3e0293ee, v248
    v_exp_f32 v168, v168
    v_exp_f32 v169, v169
    v_permlane16_swap_b32 v124, v126
    v_permlane16_swap_b32 v125, v127
    v_exp_f32 v170, v170
    v_exp_f32 v171, v171
    v_fmamk_f32 v172, v136, 0x3e0293ee, v249
    v_fmamk_f32 v173, v137, 0x3e0293ee, v249
    v_cndmask_b32_dpp v112, v124, v120, vcc quad_perm:[1,0,3,2] row_mask:0xf bank_mask:0xf
    v_cndmask_b32_dpp v113, v125, v121, vcc quad_perm:[1,0,3,2] row_mask:0xf bank_mask:0xf
    v_fmamk_f32 v174, v138, 0x3e0293ee, v249
    v_fmamk_f32 v175, v139, 0x3e0293ee, v249
    v_cvt_pk_bf16_f32 v160, v168, v169
    v_cvt_pk_bf16_f32 v161, v170, v171
    v_cndmask_b32_dpp v114, v126, v122, vcc quad_perm:[1,0,3,2] row_mask:0xf bank_mask:0xf
    v_cndmask_b32_dpp v115, v127, v123, vcc quad_perm:[1,0,3,2] row_mask:0xf bank_mask:0xf
    s_not_b64 vcc, vcc
    s_nop 0
    v_exp_f32 v172, v172
    v_exp_f32 v173, v173
    v_exp_f32 v174, v174
    v_exp_f32 v175, v175
    v_cndmask_b32_dpp v124, v120, v124, vcc quad_perm:[1,0,3,2] row_mask:0xf bank_mask:0xf
    v_cndmask_b32_dpp v125, v121, v125, vcc quad_perm:[1,0,3,2] row_mask:0xf bank_mask:0xf
    v_fmamk_f32 v168, v132, 0x3e0293ee, v248
    v_fmamk_f32 v169, v133, 0x3e0293ee, v248
    v_fmamk_f32 v170, v134, 0x3e0293ee, v248
    v_fmamk_f32 v171, v135, 0x3e0293ee, v248
    s_setprio 1
    s_nop 0
    v_cndmask_b32_dpp v126, v122, v126, vcc quad_perm:[1,0,3,2] row_mask:0xf bank_mask:0xf
    v_cndmask_b32_dpp v127, v123, v127, vcc quad_perm:[1,0,3,2] row_mask:0xf bank_mask:0xf
    s_not_b64 vcc, vcc
    s_nop 0
    v_cvt_pk_bf16_f32 v164, v172, v173
    v_cvt_pk_bf16_f32 v165, v174, v175
    v_exp_f32 v168, v168
    v_exp_f32 v169, v169
    buffer_store_dwordx4 v[112:115], v244, s[24:27], s35 offen offset:128 sc0 sc1
    v_exp_f32 v170, v170
    v_exp_f32 v171, v171
    v_fmamk_f32 v172, v140, 0x3e0293ee, v249
    v_fmamk_f32 v173, v141, 0x3e0293ee, v249
    v_fmamk_f32 v174, v142, 0x3e0293ee, v249
    v_fmamk_f32 v175, v143, 0x3e0293ee, v249
    v_cvt_pk_bf16_f32 v162, v168, v169
    v_cvt_pk_bf16_f32 v163, v170, v171
    v_exp_f32 v172, v172
    v_exp_f32 v173, v173
    v_exp_f32 v174, v174
    v_exp_f32 v175, v175
    v_cvt_pk_bf16_f32 v166, v172, v173
    v_cvt_pk_bf16_f32 v167, v174, v175
    s_waitcnt vmcnt(1)
    v_mfma_f32_16x16x32_bf16 v[200:203], v[216:219], v[160:163], v[208:211]
    v_mfma_f32_16x16x32_bf16 v[204:207], v[216:219], v[164:167], v[212:215]
    s_waitcnt lgkmcnt(3)
    v_mfma_f32_16x16x32_bf16 v[144:147], v[176:179], v[64:67], 0
    s_setprio 3
    ds_read_b128 v[192:195], v224 offset:61440
    v_mfma_f32_16x16x32_bf16 v[152:155], v[176:179], v[80:83], 0
    s_waitcnt lgkmcnt(3)
    v_mfma_f32_16x16x32_bf16 v[152:155], v[180:183], v[84:87], v[152:155]
    ds_read_b128 v[196:199], v225 offset:61440
    v_mfma_f32_16x16x32_bf16 v[144:147], v[180:183], v[68:71], v[144:147]
    s_add_u32 m0, s58, 0x800
    s_nop 0
    buffer_load_dwordx4 v242, s[12:15], s31 offen offset:0 nt lds
    s_waitcnt lgkmcnt(3)
    v_mfma_f32_16x16x32_bf16 v[144:147], v[184:187], v[72:75], v[144:147]
    ds_read_b128 v[176:179], v226 offset:61440
    v_mfma_f32_16x16x32_bf16 v[152:155], v[184:187], v[88:91], v[152:155]
    v_max_f32_e64 v250, v200, v204
    v_cmp_nle_f32_e64 s[42:43], v250, s40
    s_waitcnt lgkmcnt(3)
    v_mfma_f32_16x16x32_bf16 v[152:155], v[188:191], v[92:95], v[152:155]
    ds_read_b128 v[180:183], v227 offset:61440
    v_mfma_f32_16x16x32_bf16 v[144:147], v[188:191], v[76:79], v[144:147]
    s_cmp_lg_u64 s[42:43], 0
    s_cbranch_scc1 L_stublag19
L_retlag19:
    s_add_u32 m0, s58, 0xc00
    s_nop 0
    buffer_load_dwordx4 v243, s[12:15], s31 offen offset:0 nt lds
    s_waitcnt lgkmcnt(3)
    v_mfma_f32_16x16x32_bf16 v[148:151], v[192:195], v[64:67], 0
    ds_read_b64_tr_b16 v[184:185], v228 offset:49152
    v_mfma_f32_16x16x32_bf16 v[156:159], v[192:195], v[80:83], 0
    ds_read_b64_tr_b16 v[186:187], v228 offset:53248
    s_waitcnt lgkmcnt(4)
    v_mfma_f32_16x16x32_bf16 v[156:159], v[196:199], v[84:87], v[156:159]
    ds_read_b64_tr_b16 v[188:189], v229 offset:49152
    v_mfma_f32_16x16x32_bf16 v[148:151], v[196:199], v[68:71], v[148:151]
    ds_read_b64_tr_b16 v[190:191], v229 offset:53248
    s_waitcnt lgkmcnt(5)
    v_mfma_f32_16x16x32_bf16 v[148:151], v[176:179], v[72:75], v[148:151]
    ds_read_b64_tr_b16 v[192:193], v230 offset:49152
    v_mfma_f32_16x16x32_bf16 v[156:159], v[176:179], v[88:91], v[156:159]
    ds_read_b64_tr_b16 v[194:195], v230 offset:53248
    s_waitcnt lgkmcnt(6)
    v_mfma_f32_16x16x32_bf16 v[156:159], v[180:183], v[92:95], v[156:159]
    ds_read_b64_tr_b16 v[176:177], v231 offset:49152
    v_mfma_f32_16x16x32_bf16 v[148:151], v[180:183], v[76:79], v[148:151]
    ds_read_b64_tr_b16 v[178:179], v231 offset:53248
    s_waitcnt lgkmcnt(6)
    v_mfma_f32_16x16x32_bf16 v[0:3], v[184:187], v[160:163], v[0:3]
    ds_read_b64_tr_b16 v[180:181], v232 offset:49152
    v_mfma_f32_16x16x32_bf16 v[32:35], v[184:187], v[164:167], v[32:35]
    ds_read_b64_tr_b16 v[182:183], v232 offset:53248
    s_waitcnt lgkmcnt(6)
    v_mfma_f32_16x16x32_bf16 v[36:39], v[188:191], v[164:167], v[36:39]
    ds_read_b64_tr_b16 v[184:185], v233 offset:49152
    v_mfma_f32_16x16x32_bf16 v[4:7], v[188:191], v[160:163], v[4:7]
    ds_read_b64_tr_b16 v[186:187], v233 offset:53248
    s_waitcnt lgkmcnt(6)
    v_mfma_f32_16x16x32_bf16 v[8:11], v[192:195], v[160:163], v[8:11]
    ds_read_b64_tr_b16 v[196:197], v234 offset:49152
    v_mfma_f32_16x16x32_bf16 v[40:43], v[192:195], v[164:167], v[40:43]
    ds_read_b64_tr_b16 v[198:199], v234 offset:53248
    s_waitcnt lgkmcnt(6)
    v_mfma_f32_16x16x32_bf16 v[44:47], v[176:179], v[164:167], v[44:47]
    ds_read_b64_tr_b16 v[192:193], v235 offset:49152
    v_mfma_f32_16x16x32_bf16 v[12:15], v[176:179], v[160:163], v[12:15]
    ds_read_b64_tr_b16 v[194:195], v235 offset:53248
    s_waitcnt lgkmcnt(6)
    v_mfma_f32_16x16x32_bf16 v[16:19], v[180:183], v[160:163], v[16:19]
    v_mfma_f32_16x16x32_bf16 v[48:51], v[180:183], v[164:167], v[48:51]
    s_waitcnt lgkmcnt(4)
    v_mfma_f32_16x16x32_bf16 v[52:55], v[184:187], v[164:167], v[52:55]
    v_mfma_f32_16x16x32_bf16 v[20:23], v[184:187], v[160:163], v[20:23]
    s_waitcnt lgkmcnt(2)
    v_mfma_f32_16x16x32_bf16 v[24:27], v[196:199], v[160:163], v[24:27]
    v_mfma_f32_16x16x32_bf16 v[56:59], v[196:199], v[164:167], v[56:59]
    s_waitcnt lgkmcnt(0)
    s_waitcnt vmcnt(3)
    s_barrier
    v_mfma_f32_16x16x32_bf16 v[60:63], v[192:195], v[164:167], v[60:63]
    ds_read_b128 v[176:179], v224 offset:0
    v_mfma_f32_16x16x32_bf16 v[28:31], v[192:195], v[160:163], v[28:31]
    ds_read_b128 v[180:183], v225 offset:0
    ds_read_b128 v[184:187], v226 offset:0
    ds_read_b128 v[188:191], v227 offset:0
    s_setprio 0
.p2align 3
    v_fmamk_f32 v168, v144, 0x3e0293ee, v248
    v_fmamk_f32 v169, v145, 0x3e0293ee, v248
    buffer_store_dwordx4 v[124:127], v244, s[24:27], s35 offen offset:384 sc0 sc1
    v_fmamk_f32 v170, v146, 0x3e0293ee, v248
    v_fmamk_f32 v171, v147, 0x3e0293ee, v248
    v_exp_f32 v168, v168
    v_exp_f32 v169, v169
    v_exp_f32 v170, v170
    v_exp_f32 v171, v171
    v_fmamk_f32 v172, v152, 0x3e0293ee, v249
    v_fmamk_f32 v173, v153, 0x3e0293ee, v249
    v_fmamk_f32 v174, v154, 0x3e0293ee, v249
    v_fmamk_f32 v175, v155, 0x3e0293ee, v249
    v_cvt_pk_bf16_f32 v160, v168, v169
    v_cvt_pk_bf16_f32 v161, v170, v171
    v_exp_f32 v172, v172
    v_exp_f32 v173, v173
    v_exp_f32 v174, v174
    v_exp_f32 v175, v175
    v_fmamk_f32 v168, v148, 0x3e0293ee, v248
    v_fmamk_f32 v169, v149, 0x3e0293ee, v248
    v_fmamk_f32 v170, v150, 0x3e0293ee, v248
    v_fmamk_f32 v171, v151, 0x3e0293ee, v248
    s_setprio 1
    s_nop 0
    v_cvt_pk_bf16_f32 v164, v172, v173
    v_cvt_pk_bf16_f32 v165, v174, v175
    v_exp_f32 v168, v168
    v_exp_f32 v169, v169
    v_exp_f32 v170, v170
    v_exp_f32 v171, v171
    v_fmamk_f32 v172, v156, 0x3e0293ee, v249
    v_fmamk_f32 v173, v157, 0x3e0293ee, v249
    v_fmamk_f32 v174, v158, 0x3e0293ee, v249
    v_fmamk_f32 v175, v159, 0x3e0293ee, v249
    v_cvt_pk_bf16_f32 v162, v168, v169
    v_cvt_pk_bf16_f32 v163, v170, v171
    s_waitcnt vmcnt(1)
    s_nop 0
    ds_read_b128 v[112:115], v236 offset:0
    ds_read_b128 v[116:119], v237 offset:0
    ds_read_b128 v[120:123], v238 offset:0
    ds_read_b128 v[124:127], v239 offset:0
    v_exp_f32 v172, v172
    v_exp_f32 v173, v173
    v_exp_f32 v174, v174
    v_exp_f32 v175, v175
    v_cvt_pk_bf16_f32 v166, v172, v173
    v_cvt_pk_bf16_f32 v167, v174, v175
    s_waitcnt vmcnt(1)
    v_mfma_f32_16x16x32_bf16 v[208:211], v[216:219], v[160:163], v[200:203]
    v_mfma_f32_16x16x32_bf16 v[212:215], v[216:219], v[164:167], v[204:207]
    s_waitcnt lgkmcnt(7)
    v_mfma_f32_16x16x32_bf16 v[128:131], v[176:179], v[96:99], 0
    s_setprio 3
    ds_read_b128 v[192:195], v224 offset:4096
    s_waitcnt lgkmcnt(4)
    v_mfma_f32_16x16x32_bf16 v[136:139], v[176:179], v[112:115], 0
    s_waitcnt lgkmcnt(3)
    v_mfma_f32_16x16x32_bf16 v[136:139], v[180:183], v[116:119], v[136:139]
    ds_read_b128 v[196:199], v225 offset:4096
    v_mfma_f32_16x16x32_bf16 v[128:131], v[180:183], v[100:103], v[128:131]
    s_waitcnt lgkmcnt(2)
    s_cmp_eq_u32 s29, 3
    s_cselect_b32 s14, 0, s14
    s_add_u32 m0, s58, 0x0
    s_add_u32 s38, s32, 0x2000000
    buffer_load_dwordx4 v240, s[12:15], s38 offen offset:0 nt lds
    v_mfma_f32_16x16x32_bf16 v[128:131], v[184:187], v[104:107], v[128:131]
    ds_read_b128 v[176:179], v226 offset:4096
    v_mfma_f32_16x16x32_bf16 v[136:139], v[184:187], v[120:123], v[136:139]
    v_max_f32_e64 v250, v208, v212
    v_cmp_nle_f32_e64 s[42:43], v250, s40
    v_mfma_f32_16x16x32_bf16 v[136:139], v[188:191], v[124:127], v[136:139]
    ds_read_b128 v[180:183], v227 offset:4096
    v_mfma_f32_16x16x32_bf16 v[128:131], v[188:191], v[108:111], v[128:131]
    s_cmp_lg_u64 s[42:43], 0
    s_cbranch_scc1 L_stublag20
L_retlag20:
    s_add_u32 m0, s58, 0x400
    s_add_u32 s38, s32, 0x2000000
    buffer_load_dwordx4 v241, s[12:15], s38 offen offset:0 nt lds
    s_waitcnt lgkmcnt(3)
    v_mfma_f32_16x16x32_bf16 v[132:135], v[192:195], v[96:99], 0
    ds_read_b64_tr_b16 v[184:185], v228 offset:57344
    v_mfma_f32_16x16x32_bf16 v[140:143], v[192:195], v[112:115], 0
    ds_read_b64_tr_b16 v[186:187], v228 offset:61440
    s_waitcnt lgkmcnt(4)
    v_mfma_f32_16x16x32_bf16 v[140:143], v[196:199], v[116:119], v[140:143]
    ds_read_b64_tr_b16 v[188:189], v229 offset:57344
    v_mfma_f32_16x16x32_bf16 v[132:135], v[196:199], v[100:103], v[132:135]
    ds_read_b64_tr_b16 v[190:191], v229 offset:61440
    s_waitcnt lgkmcnt(5)
    v_mfma_f32_16x16x32_bf16 v[132:135], v[176:179], v[104:107], v[132:135]
    ds_read_b64_tr_b16 v[192:193], v230 offset:57344
    v_mfma_f32_16x16x32_bf16 v[140:143], v[176:179], v[120:123], v[140:143]
    ds_read_b64_tr_b16 v[194:195], v230 offset:61440
    s_waitcnt lgkmcnt(6)
    v_mfma_f32_16x16x32_bf16 v[140:143], v[180:183], v[124:127], v[140:143]
    ds_read_b64_tr_b16 v[176:177], v231 offset:57344
    v_mfma_f32_16x16x32_bf16 v[132:135], v[180:183], v[108:111], v[132:135]
    ds_read_b64_tr_b16 v[178:179], v231 offset:61440
    s_waitcnt lgkmcnt(6)
    v_mfma_f32_16x16x32_bf16 v[0:3], v[184:187], v[160:163], v[0:3]
    ds_read_b64_tr_b16 v[180:181], v232 offset:57344
    v_mfma_f32_16x16x32_bf16 v[32:35], v[184:187], v[164:167], v[32:35]
    ds_read_b64_tr_b16 v[182:183], v232 offset:61440
    s_waitcnt lgkmcnt(6)
    v_mfma_f32_16x16x32_bf16 v[36:39], v[188:191], v[164:167], v[36:39]
    ds_read_b64_tr_b16 v[184:185], v233 offset:57344
    v_mfma_f32_16x16x32_bf16 v[4:7], v[188:191], v[160:163], v[4:7]
    ds_read_b64_tr_b16 v[186:187], v233 offset:61440
    s_waitcnt lgkmcnt(6)
    v_mfma_f32_16x16x32_bf16 v[8:11], v[192:195], v[160:163], v[8:11]
    ds_read_b64_tr_b16 v[196:197], v234 offset:57344
    v_mfma_f32_16x16x32_bf16 v[40:43], v[192:195], v[164:167], v[40:43]
    ds_read_b64_tr_b16 v[198:199], v234 offset:61440
    s_waitcnt lgkmcnt(6)
    v_mfma_f32_16x16x32_bf16 v[44:47], v[176:179], v[164:167], v[44:47]
    ds_read_b64_tr_b16 v[192:193], v235 offset:57344
    v_mfma_f32_16x16x32_bf16 v[12:15], v[176:179], v[160:163], v[12:15]
    ds_read_b64_tr_b16 v[194:195], v235 offset:61440
    s_waitcnt lgkmcnt(6)
    v_mfma_f32_16x16x32_bf16 v[16:19], v[180:183], v[160:163], v[16:19]
    v_mfma_f32_16x16x32_bf16 v[48:51], v[180:183], v[164:167], v[48:51]
    s_waitcnt lgkmcnt(4)
    v_mfma_f32_16x16x32_bf16 v[52:55], v[184:187], v[164:167], v[52:55]
    v_mfma_f32_16x16x32_bf16 v[20:23], v[184:187], v[160:163], v[20:23]
    s_waitcnt lgkmcnt(2)
    v_mfma_f32_16x16x32_bf16 v[24:27], v[196:199], v[160:163], v[24:27]
    v_mfma_f32_16x16x32_bf16 v[56:59], v[196:199], v[164:167], v[56:59]
    s_waitcnt lgkmcnt(0)
    s_cmp_eq_u32 s29, 3
    s_cbranch_scc1 L_nobar
    s_barrier
L_nobar:
    v_mfma_f32_16x16x32_bf16 v[60:63], v[192:195], v[164:167], v[60:63]
    ds_read_b128 v[176:179], v224 offset:8192
    v_mfma_f32_16x16x32_bf16 v[28:31], v[192:195], v[160:163], v[28:31]
    ds_read_b128 v[180:183], v225 offset:8192
    ds_read_b128 v[184:187], v226 offset:8192
    ds_read_b128 v[188:191], v227 offset:8192
    s_cmp_lg_u32 s29, 3
    s_cbranch_scc1 L_looplag
L_prelag:
    s_branch L_lastlead
L_endlag:
L_stublag0:
    s_call_b64 s[56:57], L_rare1
    s_branch L_retlag0
L_stublag1:
    s_call_b64 s[56:57], L_rare0
    s_branch L_retlag1
L_stublag2:
    s_call_b64 s[56:57], L_rare1
    s_branch L_retlag2
L_stublag3:
    s_call_b64 s[56:57], L_rare0
    s_branch L_retlag3
L_stublag4:
    s_call_b64 s[56:57], L_rare1
    s_branch L_retlag4
L_stublag5:
    s_call_b64 s[56:57], L_rare0
    s_branch L_retlag5
L_stublag6:
    s_call_b64 s[56:57], L_rare1
    s_branch L_retlag6
L_stublag7:
    s_call_b64 s[56:57], L_rare1
    s_branch L_retlag7
L_stublag8:
    s_call_b64 s[56:57], L_rare0
    s_branch L_retlag8
L_stublag9:
    s_call_b64 s[56:57], L_rare1
    s_branch L_retlag9
L_stublag10:
    s_call_b64 s[56:57], L_rare0
    s_branch L_retlag10
L_stublag11:
    s_call_b64 s[56:57], L_rare1
    s_branch L_retlag11
L_stublag12:
    s_call_b64 s[56:57], L_rare0
    s_branch L_retlag12
L_stublag13:
    s_call_b64 s[56:57], L_rare1
    s_branch L_retlag13
L_stublag14:
    s_call_b64 s[56:57], L_rare1
    s_branch L_retlag14
L_stublag15:
    s_call_b64 s[56:57], L_rare0
    s_branch L_retlag15
L_stublag16:
    s_call_b64 s[56:57], L_rare1
    s_branch L_retlag16
L_stublag17:
    s_call_b64 s[56:57], L_rare0
    s_branch L_retlag17
L_stublag18:
    s_call_b64 s[56:57], L_rare1
    s_branch L_retlag18
L_stublag19:
    s_call_b64 s[56:57], L_rare0
    s_branch L_retlag19
L_stublag20:
    s_call_b64 s[56:57], L_rare1
    s_branch L_retlag20
L_codeend:
.section .rodata,"a"
.p2align 6
.amdhsa_kernel standalone__gqa_softmax__near_ridge_kernel
  .amdhsa_next_free_vgpr 256
  .amdhsa_next_free_sgpr 64
  .amdhsa_accum_offset 256
  .amdhsa_group_segment_fixed_size 0
  .amdhsa_kernarg_size 48
  .amdhsa_user_sgpr_count 2
  .amdhsa_user_sgpr_kernarg_segment_ptr 1
  .amdhsa_system_sgpr_workgroup_id_x 1
.end_amdhsa_kernel
```
